```python
import torch

def _softmax(x, axis=-1):
    return torch.softmax(x, dim=axis)
def _gelu(x):
    return torch.nn.functional.gelu(x, approximate="tanh")
def _silu(x):
    return torch.nn.functional.silu(x)
def _sigmoid(x):
    return torch.sigmoid(x)
def _layernorm(x, axis=-1, eps=1e-5):
    m = x.mean(dim=axis, keepdim=True)
    v = x.var(dim=axis, keepdim=True, unbiased=False)
    return (x - m) / torch.sqrt(v + eps)
def _scatter_add(tgt, idx, src, axis=0):
    return tgt.clone().index_add_(axis, idx, src)
def _segment_sum(src, seg, n):
    out = torch.zeros((n,) + src.shape[1:], dtype=src.dtype)
    return out.index_add_(0, seg, src)
def _pad(x, pw):
    flat = tuple(v for pair in reversed(pw) for v in pair)
    return torch.nn.functional.pad(x, flat)

kernel_name = 'interleave_layers__linear_attn_block__dense_activation_relu__prompt'

def setup_inputs():

    _w = (lambda a: (lambda t: t.to(torch.bfloat16) if t.is_floating_point() else t)(torch.as_tensor(a)))
    def _A_setup():
        B, S, D = 1, 2048, 512
        return {
            "x": _w((lambda *s: torch.randn(*s, dtype=torch.bfloat16) * 0.05)(B, S, D)),
            "wqkv": _w((lambda *s: torch.randn(*s, dtype=torch.bfloat16) * 0.05)(D, 3 * D)),
            "wo": _w((lambda *s: torch.randn(*s, dtype=torch.bfloat16) * 0.05)(D, D)),
        }
    _A_in = _A_setup()

    def _B_setup():
        B, S, D, Dff = 1, 2048, 512, 1792
        return {
            "x": _w((lambda *s: torch.randn(*s, dtype=torch.bfloat16) * 0.05)(B, S, D)),
            "w1": _w((lambda *s: torch.randn(*s, dtype=torch.bfloat16) * 0.05)(D, Dff)),
            "w2": _w((lambda *s: torch.randn(*s, dtype=torch.bfloat16) * 0.05)(Dff, D)),
        }
    _B_in = _B_setup()

    return {
        "A_x": _A_in["x"],
        "A_wqkv": _A_in["wqkv"],
        "A_wo": _A_in["wo"],
        "B_x": _B_in["x"],
        "B_w1": _B_in["w1"],
        "B_w2": _B_in["w2"],
    }

def reference(A_x, A_wqkv, A_wo, B_x, B_w1, B_w2):
    def _A_ref(x, wqkv, wo):
        B, S, D = x.shape
        H = 32; Dh = D // H
        qkv = (lambda x, *d: x.permute(*d))((x @ wqkv).reshape(B, S, 3, H, Dh), 2, 0, 3, 1, 4)
        q, k, v = qkv[0], qkv[1], qkv[2]
        phi = lambda t: torch.where(t > 0, t + 1, torch.exp(t)) + 1e-6
        pq, pk = phi(q), phi(k)
        kv = torch.einsum("bhsd,bhse->bhde", pk, v)
        z = torch.einsum("bhsd->bhd", pk)
        num = torch.einsum("bhqd,bhde->bhqe", pq, kv)
        den = torch.einsum("bhqd,bhd->bhq", pq, z)[..., None] + 1e-6
        o = num / den
        return (lambda x, *d: x.permute(*d))(o, 0, 2, 1, 3).reshape(B, S, D) @ wo

    def _B_ref(x, w1, w2):
        h = torch.einsum("bsd,df->bsf", x, w1)
        zero = torch.zeros_like(h)
        h = torch.maximum(h, zero)
        return torch.einsum("bsf,fd->bsd", h, w2)

    x = A_x
    x = x + _A_ref(_layernorm(x, axis=-1), A_wqkv, A_wo)
    x = x + _B_ref(_layernorm(x, axis=-1), B_w1, B_w2)
    x = x + _A_ref(_layernorm(x, axis=-1), A_wqkv, A_wo)
    x = x + _B_ref(_layernorm(x, axis=-1), B_w1, B_w2)
    return x
```

```asm
; @launch grid=(256,1,1) block=(256,1,1) lds=163840
.amdgcn_target "amdgcn-amd-amdhsa--gfx950"
.text
.globl interleave_layers__linear_attn_block__dense_activation_relu__prompt_kernel
.p2align 8
.type interleave_layers__linear_attn_block__dense_activation_relu__prompt_kernel,@function
.set CODE_BYTES, L_code_end - L_pcref - 512
interleave_layers__linear_attn_block__dense_activation_relu__prompt_kernel:
    s_cmp_ge_u32 s2, 256
    s_cbranch_scc1 L_end
    s_load_dwordx2 s[4:5], s[0:1], 0
    s_load_dwordx2 s[8:9], s[0:1], 8
    s_load_dwordx2 s[28:29], s[0:1], 64
    s_load_dwordx2 s[12:13], s[0:1], 16
    s_load_dwordx2 s[16:17], s[0:1], 32
    s_load_dwordx2 s[20:21], s[0:1], 40
    s_load_dwordx2 s[24:25], s[0:1], 48
    s_getpc_b64 s[88:89]
L_pcref:
    s_lshr_b32 s44, s2, 3
    s_lshl_b32 s44, s44, 11
    v_lshlrev_b32 v15, 3, v0
    v_add_u32 v15, s44, v15
    v_min_u32 v15, CODE_BYTES, v15
    s_mov_b32 exec_lo, 0x10001
    s_mov_b32 exec_hi, 0x10001
    global_load_dword a227, v15, s[88:89]
    s_mov_b64 exec, -1
    v_lshrrev_b32 v12, 6, v0
    v_and_b32 v0, 63, v0
    s_mov_b32 s6, 2097152
    v_readfirstlane_b32 s32, v12
    s_mov_b32 s7, 0x20000
    s_mov_b32 s10, 1572864
    s_mov_b32 s11, 0x20000
    s_lshr_b32 s42, s2, 3
    s_and_b32 s33, s42, 15
    s_lshr_b32 s42, s42, 4
    s_and_b32 s34, s2, 7
    s_lshl1_add_u32 s34, s34, s42
    s_lshr_b32 s43, s33, 1
    s_xor_b32 s43, s43, s42
    s_and_b32 s43, s43, 1
    s_and_b32 s77, s33, 1
    s_lshl1_add_u32 s77, s43, s77
    v_lshlrev_b32 v1, 4, v0
    v_lshrrev_b32 v12, 4, v0
    v_and_b32 v13, 15, v0
    v_xor_b32 v14, v12, v13
    v_lshlrev_b32 v14, 4, v14
    v_lshl_add_u32 v16, v12, 10, v14
    v_xor_b32 v17, 64, v16
    v_xor_b32 v18, 0x80, v16
    v_xor_b32 v19, 0xc0, v16
    v_lshrrev_b32 v8, 2, v0
    v_and_b32 v9, 3, v0
    v_lshrrev_b32 v15, 3, v0
    v_and_b32 v15, 2, v15
    v_xor_b32 v9, v9, v15
    v_lshlrev_b32 v9, 4, v9
    v_and_b32 v15, 3, v8
    v_lshl_add_u32 v15, v12, 3, v15
    s_movk_i32 s43, 3072
    v_mad_u32_u24 v10, v15, s43, v9
    s_lshl_b32 s82, s32, 14
    s_add_u32 s82, s82, 98304
    s_lshl_b32 s43, s34, 17
    s_lshl_b32 s44, s32, 15
    s_add_u32 s43, s43, s44
    s_lshl_b32 s83, s32, 12
    s_add_u32 s44, s77, 0
    s_and_b32 s44, s44, 3
    s_lshl_b32 s45, s44, 8
    s_add_u32 s78, s43, s45
    s_lshl2_add_u32 s44, s44, s32
    s_mul_i32 s44, s44, 98304
    s_lshl_b32 s45, s33, 6
    s_add_u32 s68, s44, s45
    s_add_u32 s44, s77, 1
    s_and_b32 s44, s44, 3
    s_lshl_b32 s45, s44, 8
    s_add_u32 s79, s43, s45
    s_lshl2_add_u32 s44, s44, s32
    s_mul_i32 s44, s44, 98304
    s_lshl_b32 s45, s33, 6
    s_add_u32 s69, s44, s45
    s_add_u32 s44, s77, 2
    s_and_b32 s44, s44, 3
    s_lshl_b32 s45, s44, 8
    s_add_u32 s80, s43, s45
    s_lshl2_add_u32 s44, s44, s32
    s_mul_i32 s44, s44, 98304
    s_lshl_b32 s45, s33, 6
    s_add_u32 s70, s44, s45
    s_add_u32 s44, s77, 3
    s_and_b32 s44, s44, 3
    s_lshl_b32 s45, s44, 8
    s_add_u32 s81, s43, s45
    s_lshl2_add_u32 s44, s44, s32
    s_mul_i32 s44, s44, 98304
    s_lshl_b32 s45, s33, 6
    s_add_u32 s71, s44, s45
    s_waitcnt lgkmcnt(0)
    s_load_dword s39, s[28:29], 0
    s_lshl_b32 s44, s33, 11
    s_add_u32 s44, s44, s43
    buffer_load_dwordx4 v[64:67], v1, s[4:7], s44 offen offset:0
    buffer_load_dwordx4 v[68:71], v1, s[4:7], s44 offen offset:1024
    s_add_u32 m0, s83, 0
    s_add_u32 s47, s68, 1024
    buffer_load_dwordx4 v10, s[8:11], s47 offen lds
    s_add_u32 m0, s83, 1024
    s_add_u32 s47, s68, 13312
    buffer_load_dwordx4 v10, s[8:11], s47 offen lds
    s_mov_b32 s14, 524288
    s_mov_b32 s15, 0x20000
    s_mov_b32 s18, 1835008
    s_mov_b32 s19, 0x20000
    s_mov_b32 s22, 1835008
    s_mov_b32 s23, 0x20000
    s_mov_b32 s30, 29360128
    s_mov_b32 s31, 0x20000
    s_lshl_b32 s37, s34, 20
    s_add_u32 s37, s37, 1048576
    v_lshlrev_b32 v15, 7, v0
    s_mov_b64 exec, 0xf
    s_lshl2_add_u32 s44, s2, s32
    s_lshr_b32 s45, s44, 1
    s_mul_i32 s45, s45, 3072
    s_and_b32 s46, s44, 1
    s_lshl_b32 s46, s46, 9
    s_add_u32 s45, s45, s46
    buffer_load_dword a227, v15, s[8:11], s45 offen
    s_lshl2_add_u32 s44, s33, s32
    s_lshl_b32 s44, s44, 8
    s_add_u32 s44, s44, s37
    s_mov_b64 exec, 3
    buffer_load_dword a227, v15, s[28:31], s44 offen sc1
    s_mov_b64 exec, -1
    s_mul_i32 s84, s33, 278528
    s_add_u32 s84, s84, 23068672
    s_lshl_b32 s64, s32, 12
    s_add_u32 s64, s64, 65536
    s_lshr_b32 s60, s33, 2
    s_mul_i32 s60, s60, 896
    s_mul_i32 s61, s34, 114688
    s_add_u32 s60, s60, s61
    s_and_b32 s61, s33, 3
    s_cmp_eq_u32 s32, 3
    s_cbranch_scc1 L_u3_2
    s_cmp_eq_u32 s32, 2
    s_cbranch_scc1 L_u2_1
    s_mov_b32 s88, s20
    s_mov_b32 s89, s21
    s_mov_b32 s90, 1835008
    s_movk_i32 s62, 1024
    s_lshl1_add_u32 s60, s2, s32
    s_lshr_b32 s61, s60, 3
    s_and_b32 s60, s60, 7
    s_mul_i32 s86, s60, 56
    s_add_u32 s86, s86, s61
    s_lshl_b32 s86, s86, 12
    s_add_u32 s86, s86, 20971520
    s_cmp_ge_u32 s61, 56
    s_cselect_b32 s86, 2130706432, s86
    s_lshl_b32 s61, s61, 15
    s_lshl_b32 s60, s60, 7
    s_add_u32 s60, s60, s61
    s_branch L_uq_3
L_u2_1:
    s_mov_b32 s88, s16
    s_mov_b32 s89, s17
    s_mov_b32 s90, 1835008
    s_movk_i32 s62, 3584
    s_lshl_b32 s61, s61, 7
    s_add_u32 s60, s60, s61
    s_lshl_b32 s86, s34, 12
    s_add_u32 s86, s86, s84
    s_add_u32 s86, s86, 98304
L_uq_3:
    s_mov_b32 s91, 0x20000
    v_lshrrev_b32 v40, 3, v0
    v_and_b32 v255, 6, v40
    v_xor_b32 v255, v255, v0
    v_and_b32 v255, 7, v255
    v_lshlrev_b32 v255, 4, v255
    v_mad_u32_u24 v40, v40, s62, v255
    s_lshl_b32 s62, s62, 3
    s_add_u32 m0, s64, 0
    s_nop 0
    buffer_load_dwordx4 v40, s[88:91], s60 offen lds
    s_add_u32 m0, s64, 1024
    s_add_u32 s60, s60, s62
    buffer_load_dwordx4 v40, s[88:91], s60 offen lds
    s_add_u32 m0, s64, 2048
    s_add_u32 s60, s60, s62
    buffer_load_dwordx4 v40, s[88:91], s60 offen lds
    s_add_u32 m0, s64, 3072
    s_add_u32 s60, s60, s62
    buffer_load_dwordx4 v40, s[88:91], s60 offen lds
    s_branch L_ue_4
L_u3_2:
    s_movk_i32 s63, 3584
    s_mul_i32 s86, s34, 3072
    s_add_u32 s86, s86, s84
    s_add_u32 s86, s86, 163840
    s_lshr_b32 s47, s61, 1
    s_mul_i32 s47, s47, 6
    s_and_b32 s62, s61, 1
    s_add_u32 s47, s47, s62
    s_add_u32 s47, s47, 18
    s_lshl_b32 s47, s47, 5
    s_add_u32 s47, s47, s60
    v_lshrrev_b32 v40, 1, v0
    v_and_b32 v255, 16, v1
    v_mad_u32_u24 v40, v40, s63, v255
    s_add_u32 m0, s64, 2048
    s_mul_i32 s61, s61, 3
    buffer_load_dwordx4 v40, s[16:19], s47 offen lds
    s_add_u32 s61, s61, 17
    s_lshr_b32 s61, s61, 1
    s_lshl_b32 s61, s61, 6
    s_add_u32 s60, s60, s61
    s_mov_b32 s62, 57344
    v_mad_u32_u24 v40, v8, s63, v9
    s_add_u32 m0, s64, 0
    s_nop 0
    buffer_load_dwordx4 v40, s[16:19], s60 offen lds
    s_add_u32 m0, s64, 1024
    s_add_u32 s60, s60, s62
    buffer_load_dwordx4 v40, s[16:19], s60 offen lds
    buffer_load_dword a227, v1, s[16:19], s18 offen
L_ue_4:
    v_lshrrev_b32 v40, 3, v0
    v_and_b32 v255, 6, v40
    v_xor_b32 v255, v255, v0
    v_and_b32 v255, 7, v255
    v_lshlrev_b32 v255, 4, v255
    s_movk_i32 s63, 1024
    v_mad_u32_u24 v40, v40, s63, v255
    s_lshl2_add_u32 s60, s34, s32
    s_lshl_b32 s85, s60, 10
    s_add_u32 s85, s85, s84
    s_add_u32 s85, s85, 212992
    s_lshl_b32 s60, s60, 13
    s_lshl_b32 s61, s33, 7
    s_add_u32 s60, s60, s61
    s_cmp_ge_u32 s33, 8
    s_cselect_b32 s60, 2130706432, s60
    s_cselect_b32 s85, 2130706432, s85
    s_lshl_b32 s61, s32, 10
    s_add_u32 m0, s61, 49152
    s_nop 0
    buffer_load_dwordx4 v40, s[12:15], s60 offen lds
    s_add_u32 m0, s83, 2048
    s_add_u32 s47, s68, 2048
    buffer_load_dwordx4 v10, s[8:11], s47 offen lds
    s_add_u32 m0, s83, 3072
    s_add_u32 s47, s68, 14336
    buffer_load_dwordx4 v10, s[8:11], s47 offen lds
    s_mov_b32 s26, 2097152
    s_mov_b32 s27, 0x20000
    s_lshr_b32 s74, s33, 3
    s_and_b32 s75, s33, 7
    s_mov_b32 s38, 150000
    s_mov_b32 s40, 0x358637bd
    s_mov_b32 s41, 0x358637bd
    s_getreg_b32 s76, hwreg(HW_REG_XCC_ID, 0, 4)
    s_lshl_b32 s48, s32, 15
    s_add_u32 s48, s48, s37
    s_add_u32 s49, s48, 16384
    s_lshl2_add_u32 s42, s74, s32
    s_lshl_b32 s50, s42, 14
    s_add_u32 s50, s50, s37
    s_lshl_b32 s51, s75, 11
    s_add_u32 s51, s51, s50
    s_mul_i32 s50, s42, 57344
    s_add_u32 s50, s50, s37
    s_mul_i32 s52, s32, 114688
    s_lshl_b32 s53, s33, 10
    s_add_u32 s52, s52, s53
    s_add_u32 s52, s52, s37
    s_add_u32 s52, s52, 163840
    s_add_u32 s53, s52, 57344
    s_lshl_b32 s57, s32, 7
    s_add_u32 s57, s57, s37
    s_lshl2_add_u32 s54, s33, s57
    s_lshl_b32 s67, s42, 7
    s_add_u32 s67, s67, s37
    s_lshr_b32 s42, s42, 1
    s_mov_b32 s43, s42
    s_lshl_b32 s55, s42, 7
    s_add_u32 s55, s55, s37
    s_and_b32 s44, s32, 1
    s_lshl1_add_u32 s45, s75, s44
    s_lshl2_add_u32 s56, s45, s55
    s_lshl3_add_u32 s45, s42, s75
    s_lshl_b32 s45, s45, 8
    s_lshl3_add_u32 s45, s44, s45
    s_add_u32 s58, s45, s37
    s_lshl_b32 s59, s32, 11
    s_add_u32 s59, s59, s37
    s_lshl2_add_u32 s43, s43, s44
    s_lshl_b32 s43, s43, 6
    s_add_u32 s43, s43, 162944
    v_lshl_add_u32 v15, v13, 2, s43
    v_accvgpr_write_b32 a244, v15
    s_mul_i32 s42, s32, 114688
    s_add_u32 s42, s42, s37
    s_lshr_b32 s45, s33, 2
    s_add_u32 s42, s42, 163840
    s_lshl2_add_u32 s60, s45, s33
    s_lshl_b32 s60, s60, 10
    s_add_u32 s60, s60, 25600
    s_add_u32 s60, s60, s42
    s_add_u32 s61, s60, 57344
    s_mul_i32 s46, s45, 6144
    s_add_u32 s42, s42, s46
    s_and_b32 s46, s33, 3
    s_mul_i32 s62, s46, 3
    s_add_u32 s62, s62, 1
    s_lshr_b32 s62, s62, 1
    s_lshl_b32 s62, s62, 10
    s_add_u32 s62, s62, s42
    s_add_u32 s63, s62, 57344
    s_lshr_b32 s64, s46, 1
    s_mul_i32 s64, s64, 3072
    s_and_b32 s65, s46, 1
    s_lshl3_add_u32 s64, s65, s64
    s_add_u32 s64, s64, 1024
    s_add_u32 s64, s64, s42
    s_add_u32 s65, s64, 57344
    s_lshr_b32 s42, s32, 1
    s_lshl2_add_u32 s42, s42, s45
    s_lshl_b32 s42, s42, 7
    s_lshl1_add_u32 s44, s46, s44
    s_lshl2_add_u32 s42, s44, s42
    s_add_u32 s66, s42, s37
    s_mul_i32 s42, s33, 36864
    s_add_u32 s42, s42, 18874368
    s_lshl_b32 s43, s32, 13
    s_add_u32 s72, s42, s43
    s_lshl_b32 s44, s32, 14
    s_lshl_b32 s45, s34, 10
    s_lshl_b32 s46, s34, 7
    s_cmp_lt_u32 s32, 2
    s_cselect_b32 s45, s45, s46
    s_cselect_b32 s96, -1, 0x30003
    s_cselect_b32 s97, -1, 0x30003
    s_cselect_b64 vcc, -1, 0
    s_add_u32 s73, s42, s44
    s_add_u32 s73, s73, s45
    s_cmp_eq_u32 s32, 3
    s_cselect_b32 s73, 2130706432, s73
    v_lshlrev_b32 v15, 4, v12
    v_lshl_add_u32 v15, v13, 6, v15
    v_cndmask_b32 v15, v15, v1, vcc
    v_accvgpr_write_b32 a236, v15
    v_lshlrev_b32 v15, 2, v1
    v_and_b32 v15, 0xf00, v15
    v_lshrrev_b32 v15, 1, v15
    v_and_b32 v32, 48, v1
    s_lshr_b32 s44, s32, 1
    s_lshl_b32 s44, s44, 6
    s_add_u32 s44, s44, 32768
    s_sub_u32 s44, s44, s43
    v_add3_u32 v15, v15, v32, s44
    v_accvgpr_write_b32 a246, v15
    v_and_b32 v37, 1, v0
    v_cndmask_b32 v37, v37, 0, vcc
    s_min_u32 s47, s32, 2
    v_lshl_add_u32 v20, v13, 8, v14
    v_add_u32 v20, s82, v20
    v_xor_b32 v21, 64, v20
    v_xor_b32 v22, 0x80, v20
    v_xor_b32 v23, 0xc0, v20
    v_and_b32 v15, 3, v0
    v_lshlrev_b32 v15, 3, v15
    v_lshl_add_u32 v2, v8, 6, v15
    v_lshl_add_u32 v4, v8, 7, v15
    v_and_b32 v15, 1, v12
    v_lshlrev_b32 v15, 5, v15
    v_add_u32 v2, v2, v15
    v_xor_b32 v3, 32, v2
    v_bfe_u32 v15, v0, 3, 2
    v_lshl_add_u32 v4, v15, 5, v4
    v_xor_b32 v5, 32, v4
    v_xor_b32 v6, 64, v4
    v_xor_b32 v7, 0x60, v4
    v_lshlrev_b32 v32, 2, v13
    v_accvgpr_write_b32 a226, v32
    v_mov_b32 v33, 0x3f803f80
    v_accvgpr_write_b32 a248, v33
    v_accvgpr_write_b32 a249, v33
    v_accvgpr_write_b32 a250, v33
    v_accvgpr_write_b32 a251, v33
    v_add_u32 v33, 161792, v32
    v_accvgpr_write_b32 a224, v33
    v_and_b32 v34, 48, v0
    v_add_u32 v33, 161792, v34
    v_accvgpr_write_b32 a225, v33
    v_lshlrev_b32 v33, 2, v12
    v_lshl_add_u32 v33, v13, 4, v33
    v_accvgpr_write_b32 a228, v33
    s_lshl_b32 s42, s32, 8
    s_add_u32 s42, s42, 162816
    v_add_u32 v33, s42, v32
    v_accvgpr_write_b32 a230, v33
    v_and_b32 v35, 32, v0
    v_lshl_add_u32 v33, v35, 1, v33
    v_accvgpr_write_b32 a229, v33
    v_add_u32 v33, s42, v34
    v_accvgpr_write_b32 a231, v33
    s_lshl_b32 s42, s32, 10
    v_add_u32 v33, s42, v1
    v_accvgpr_write_b32 a232, v33
    v_add_u32 v35, 106496, v33
    v_accvgpr_write_b32 a234, v35
    s_lshl_b32 s42, s47, 14
    v_add_u32 v33, s42, v1
    v_lshl_add_u32 v33, v37, 12, v33
    v_accvgpr_write_b32 a233, v33
    s_lshl_b32 s42, s47, 14
    s_add_u32 s42, s42, 106496
    v_add_u32 v33, s42, v1
    v_lshl_add_u32 v33, v37, 14, v33
    v_accvgpr_write_b32 a235, v33
    v_add_u32 v33, 157696, v1
    v_accvgpr_write_b32 a238, v33
    v_lshlrev_b32 v35, 3, v12
    v_add_u32 v35, 162688, v35
    v_accvgpr_write_b32 a239, v35
    s_lshl_b32 s42, s32, 10
    v_add_u32 v33, s42, v33
    v_accvgpr_write_b32 a237, v33
    v_and_b32 v35, 1, v12
    v_lshrrev_b32 v36, 1, v12
    v_lshl_add_u32 v35, v35, 1, v36
    v_and_b32 v36, 3, v0
    v_lshl_add_u32 v35, v36, 2, v35
    s_lshr_b32 s42, s32, 1
    s_lshl_b32 s42, s42, 5
    s_add_u32 s42, s42, 162688
    v_lshl_add_u32 v35, v35, 1, s42
    v_accvgpr_write_b32 a247, v35
    s_add_u32 s42, s32, 0
    s_and_b32 s42, s42, 3
    s_lshl_b32 s42, s42, 13
    s_add_u32 s42, s42, 98304
    v_add_u32 v33, s42, v1
    v_accvgpr_write_b32 a240, v33
    s_add_u32 s42, s32, 1
    s_and_b32 s42, s42, 3
    s_lshl_b32 s42, s42, 13
    s_add_u32 s42, s42, 98304
    v_add_u32 v33, s42, v1
    v_accvgpr_write_b32 a241, v33
    s_add_u32 s42, s32, 2
    s_and_b32 s42, s42, 3
    s_lshl_b32 s42, s42, 13
    s_add_u32 s42, s42, 102400
    v_add_u32 v33, s42, v1
    v_accvgpr_write_b32 a242, v33
    s_add_u32 s42, s32, 3
    s_and_b32 s42, s42, 3
    s_lshl_b32 s42, s42, 13
    s_add_u32 s42, s42, 98304
    v_add_u32 v33, s42, v1
    v_accvgpr_write_b32 a243, v33
    s_lshl2_add_u32 s42, s74, s32
    s_lshl3_add_u32 s42, s34, s42
    s_lshl_b32 s42, s42, 14
    s_lshl_b32 s43, s75, 7
    s_add_u32 s42, s42, s43
    v_lshl_add_u32 v33, v13, 10, s42
    v_and_b32 v35, 1, v12
    v_lshl_add_u32 v33, v35, 5, v33
    v_lshrrev_b32 v35, 1, v12
    v_lshl_add_u32 v33, v35, 4, v33
    v_accvgpr_write_b32 a245, v33
    s_and_b32 s42, s32, 1
    s_lshl_b32 s42, s42, 5
    v_xor_b32 v27, s42, v2
    s_lshr_b32 s42, s32, 1
    s_lshl_b32 s42, s42, 11
    v_add_u32 v26, s42, v27
    s_lshl_b32 s43, s32, 5
    v_xor_b32 v30, s43, v4
    v_mov_b32 v76, 0x3f803f80
    s_waitcnt vmcnt(11)
    v_dot2_f32_bf16 v72, v76, v64, 0
    v_dot2_f32_bf16 v74, v76, v68, 0
    v_dot2_f32_bf16 v73, v64, v64, 0
    v_dot2_f32_bf16 v75, v68, v68, 0
    v_dot2_f32_bf16 v72, v76, v65, v72
    v_dot2_f32_bf16 v74, v76, v69, v74
    v_dot2_f32_bf16 v73, v65, v65, v73
    v_dot2_f32_bf16 v75, v69, v69, v75
    v_dot2_f32_bf16 v72, v76, v66, v72
    v_dot2_f32_bf16 v74, v76, v70, v74
    v_dot2_f32_bf16 v73, v66, v66, v73
    v_dot2_f32_bf16 v75, v70, v70, v75
    v_dot2_f32_bf16 v72, v76, v67, v72
    v_dot2_f32_bf16 v74, v76, v71, v74
    v_dot2_f32_bf16 v73, v67, v67, v73
    v_dot2_f32_bf16 v75, v71, v71, v75
    s_waitcnt lgkmcnt(0)
    s_mul_i32 s35, s39, 0x9E3779B1
    s_add_u32 s35, s35, 0x7F4A7C15
    s_add_u32 s77, s39, 1
    s_and_b32 s77, s77, 0xff
    s_mov_b32 s93, s39
    v_permlane32_swap_b32 v72, v74
    v_permlane32_swap_b32 v73, v75
    v_add_f32 v72, v72, v74
    v_add_f32 v73, v73, v75
    v_mov_b32 v74, v72
    v_mov_b32 v75, v73
    s_nop 1
    v_permlane16_swap_b32 v72, v74
    v_permlane16_swap_b32 v73, v75
    v_add_f32 v72, v72, v74
    v_add_f32 v73, v73, v75
    s_nop 0
    v_add_f32_dpp v72, v72, v72 row_ror:8 row_mask:0xf bank_mask:0xf
    v_add_f32_dpp v73, v73, v73 row_ror:8 row_mask:0xf bank_mask:0xf
    s_nop 0
    v_add_f32_dpp v72, v72, v72 row_ror:4 row_mask:0xf bank_mask:0xf
    v_add_f32_dpp v73, v73, v73 row_ror:4 row_mask:0xf bank_mask:0xf
    s_nop 0
    v_add_f32_dpp v72, v72, v72 row_ror:2 row_mask:0xf bank_mask:0xf
    v_add_f32_dpp v73, v73, v73 row_ror:2 row_mask:0xf bank_mask:0xf
    s_nop 0
    v_add_f32_dpp v72, v72, v72 row_ror:1 row_mask:0xf bank_mask:0xf
    v_add_f32_dpp v73, v73, v73 row_ror:1 row_mask:0xf bank_mask:0xf
    v_mul_f32 v72, 0xbb000000, v72
    v_mul_f32 v73, 0x3b000000, v73
    v_fma_f32 v73, -v72, v72, v73
    v_max_f32 v73, 0, v73
    v_add_f32 v73, 0x3727c5ac, v73
    v_rsq_f32 v73, v73
    v_mov_b32 v74, s35
    v_mov_b32 v75, s76
    v_lshrrev_b32 v15, 1, v0
    s_lshl4_add_u32 s44, s32, s33
    s_lshl_b32 s44, s44, 7
    s_add_u32 s44, s44, s37
    s_add_u32 s44, s44, 16384
    s_mov_b32 exec_lo, 1
    s_mov_b32 exec_hi, 1
    buffer_store_dwordx4 v[72:75], v15, s[28:31], s44 offen sc1
    s_mov_b64 exec, -1
    s_mov_b64 exec, 0
    s_cmp_eq_u32 s32, 0
    s_cbranch_scc1 L_pad0
    s_cmp_eq_u32 s32, 1
    s_cbranch_scc1 L_pad1
    s_cmp_eq_u32 s32, 2
    s_cbranch_scc1 L_pad2
    s_branch L_pad3
.p2align 12
L_padret0:
    s_mov_b64 exec, -1
    s_add_u32 m0, s82, 0
    s_add_u32 s47, s78, 0
    buffer_load_dwordx4 v16, s[4:7], s47 offen lds
    s_add_u32 m0, s82, 1024
    s_add_u32 s47, s78, 4096
    buffer_load_dwordx4 v17, s[4:7], s47 offen lds
    s_add_u32 m0, s82, 2048
    s_add_u32 s47, s78, 8192
    buffer_load_dwordx4 v18, s[4:7], s47 offen lds
    s_add_u32 m0, s82, 3072
    s_add_u32 s47, s78, 12288
    buffer_load_dwordx4 v19, s[4:7], s47 offen lds
    s_add_u32 m0, s82, 4096
    s_add_u32 s47, s78, 16384
    buffer_load_dwordx4 v16, s[4:7], s47 offen lds
    s_add_u32 m0, s82, 5120
    s_add_u32 s47, s78, 20480
    buffer_load_dwordx4 v17, s[4:7], s47 offen lds
    s_add_u32 m0, s82, 6144
    s_add_u32 s47, s78, 24576
    buffer_load_dwordx4 v18, s[4:7], s47 offen lds
    s_add_u32 m0, s82, 7168
    s_add_u32 s47, s78, 28672
    buffer_load_dwordx4 v19, s[4:7], s47 offen lds
    s_add_u32 m0, s82, 8192
    s_add_u32 s47, s79, 0
    buffer_load_dwordx4 v16, s[4:7], s47 offen lds
    s_add_u32 m0, s82, 9216
    s_add_u32 s47, s79, 4096
    buffer_load_dwordx4 v17, s[4:7], s47 offen lds
    s_add_u32 m0, s82, 10240
    s_add_u32 s47, s79, 8192
    buffer_load_dwordx4 v18, s[4:7], s47 offen lds
    s_add_u32 m0, s82, 11264
    s_add_u32 s47, s79, 12288
    buffer_load_dwordx4 v19, s[4:7], s47 offen lds
    s_lshl_b32 s47, s32, 12
    s_add_u32 s47, s47, 65536
    s_waitcnt vmcnt(16)
    s_cmp_eq_u32 s32, 3
    s_cbranch_scc1 L_qb_5
    v_add_u32 v208, s47, v4
    v_add_u32 v209, s47, v5
    v_add_u32 v210, s47, v6
    v_add_u32 v211, s47, v7
    ds_read_b64_tr_b16 v[192:193], v208 offset:0
    ds_read_b64_tr_b16 v[194:195], v208 offset:2048
    ds_read_b64_tr_b16 v[196:197], v209 offset:0
    ds_read_b64_tr_b16 v[198:199], v209 offset:2048
    ds_read_b64_tr_b16 v[200:201], v210 offset:0
    ds_read_b64_tr_b16 v[202:203], v210 offset:2048
    ds_read_b64_tr_b16 v[204:205], v211 offset:0
    ds_read_b64_tr_b16 v[206:207], v211 offset:2048
    s_waitcnt lgkmcnt(0)
    buffer_store_dwordx4 v[192:195], v1, s[28:31], s86 offen offset:0 sc1
    buffer_store_dwordx4 v[196:199], v1, s[28:31], s86 offen offset:1024 sc1
    buffer_store_dwordx4 v[200:203], v1, s[28:31], s86 offen offset:2048 sc1
    buffer_store_dwordx4 v[204:207], v1, s[28:31], s86 offen offset:3072 sc1
    s_branch L_qe_6
L_qb_5:
    v_add_u32 v208, s47, v2
    v_add_u32 v209, s47, v3
    v_lshl_add_u32 v210, v0, 3, s47
    ds_read_b64_tr_b16 v[192:193], v208 offset:0
    ds_read_b64_tr_b16 v[194:195], v208 offset:1024
    ds_read_b64_tr_b16 v[196:197], v209 offset:0
    ds_read_b64_tr_b16 v[198:199], v209 offset:1024
    ds_read_b64_tr_b16 v[200:201], v210 offset:2048
    ds_read_b64_tr_b16 v[202:203], v210 offset:2560
    s_waitcnt lgkmcnt(0)
    buffer_store_dwordx4 v[192:195], v1, s[28:31], s86 offen offset:0 sc1
    buffer_store_dwordx4 v[196:199], v1, s[28:31], s86 offen offset:1024 sc1
    buffer_store_dwordx4 v[200:203], v1, s[28:31], s86 offen offset:2048 sc1
    buffer_load_dword a227, v1, s[16:19], s18 offen
L_qe_6:
    s_waitcnt vmcnt(8)
    ds_read_b128 v[128:131], v20 offset:0
    ds_read_b128 v[132:135], v20 offset:4096
    ds_read_b128 v[136:139], v21 offset:0
    ds_read_b128 v[140:143], v21 offset:4096
    ds_read_b128 v[144:147], v22 offset:0
    ds_read_b128 v[148:151], v22 offset:4096
    ds_read_b128 v[152:155], v23 offset:0
    ds_read_b128 v[156:159], v23 offset:4096
    s_add_u32 m0, s82, 12288
    s_add_u32 s47, s79, 16384
    buffer_load_dwordx4 v16, s[4:7], s47 offen lds
    s_add_u32 m0, s82, 13312
    s_add_u32 s47, s79, 20480
    buffer_load_dwordx4 v17, s[4:7], s47 offen lds
    s_add_u32 m0, s82, 14336
    s_add_u32 s47, s79, 24576
    buffer_load_dwordx4 v18, s[4:7], s47 offen lds
    s_add_u32 m0, s82, 15360
    s_add_u32 s47, s79, 28672
    buffer_load_dwordx4 v19, s[4:7], s47 offen lds
    s_waitcnt lgkmcnt(0)
    s_barrier
    ds_read_b64_tr_b16 v[32:33], v26 offset:0
    ds_read_b64_tr_b16 v[34:35], v26 offset:1024
    ds_read_b64_tr_b16 v[36:37], v26 offset:4096
    ds_read_b64_tr_b16 v[38:39], v26 offset:5120
    ds_read_b64_tr_b16 v[40:41], v26 offset:8192
    ds_read_b64_tr_b16 v[42:43], v26 offset:9216
    ds_read_b64_tr_b16 v[44:45], v26 offset:12288
    ds_read_b64_tr_b16 v[46:47], v26 offset:13312
    ds_read_b64_tr_b16 v[48:49], v2 offset:0
    ds_read_b64_tr_b16 v[50:51], v2 offset:1024
    ds_read_b64_tr_b16 v[52:53], v3 offset:0
    ds_read_b64_tr_b16 v[54:55], v3 offset:1024
    s_waitcnt lgkmcnt(8)
    v_mfma_f32_16x16x32_bf16 a[252:255], a[248:251], v[32:35], 0
    ds_read_b64_tr_b16 v[56:57], v2 offset:2048
    ds_read_b64_tr_b16 v[58:59], v2 offset:3072
    v_mfma_f32_16x16x32_bf16 a[252:255], a[248:251], v[36:39], a[252:255]
    ds_read_b64_tr_b16 v[60:61], v3 offset:2048
    ds_read_b64_tr_b16 v[62:63], v3 offset:3072
    s_waitcnt lgkmcnt(8)
    v_mfma_f32_16x16x32_bf16 a[252:255], a[248:251], v[40:43], a[252:255]
    ds_read_b64_tr_b16 v[32:33], v2 offset:4096
    ds_read_b64_tr_b16 v[34:35], v2 offset:5120
    v_mfma_f32_16x16x32_bf16 a[252:255], a[248:251], v[44:47], a[252:255]
    ds_read_b64_tr_b16 v[36:37], v3 offset:4096
    ds_read_b64_tr_b16 v[38:39], v3 offset:5120
    s_add_u32 m0, s83, 16384
    s_add_u32 s47, s69, 1024
    buffer_load_dwordx4 v10, s[8:11], s47 offen lds
    ds_read_b64_tr_b16 v[224:225], v30 offset:49152
    s_waitcnt lgkmcnt(9)
    v_mfma_f32_16x16x32_bf16 v[64:67], v[128:131], v[48:51], 0
    ds_read_b64_tr_b16 v[40:41], v2 offset:6144
    ds_read_b64_tr_b16 v[226:227], v30 offset:51200
    v_mfma_f32_16x16x32_bf16 v[68:71], v[132:135], v[48:51], 0
    ds_read_b64_tr_b16 v[42:43], v2 offset:7168
    s_add_u32 m0, s83, 17408
    s_add_u32 s47, s69, 13312
    buffer_load_dwordx4 v10, s[8:11], s47 offen lds
    v_mfma_f32_16x16x32_bf16 v[72:75], v[128:131], v[52:55], 0
    ds_read_b64_tr_b16 v[44:45], v3 offset:6144
    v_mfma_f32_16x16x32_bf16 v[76:79], v[132:135], v[52:55], 0
    ds_read_b64_tr_b16 v[46:47], v3 offset:7168
    s_waitcnt lgkmcnt(3)
    buffer_store_dwordx4 v[224:227], v1, s[28:31], s85 offen sc1
    v_mfma_f32_16x16x32_bf16 v[80:83], v[128:131], v[56:59], 0
    ds_read_b64_tr_b16 v[48:49], v2 offset:8192
    v_mfma_f32_16x16x32_bf16 v[84:87], v[132:135], v[56:59], 0
    ds_read_b64_tr_b16 v[50:51], v2 offset:9216
    s_add_u32 m0, s83, 18432
    s_add_u32 s47, s69, 2048
    buffer_load_dwordx4 v10, s[8:11], s47 offen lds
    v_mfma_f32_16x16x32_bf16 v[88:91], v[128:131], v[60:63], 0
    ds_read_b64_tr_b16 v[52:53], v3 offset:8192
    v_mfma_f32_16x16x32_bf16 v[92:95], v[132:135], v[60:63], 0
    ds_read_b64_tr_b16 v[54:55], v3 offset:9216
    v_mfma_f32_16x16x32_bf16 v[64:67], v[136:139], v[32:35], v[64:67]
    ds_read_b64_tr_b16 v[56:57], v2 offset:10240
    s_add_u32 m0, s83, 19456
    s_add_u32 s47, s69, 14336
    buffer_load_dwordx4 v10, s[8:11], s47 offen lds
    v_mfma_f32_16x16x32_bf16 v[68:71], v[140:143], v[32:35], v[68:71]
    ds_read_b64_tr_b16 v[58:59], v2 offset:11264
    v_mfma_f32_16x16x32_bf16 v[72:75], v[136:139], v[36:39], v[72:75]
    ds_read_b64_tr_b16 v[60:61], v3 offset:10240
    v_mfma_f32_16x16x32_bf16 v[76:79], v[140:143], v[36:39], v[76:79]
    ds_read_b64_tr_b16 v[62:63], v3 offset:11264
    s_add_u32 m0, s82, 0
    s_add_u32 s47, s80, 0
    buffer_load_dwordx4 v16, s[4:7], s47 offen lds
    s_waitcnt lgkmcnt(8)
    v_mfma_f32_16x16x32_bf16 v[80:83], v[136:139], v[40:43], v[80:83]
    ds_read_b64_tr_b16 v[32:33], v2 offset:12288
    v_mfma_f32_16x16x32_bf16 v[84:87], v[140:143], v[40:43], v[84:87]
    ds_read_b64_tr_b16 v[34:35], v2 offset:13312
    v_mfma_f32_16x16x32_bf16 v[88:91], v[136:139], v[44:47], v[88:91]
    ds_read_b64_tr_b16 v[36:37], v3 offset:12288
    s_add_u32 m0, s82, 1024
    s_add_u32 s47, s80, 4096
    buffer_load_dwordx4 v17, s[4:7], s47 offen lds
    v_mfma_f32_16x16x32_bf16 v[92:95], v[140:143], v[44:47], v[92:95]
    ds_read_b64_tr_b16 v[38:39], v3 offset:13312
    s_waitcnt lgkmcnt(8)
    v_mfma_f32_16x16x32_bf16 v[64:67], v[144:147], v[48:51], v[64:67]
    ds_read_b64_tr_b16 v[40:41], v2 offset:14336
    v_mfma_f32_16x16x32_bf16 v[68:71], v[148:151], v[48:51], v[68:71]
    ds_read_b64_tr_b16 v[42:43], v2 offset:15360
    s_add_u32 m0, s82, 2048
    s_add_u32 s47, s80, 8192
    buffer_load_dwordx4 v18, s[4:7], s47 offen lds
    v_mfma_f32_16x16x32_bf16 v[72:75], v[144:147], v[52:55], v[72:75]
    ds_read_b64_tr_b16 v[44:45], v3 offset:14336
    v_mfma_f32_16x16x32_bf16 v[76:79], v[148:151], v[52:55], v[76:79]
    ds_read_b64_tr_b16 v[46:47], v3 offset:15360
    s_waitcnt lgkmcnt(8)
    v_mfma_f32_16x16x32_bf16 v[80:83], v[144:147], v[56:59], v[80:83]
    s_add_u32 m0, s82, 3072
    s_add_u32 s47, s80, 12288
    buffer_load_dwordx4 v19, s[4:7], s47 offen lds
    v_mfma_f32_16x16x32_bf16 v[84:87], v[148:151], v[56:59], v[84:87]
    s_add_u32 m0, s82, 4096
    s_add_u32 s47, s80, 16384
    buffer_load_dwordx4 v16, s[4:7], s47 offen lds
    v_mfma_f32_16x16x32_bf16 v[88:91], v[144:147], v[60:63], v[88:91]
    v_mfma_f32_16x16x32_bf16 v[92:95], v[148:151], v[60:63], v[92:95]
    s_waitcnt lgkmcnt(4)
    v_mfma_f32_16x16x32_bf16 v[64:67], v[152:155], v[32:35], v[64:67]
    s_add_u32 m0, s82, 5120
    s_add_u32 s47, s80, 20480
    buffer_load_dwordx4 v17, s[4:7], s47 offen lds
    v_mfma_f32_16x16x32_bf16 v[68:71], v[156:159], v[32:35], v[68:71]
    v_mfma_f32_16x16x32_bf16 v[72:75], v[152:155], v[36:39], v[72:75]
    s_add_u32 m0, s82, 6144
    s_add_u32 s47, s80, 24576
    buffer_load_dwordx4 v18, s[4:7], s47 offen lds
    v_mfma_f32_16x16x32_bf16 v[76:79], v[156:159], v[36:39], v[76:79]
    s_waitcnt vmcnt(12) lgkmcnt(0)
    v_mfma_f32_16x16x32_bf16 v[80:83], v[152:155], v[40:43], v[80:83]
    ds_read_b128 v[160:163], v20 offset:8192
    ds_read_b128 v[164:167], v20 offset:12288
    v_mfma_f32_16x16x32_bf16 v[84:87], v[156:159], v[40:43], v[84:87]
    ds_read_b128 v[168:171], v21 offset:8192
    ds_read_b128 v[172:175], v21 offset:12288
    v_mfma_f32_16x16x32_bf16 v[88:91], v[152:155], v[44:47], v[88:91]
    ds_read_b128 v[176:179], v22 offset:8192
    v_mfma_f32_16x16x32_bf16 v[92:95], v[156:159], v[44:47], v[92:95]
    s_add_u32 m0, s82, 7168
    s_add_u32 s47, s80, 28672
    buffer_load_dwordx4 v19, s[4:7], s47 offen lds
    ds_read_b128 v[180:183], v22 offset:12288
    ds_read_b128 v[184:187], v23 offset:8192
    ds_read_b128 v[188:191], v23 offset:12288
    s_waitcnt vmcnt(8) lgkmcnt(0)
    s_barrier
    ds_read_b64_tr_b16 v[32:33], v26 offset:16384
    ds_read_b64_tr_b16 v[34:35], v26 offset:17408
    ds_read_b64_tr_b16 v[36:37], v26 offset:20480
    ds_read_b64_tr_b16 v[38:39], v26 offset:21504
    ds_read_b64_tr_b16 v[40:41], v26 offset:24576
    ds_read_b64_tr_b16 v[42:43], v26 offset:25600
    ds_read_b64_tr_b16 v[44:45], v26 offset:28672
    ds_read_b64_tr_b16 v[46:47], v26 offset:29696
    ds_read_b64_tr_b16 v[48:49], v2 offset:16384
    ds_read_b64_tr_b16 v[50:51], v2 offset:17408
    ds_read_b64_tr_b16 v[52:53], v3 offset:16384
    ds_read_b64_tr_b16 v[54:55], v3 offset:17408
    s_waitcnt lgkmcnt(8)
    v_mfma_f32_16x16x32_bf16 a[252:255], a[248:251], v[32:35], a[252:255]
    ds_read_b64_tr_b16 v[56:57], v2 offset:18432
    ds_read_b64_tr_b16 v[58:59], v2 offset:19456
    v_mfma_f32_16x16x32_bf16 a[252:255], a[248:251], v[36:39], a[252:255]
    ds_read_b64_tr_b16 v[60:61], v3 offset:18432
    ds_read_b64_tr_b16 v[62:63], v3 offset:19456
    s_waitcnt lgkmcnt(8)
    v_mfma_f32_16x16x32_bf16 a[252:255], a[248:251], v[40:43], a[252:255]
    ds_read_b64_tr_b16 v[32:33], v2 offset:20480
    ds_read_b64_tr_b16 v[34:35], v2 offset:21504
    v_mfma_f32_16x16x32_bf16 a[252:255], a[248:251], v[44:47], a[252:255]
    ds_read_b64_tr_b16 v[36:37], v3 offset:20480
    ds_read_b64_tr_b16 v[38:39], v3 offset:21504
    s_add_u32 m0, s83, 32768
    s_add_u32 s47, s70, 1024
    buffer_load_dwordx4 v10, s[8:11], s47 offen lds
    s_waitcnt lgkmcnt(8)
    v_mfma_f32_16x16x32_bf16 v[64:67], v[160:163], v[48:51], v[64:67]
    ds_read_b64_tr_b16 v[40:41], v2 offset:22528
    s_lshl_b32 s47, s2, 7
    s_add_u32 s47, s47, 65536
    s_cmp_lg_u32 s32, 0
    s_cselect_b32 s47, 2130706432, s47
    v_mov_b32 v13, s35
    s_mov_b64 exec, 1
    buffer_store_dword v13, v1, s[28:31], s47 offen sc1
    s_mov_b64 exec, -1
    v_mfma_f32_16x16x32_bf16 v[68:71], v[164:167], v[48:51], v[68:71]
    ds_read_b64_tr_b16 v[42:43], v2 offset:23552
    v_mfma_f32_16x16x32_bf16 v[72:75], v[160:163], v[52:55], v[72:75]
    ds_read_b64_tr_b16 v[44:45], v3 offset:22528
    s_add_u32 m0, s83, 33792
    s_add_u32 s47, s70, 13312
L_pad0:
    s_cbranch_execz L_pad4
    buffer_load_dwordx4 v10, s[8:11], s47 offen lds
    v_mfma_f32_16x16x32_bf16 v[76:79], v[164:167], v[52:55], v[76:79]
    ds_read_b64_tr_b16 v[46:47], v3 offset:23552
    s_waitcnt lgkmcnt(8)
    v_mfma_f32_16x16x32_bf16 v[80:83], v[160:163], v[56:59], v[80:83]
    ds_read_b64_tr_b16 v[48:49], v2 offset:24576
    v_mfma_f32_16x16x32_bf16 v[84:87], v[164:167], v[56:59], v[84:87]
    ds_read_b64_tr_b16 v[50:51], v2 offset:25600
    s_add_u32 m0, s83, 34816
    s_add_u32 s47, s70, 2048
    buffer_load_dwordx4 v10, s[8:11], s47 offen lds
    v_mfma_f32_16x16x32_bf16 v[88:91], v[160:163], v[60:63], v[88:91]
    ds_read_b64_tr_b16 v[52:53], v3 offset:24576
    v_mfma_f32_16x16x32_bf16 v[92:95], v[164:167], v[60:63], v[92:95]
    ds_read_b64_tr_b16 v[54:55], v3 offset:25600
    s_waitcnt lgkmcnt(8)
    v_mfma_f32_16x16x32_bf16 v[64:67], v[168:171], v[32:35], v[64:67]
    ds_read_b64_tr_b16 v[56:57], v2 offset:26624
    s_add_u32 m0, s83, 35840
    s_add_u32 s47, s70, 14336
    buffer_load_dwordx4 v10, s[8:11], s47 offen lds
    v_mfma_f32_16x16x32_bf16 v[68:71], v[172:175], v[32:35], v[68:71]
    ds_read_b64_tr_b16 v[58:59], v2 offset:27648
    v_mfma_f32_16x16x32_bf16 v[72:75], v[168:171], v[36:39], v[72:75]
    ds_read_b64_tr_b16 v[60:61], v3 offset:26624
    v_mfma_f32_16x16x32_bf16 v[76:79], v[172:175], v[36:39], v[76:79]
    ds_read_b64_tr_b16 v[62:63], v3 offset:27648
    s_add_u32 m0, s82, 8192
    s_add_u32 s47, s81, 0
    buffer_load_dwordx4 v16, s[4:7], s47 offen lds
    s_waitcnt lgkmcnt(8)
    v_mfma_f32_16x16x32_bf16 v[80:83], v[168:171], v[40:43], v[80:83]
    ds_read_b64_tr_b16 v[32:33], v2 offset:28672
    v_mfma_f32_16x16x32_bf16 v[84:87], v[172:175], v[40:43], v[84:87]
    ds_read_b64_tr_b16 v[34:35], v2 offset:29696
    v_mfma_f32_16x16x32_bf16 v[88:91], v[168:171], v[44:47], v[88:91]
    ds_read_b64_tr_b16 v[36:37], v3 offset:28672
    s_add_u32 m0, s82, 9216
    s_add_u32 s47, s81, 4096
    buffer_load_dwordx4 v17, s[4:7], s47 offen lds
    v_mfma_f32_16x16x32_bf16 v[92:95], v[172:175], v[44:47], v[92:95]
    ds_read_b64_tr_b16 v[38:39], v3 offset:29696
    s_waitcnt lgkmcnt(8)
    v_mfma_f32_16x16x32_bf16 v[64:67], v[176:179], v[48:51], v[64:67]
    ds_read_b64_tr_b16 v[40:41], v2 offset:30720
    v_mfma_f32_16x16x32_bf16 v[68:71], v[180:183], v[48:51], v[68:71]
    ds_read_b64_tr_b16 v[42:43], v2 offset:31744
    s_add_u32 m0, s82, 10240
    s_add_u32 s47, s81, 8192
    buffer_load_dwordx4 v18, s[4:7], s47 offen lds
    v_mfma_f32_16x16x32_bf16 v[72:75], v[176:179], v[52:55], v[72:75]
    ds_read_b64_tr_b16 v[44:45], v3 offset:30720
    v_mfma_f32_16x16x32_bf16 v[76:79], v[180:183], v[52:55], v[76:79]
    ds_read_b64_tr_b16 v[46:47], v3 offset:31744
    s_waitcnt lgkmcnt(8)
    v_mfma_f32_16x16x32_bf16 v[80:83], v[176:179], v[56:59], v[80:83]
    s_add_u32 m0, s82, 11264
    s_add_u32 s47, s81, 12288
    buffer_load_dwordx4 v19, s[4:7], s47 offen lds
    v_mfma_f32_16x16x32_bf16 v[84:87], v[180:183], v[56:59], v[84:87]
    s_add_u32 m0, s82, 12288
    s_add_u32 s47, s81, 16384
    buffer_load_dwordx4 v16, s[4:7], s47 offen lds
    v_mfma_f32_16x16x32_bf16 v[88:91], v[176:179], v[60:63], v[88:91]
    v_mfma_f32_16x16x32_bf16 v[92:95], v[180:183], v[60:63], v[92:95]
    s_waitcnt lgkmcnt(4)
    v_mfma_f32_16x16x32_bf16 v[64:67], v[184:187], v[32:35], v[64:67]
    s_add_u32 m0, s82, 13312
    s_add_u32 s47, s81, 20480
    buffer_load_dwordx4 v17, s[4:7], s47 offen lds
    v_mfma_f32_16x16x32_bf16 v[68:71], v[188:191], v[32:35], v[68:71]
    v_mfma_f32_16x16x32_bf16 v[72:75], v[184:187], v[36:39], v[72:75]
    s_add_u32 m0, s82, 14336
    s_add_u32 s47, s81, 24576
    buffer_load_dwordx4 v18, s[4:7], s47 offen lds
    v_mfma_f32_16x16x32_bf16 v[76:79], v[188:191], v[36:39], v[76:79]
    s_waitcnt vmcnt(12) lgkmcnt(0)
    v_mfma_f32_16x16x32_bf16 v[80:83], v[184:187], v[40:43], v[80:83]
    ds_read_b128 v[192:195], v20 offset:0
    ds_read_b128 v[196:199], v20 offset:4096
    v_mfma_f32_16x16x32_bf16 v[84:87], v[188:191], v[40:43], v[84:87]
    ds_read_b128 v[200:203], v21 offset:0
    v_mfma_f32_16x16x32_bf16 v[88:91], v[184:187], v[44:47], v[88:91]
    s_add_u32 m0, s82, 15360
    s_add_u32 s47, s81, 28672
    buffer_load_dwordx4 v19, s[4:7], s47 offen lds
    v_mfma_f32_16x16x32_bf16 v[92:95], v[188:191], v[44:47], v[92:95]
    ds_read_b128 v[204:207], v21 offset:4096
    ds_read_b128 v[208:211], v22 offset:0
    ds_read_b128 v[212:215], v22 offset:4096
    ds_read_b128 v[216:219], v23 offset:0
    ds_read_b128 v[220:223], v23 offset:4096
    s_waitcnt vmcnt(8) lgkmcnt(0)
    s_barrier
    ds_read_b64_tr_b16 v[32:33], v26 offset:32768
    ds_read_b64_tr_b16 v[34:35], v26 offset:33792
    ds_read_b64_tr_b16 v[36:37], v26 offset:36864
    ds_read_b64_tr_b16 v[38:39], v26 offset:37888
    ds_read_b64_tr_b16 v[40:41], v26 offset:40960
    ds_read_b64_tr_b16 v[42:43], v26 offset:41984
    ds_read_b64_tr_b16 v[44:45], v26 offset:45056
    ds_read_b64_tr_b16 v[46:47], v26 offset:46080
    ds_read_b64_tr_b16 v[48:49], v2 offset:32768
    ds_read_b64_tr_b16 v[50:51], v2 offset:33792
    ds_read_b64_tr_b16 v[52:53], v3 offset:32768
    ds_read_b64_tr_b16 v[54:55], v3 offset:33792
    s_waitcnt lgkmcnt(8)
    v_mfma_f32_16x16x32_bf16 a[252:255], a[248:251], v[32:35], a[252:255]
    ds_read_b64_tr_b16 v[56:57], v2 offset:34816
    ds_read_b64_tr_b16 v[58:59], v2 offset:35840
    v_mfma_f32_16x16x32_bf16 a[252:255], a[248:251], v[36:39], a[252:255]
    ds_read_b64_tr_b16 v[60:61], v3 offset:34816
    ds_read_b64_tr_b16 v[62:63], v3 offset:35840
    s_waitcnt lgkmcnt(8)
    v_mfma_f32_16x16x32_bf16 a[252:255], a[248:251], v[40:43], a[252:255]
    ds_read_b64_tr_b16 v[32:33], v2 offset:36864
    ds_read_b64_tr_b16 v[34:35], v2 offset:37888
    v_mfma_f32_16x16x32_bf16 a[252:255], a[248:251], v[44:47], a[252:255]
    ds_read_b64_tr_b16 v[36:37], v3 offset:36864
    ds_read_b64_tr_b16 v[38:39], v3 offset:37888
    s_add_u32 m0, s83, 49152
    s_add_u32 s47, s71, 1024
    buffer_load_dwordx4 v10, s[8:11], s47 offen lds
    s_waitcnt lgkmcnt(8)
    v_mfma_f32_16x16x32_bf16 v[64:67], v[192:195], v[48:51], v[64:67]
    ds_read_b64_tr_b16 v[40:41], v2 offset:38912
    v_mfma_f32_16x16x32_bf16 v[68:71], v[196:199], v[48:51], v[68:71]
    ds_read_b64_tr_b16 v[42:43], v2 offset:39936
    v_mfma_f32_16x16x32_bf16 v[72:75], v[192:195], v[52:55], v[72:75]
    ds_read_b64_tr_b16 v[44:45], v3 offset:38912
    s_add_u32 m0, s83, 50176
    s_add_u32 s47, s71, 13312
    buffer_load_dwordx4 v10, s[8:11], s47 offen lds
    v_mfma_f32_16x16x32_bf16 v[76:79], v[196:199], v[52:55], v[76:79]
    ds_read_b64_tr_b16 v[46:47], v3 offset:39936
    s_waitcnt lgkmcnt(8)
    v_mfma_f32_16x16x32_bf16 v[80:83], v[192:195], v[56:59], v[80:83]
    ds_read_b64_tr_b16 v[48:49], v2 offset:40960
    v_mfma_f32_16x16x32_bf16 v[84:87], v[196:199], v[56:59], v[84:87]
    ds_read_b64_tr_b16 v[50:51], v2 offset:41984
    s_add_u32 m0, s83, 51200
    s_add_u32 s47, s71, 2048
    buffer_load_dwordx4 v10, s[8:11], s47 offen lds
    v_mfma_f32_16x16x32_bf16 v[88:91], v[192:195], v[60:63], v[88:91]
    ds_read_b64_tr_b16 v[52:53], v3 offset:40960
    v_mfma_f32_16x16x32_bf16 v[92:95], v[196:199], v[60:63], v[92:95]
    ds_read_b64_tr_b16 v[54:55], v3 offset:41984
    s_waitcnt lgkmcnt(8)
    v_mfma_f32_16x16x32_bf16 v[64:67], v[200:203], v[32:35], v[64:67]
    ds_read_b64_tr_b16 v[56:57], v2 offset:43008
    s_add_u32 m0, s83, 52224
    s_add_u32 s47, s71, 14336
    buffer_load_dwordx4 v10, s[8:11], s47 offen lds
    v_mfma_f32_16x16x32_bf16 v[68:71], v[204:207], v[32:35], v[68:71]
    ds_read_b64_tr_b16 v[58:59], v2 offset:44032
    v_mfma_f32_16x16x32_bf16 v[72:75], v[200:203], v[36:39], v[72:75]
    ds_read_b64_tr_b16 v[60:61], v3 offset:43008
    v_mfma_f32_16x16x32_bf16 v[76:79], v[204:207], v[36:39], v[76:79]
    ds_read_b64_tr_b16 v[62:63], v3 offset:44032
    v_and_b32 v12, 30, v0
    v_lshlrev_b32 v12, 6, v12
    v_and_b32 v13, 16, v1
    v_add_u32 v12, v12, v13
    s_add_u32 s46, s59, 16384
    buffer_load_dwordx4 v[116:119], v12, s[28:31], s46 offen sc1
    s_waitcnt lgkmcnt(8)
    v_mfma_f32_16x16x32_bf16 v[80:83], v[200:203], v[40:43], v[80:83]
    ds_read_b64_tr_b16 v[32:33], v2 offset:45056
    s_lshl_b32 s83, s32, 11
    v_mfma_f32_16x16x32_bf16 v[84:87], v[204:207], v[40:43], v[84:87]
    ds_read_b64_tr_b16 v[34:35], v2 offset:46080
    v_mfma_f32_16x16x32_bf16 v[88:91], v[200:203], v[44:47], v[88:91]
    ds_read_b64_tr_b16 v[36:37], v3 offset:45056
    v_mfma_f32_16x16x32_bf16 v[92:95], v[204:207], v[44:47], v[92:95]
    ds_read_b64_tr_b16 v[38:39], v3 offset:46080
    s_waitcnt lgkmcnt(8)
    v_mfma_f32_16x16x32_bf16 v[64:67], v[208:211], v[48:51], v[64:67]
    ds_read_b64_tr_b16 v[40:41], v2 offset:47104
    v_mfma_f32_16x16x32_bf16 v[68:71], v[212:215], v[48:51], v[68:71]
    ds_read_b64_tr_b16 v[42:43], v2 offset:48128
    v_and_b32 v14, 3, v8
    v_lshrrev_b32 v10, 4, v0
    v_lshl_add_u32 v14, v10, 3, v14
    s_movk_i32 s81, 3072
    v_mad_u32_u24 v10, v14, s81, v9
    v_mfma_f32_16x16x32_bf16 v[72:75], v[208:211], v[52:55], v[72:75]
    ds_read_b64_tr_b16 v[44:45], v3 offset:47104
    v_mfma_f32_16x16x32_bf16 v[76:79], v[212:215], v[52:55], v[76:79]
    ds_read_b64_tr_b16 v[46:47], v3 offset:48128
    s_waitcnt lgkmcnt(8)
    v_mfma_f32_16x16x32_bf16 v[80:83], v[208:211], v[56:59], v[80:83]
    s_add_u32 m0, s83, 65536
    s_add_u32 s47, s68, 0
    buffer_load_dwordx4 v10, s[8:11], s47 offen lds
    v_mfma_f32_16x16x32_bf16 v[84:87], v[212:215], v[56:59], v[84:87]
    s_add_u32 m0, s83, 66560
    s_add_u32 s47, s68, 12288
    buffer_load_dwordx4 v10, s[8:11], s47 offen lds
    v_mfma_f32_16x16x32_bf16 v[88:91], v[208:211], v[60:63], v[88:91]
    v_mfma_f32_16x16x32_bf16 v[92:95], v[212:215], v[60:63], v[92:95]
    s_waitcnt lgkmcnt(4)
    v_mfma_f32_16x16x32_bf16 v[64:67], v[216:219], v[32:35], v[64:67]
    s_add_u32 m0, s83, 73728
    s_add_u32 s47, s69, 0
    buffer_load_dwordx4 v10, s[8:11], s47 offen lds
    v_mfma_f32_16x16x32_bf16 v[68:71], v[220:223], v[32:35], v[68:71]
    v_mfma_f32_16x16x32_bf16 v[72:75], v[216:219], v[36:39], v[72:75]
    s_add_u32 m0, s83, 74752
    s_add_u32 s47, s69, 12288
    buffer_load_dwordx4 v10, s[8:11], s47 offen lds
    v_mfma_f32_16x16x32_bf16 v[76:79], v[220:223], v[36:39], v[76:79]
    s_waitcnt vmcnt(9) lgkmcnt(0)
    v_mfma_f32_16x16x32_bf16 v[80:83], v[216:219], v[40:43], v[80:83]
    ds_read_b128 v[224:227], v20 offset:8192
    ds_read_b128 v[228:231], v20 offset:12288
    v_mfma_f32_16x16x32_bf16 v[84:87], v[220:223], v[40:43], v[84:87]
    ds_read_b128 v[232:235], v21 offset:8192
    ds_read_b128 v[236:239], v21 offset:12288
    v_mfma_f32_16x16x32_bf16 v[88:91], v[216:219], v[44:47], v[88:91]
    ds_read_b128 v[240:243], v22 offset:8192
    ds_read_b128 v[244:247], v22 offset:12288
    v_mfma_f32_16x16x32_bf16 v[92:95], v[220:223], v[44:47], v[92:95]
    ds_read_b128 v[248:251], v23 offset:8192
    ds_read_b128 v[252:255], v23 offset:12288
    s_waitcnt vmcnt(5) lgkmcnt(0)
    s_barrier
    ds_read_b64_tr_b16 v[32:33], v26 offset:49152
    ds_read_b64_tr_b16 v[34:35], v26 offset:50176
    ds_read_b64_tr_b16 v[36:37], v26 offset:53248
    ds_read_b64_tr_b16 v[38:39], v26 offset:54272
    ds_read_b64_tr_b16 v[40:41], v26 offset:57344
    ds_read_b64_tr_b16 v[42:43], v26 offset:58368
    ds_read_b64_tr_b16 v[44:45], v26 offset:61440
    ds_read_b64_tr_b16 v[46:47], v26 offset:62464
    ds_read_b64_tr_b16 v[48:49], v2 offset:49152
    ds_read_b64_tr_b16 v[50:51], v2 offset:50176
    ds_read_b64_tr_b16 v[52:53], v3 offset:49152
    ds_read_b64_tr_b16 v[54:55], v3 offset:50176
    s_waitcnt lgkmcnt(8)
    v_mfma_f32_16x16x32_bf16 a[252:255], a[248:251], v[32:35], a[252:255]
    ds_read_b64_tr_b16 v[56:57], v2 offset:51200
    ds_read_b64_tr_b16 v[58:59], v2 offset:52224
    v_mfma_f32_16x16x32_bf16 a[252:255], a[248:251], v[36:39], a[252:255]
    ds_read_b64_tr_b16 v[60:61], v3 offset:51200
    ds_read_b64_tr_b16 v[62:63], v3 offset:52224
    s_waitcnt lgkmcnt(8)
    v_mfma_f32_16x16x32_bf16 a[252:255], a[248:251], v[40:43], a[252:255]
    ds_read_b64_tr_b16 v[32:33], v2 offset:53248
    ds_read_b64_tr_b16 v[34:35], v2 offset:54272
    v_mfma_f32_16x16x32_bf16 a[252:255], a[248:251], v[44:47], a[252:255]
    ds_read_b64_tr_b16 v[36:37], v3 offset:53248
    ds_read_b64_tr_b16 v[38:39], v3 offset:54272
    s_waitcnt vmcnt(4)
L_s0_7:
    v_cmp_ne_u32 vcc, s35, v118
    s_cbranch_vccz L_s0ok_8
    buffer_load_dwordx4 v[116:119], v12, s[28:31], s46 offen sc1
    s_waitcnt vmcnt(0)
    s_sub_u32 s38, s38, 1
    s_cbranch_scc0 L_s0_7
    s_mov_b32 s38, 0
L_s0ok_8:
    v_cmp_ne_u32 vcc, s76, v119
    s_nop 4
    s_or_b32 s36, vcc_lo, 0
    s_waitcnt lgkmcnt(8)
    v_mfma_f32_16x16x32_bf16 v[64:67], v[224:227], v[48:51], v[64:67]
    ds_read_b64_tr_b16 v[40:41], v2 offset:55296
    v_accvgpr_read_b32 v12, a230
    s_add_u32 m0, s83, 81920
    s_add_u32 s47, s70, 0
    buffer_load_dwordx4 v10, s[8:11], s47 offen lds
    v_mfma_f32_16x16x32_bf16 v[68:71], v[228:231], v[48:51], v[68:71]
    ds_read_b64_tr_b16 v[42:43], v2 offset:56320
    v_and_b32 v13, 16, v0
    v_mfma_f32_16x16x32_bf16 v[72:75], v[224:227], v[52:55], v[72:75]
    ds_read_b64_tr_b16 v[44:45], v3 offset:55296
    v_lshl_add_u32 v13, v13, 2, v12
    v_mfma_f32_16x16x32_bf16 v[76:79], v[228:231], v[52:55], v[76:79]
    ds_read_b64_tr_b16 v[46:47], v3 offset:56320
    ds_write2_b32 v13, v116, v117 offset0:0 offset1:32
L_pad1:
    s_cbranch_execz L_pad5
    s_waitcnt lgkmcnt(9)
    v_mfma_f32_16x16x32_bf16 v[80:83], v[224:227], v[56:59], v[80:83]
    ds_read_b64_tr_b16 v[48:49], v2 offset:57344
    ds_read2_b32 v[124:125], v12 offset0:0 offset1:16
    v_mfma_f32_16x16x32_bf16 v[84:87], v[228:231], v[56:59], v[84:87]
    ds_read_b64_tr_b16 v[50:51], v2 offset:58368
    ds_read2_b32 v[126:127], v12 offset0:32 offset1:48
    s_add_u32 m0, s83, 82944
    s_add_u32 s47, s70, 12288
    buffer_load_dwordx4 v10, s[8:11], s47 offen lds
    v_mfma_f32_16x16x32_bf16 v[88:91], v[224:227], v[60:63], v[88:91]
    ds_read_b64_tr_b16 v[52:53], v3 offset:57344
    v_mfma_f32_16x16x32_bf16 v[92:95], v[228:231], v[60:63], v[92:95]
    ds_read_b64_tr_b16 v[54:55], v3 offset:58368
    v_accvgpr_read_b32 v12, a224
    s_lshl_b32 s47, s32, 6
    v_add_u32 v12, s47, v12
    ds_write_b32 v12, a252 offset:0
    s_waitcnt lgkmcnt(12)
    v_mfma_f32_16x16x32_bf16 v[64:67], v[232:235], v[32:35], v[64:67]
    ds_read_b64_tr_b16 v[56:57], v2 offset:59392
    v_accvgpr_read_b32 v13, a231
    v_mfma_f32_16x16x32_bf16 v[68:71], v[236:239], v[32:35], v[68:71]
    ds_read_b64_tr_b16 v[58:59], v2 offset:60416
    ds_read_b128 v[96:99], v13 offset:0
    v_mfma_f32_16x16x32_bf16 v[72:75], v[232:235], v[36:39], v[72:75]
    ds_read_b64_tr_b16 v[60:61], v3 offset:59392
    s_add_u32 m0, s83, 90112
    s_add_u32 s47, s71, 0
    buffer_load_dwordx4 v10, s[8:11], s47 offen lds
    v_mfma_f32_16x16x32_bf16 v[76:79], v[236:239], v[36:39], v[76:79]
    ds_read_b64_tr_b16 v[62:63], v3 offset:60416
    ds_read_b128 v[104:107], v13 offset:128
    s_waitcnt lgkmcnt(14)
    v_mfma_f32_16x16x32_bf16 v[80:83], v[232:235], v[40:43], v[80:83]
    ds_read_b64_tr_b16 v[32:33], v2 offset:61440
    ds_read_b128 v[100:103], v13 offset:64
    v_mfma_f32_16x16x32_bf16 v[84:87], v[236:239], v[40:43], v[84:87]
    ds_read_b64_tr_b16 v[34:35], v2 offset:62464
    ds_read_b128 v[108:111], v13 offset:192
    v_mfma_f32_16x16x32_bf16 v[88:91], v[232:235], v[44:47], v[88:91]
    ds_read_b64_tr_b16 v[36:37], v3 offset:61440
    v_bfe_u32 v18, v0, 4, 1
    v_lshlrev_b32 v18, 10, v18
    v_lshrrev_b32 v19, 5, v0
    v_mul_u32_u24 v19, 0x120, v19
    v_add_u32 v18, v18, v19
    v_and_b32 v19, 0xd8, v2
    s_lshl_b32 s47, s32, 12
    s_add_u32 s47, s47, 0
    v_add3_u32 v18, v18, v19, s47
    v_xor_b32 v19, 32, v18
    v_mfma_f32_16x16x32_bf16 v[92:95], v[236:239], v[44:47], v[92:95]
    ds_read_b64_tr_b16 v[38:39], v3 offset:62464
    s_add_u32 m0, s83, 91136
    s_add_u32 s47, s71, 12288
    buffer_load_dwordx4 v10, s[8:11], s47 offen lds
    s_waitcnt lgkmcnt(13)
    v_mfma_f32_16x16x32_bf16 v[64:67], v[240:243], v[48:51], v[64:67]
    ds_read_b64_tr_b16 v[40:41], v2 offset:63488
    v_mfma_f32_16x16x32_bf16 v[68:71], v[244:247], v[48:51], v[68:71]
    ds_read_b64_tr_b16 v[42:43], v2 offset:64512
    v_mfma_f32_16x16x32_bf16 v[72:75], v[240:243], v[52:55], v[72:75]
    ds_read_b64_tr_b16 v[44:45], v3 offset:63488
    v_mfma_f32_16x16x32_bf16 v[76:79], v[244:247], v[52:55], v[76:79]
    ds_read_b64_tr_b16 v[46:47], v3 offset:64512
    s_waitcnt lgkmcnt(11)
    v_mfma_f32_16x16x32_bf16 v[80:83], v[240:243], v[56:59], v[80:83]
    v_and_b32 v16, 1, v0
    v_lshlrev_b32 v16, 7, v16
    v_lshrrev_b32 v17, 1, v0
    v_and_b32 v17, 1, v17
    s_lshl2_add_u32 s47, s33, s32
    s_lshl_b32 s47, s47, 1
    v_add3_u32 v16, v16, v17, s47
    s_mov_b32 exec_lo, 0
    v_and_b32 v16, 0xbf, v16
    s_mov_b32 exec_lo, -1
    v_min_u32 v17, 29, v0
    s_mul_i32 s47, s32, 56
    s_lshr_b32 s86, s75, 1
    s_add_u32 s47, s47, s86
    s_sub_u32 s47, s47, 64
    v_lshl_add_u32 v17, v17, 2, s47
    s_mov_b32 vcc_lo, 0xffff
    s_mov_b32 vcc_hi, -1
    s_mov_b32 s86, 65536
    v_cndmask_b32 v16, v17, v16, vcc
    v_lshlrev_b32 v16, 7, v16
    buffer_load_dword v17, v16, s[28:31], s86 offen sc1
    v_mfma_f32_16x16x32_bf16 v[84:87], v[244:247], v[56:59], v[84:87]
    s_waitcnt lgkmcnt(6)
    v_mul_f32 v112, 0x3fb8aa3b, v104
    v_mfma_f32_16x16x32_bf16 v[88:91], v[240:243], v[60:63], v[88:91]
    v_mul_f32 v113, 0x3fb8aa3b, v105
    v_mfma_f32_16x16x32_bf16 v[92:95], v[244:247], v[60:63], v[92:95]
    v_mul_f32 v114, 0x3fb8aa3b, v106
    s_waitcnt lgkmcnt(4)
    v_mfma_f32_16x16x32_bf16 v[64:67], v[248:251], v[32:35], v[64:67]
    v_mul_f32 v115, 0x3fb8aa3b, v107
    v_mfma_f32_16x16x32_bf16 v[68:71], v[252:255], v[32:35], v[68:71]
    v_mul_f32 v116, 0x3fb8aa3b, v108
    v_mfma_f32_16x16x32_bf16 v[72:75], v[248:251], v[36:39], v[72:75]
    v_mul_f32 v117, 0x3fb8aa3b, v109
    v_mfma_f32_16x16x32_bf16 v[76:79], v[252:255], v[36:39], v[76:79]
    v_mul_f32 v118, 0x3fb8aa3b, v110
    s_waitcnt lgkmcnt(0)
    v_mfma_f32_16x16x32_bf16 v[80:83], v[248:251], v[40:43], v[80:83]
    v_mul_f32 v119, 0x3fb8aa3b, v111
    v_mfma_f32_16x16x32_bf16 v[84:87], v[252:255], v[40:43], v[84:87]
    v_mul_f32 v120, 0x3fb8aa3b, v126
    v_mfma_f32_16x16x32_bf16 v[88:91], v[248:251], v[44:47], v[88:91]
    v_mul_f32 v121, 0x3fb8aa3b, v127
    v_mfma_f32_16x16x32_bf16 v[92:95], v[252:255], v[44:47], v[92:95]
    s_barrier
    v_accvgpr_read_b32 v24, a224
    ds_read2_b32 v[12:13], v24 offset0:0 offset1:16
    ds_read2_b32 v[14:15], v24 offset0:32 offset1:48
    s_nop 2
    v_accvgpr_read_b32 v54, a234
    v_accvgpr_read_b32 v55, a235
    s_waitcnt lgkmcnt(0)
    s_lshl2_add_u32 s81, s33, s32
    v_lshlrev_b32 v52, 7, v0
    s_lshr_b32 s47, s81, 3
    s_mul_i32 s47, s47, 57344
    s_and_b32 s81, s81, 7
    s_mul_i32 s81, s81, 3072
    s_add_u32 s47, s47, s81
    s_add_u32 s47, s47, s37
    s_add_u32 s47, s47, 163840
    s_mov_b32 exec_lo, 16777215
    s_mov_b32 exec_hi, 0
    buffer_load_dword a227, v52, s[28:31], s47 offen sc1
    s_mov_b64 exec, -1
    v_pk_fma_f32 v[64:65], v[96:97], v[12:13], v[64:65] op_sel:[0,0,0] op_sel_hi:[1,0,1]
    v_pk_fma_f32 v[66:67], v[98:99], v[12:13], v[66:67] op_sel:[0,0,0] op_sel_hi:[1,0,1]
    v_pk_mul_f32 v[56:57], v[64:65], v[112:113]
    ds_read_b64_tr_b16 a[160:161], v18 offset:0
    v_pk_mul_f32 v[58:59], v[66:67], v[114:115]
    v_exp_f32 v56, v56 clamp
    v_exp_f32 v57, v57 clamp
    ds_read_b64_tr_b16 a[162:163], v18 offset:512
    v_exp_f32 v58, v58 clamp
    v_exp_f32 v59, v59 clamp
    v_max_f32 v64, 0, v64
    ds_read_b64_tr_b16 a[164:165], v19 offset:0
    v_max_f32 v65, 0, v65
    v_max_f32 v66, 0, v66
    v_max_f32 v67, 0, v67
    ds_read_b64_tr_b16 a[166:167], v19 offset:512
    v_pk_fma_f32 v[64:65], v[64:65], v[104:105], v[56:57]
    v_pk_fma_f32 v[66:67], v[66:67], v[106:107], v[58:59]
    v_pk_add_f32 v[64:65], v[64:65], s[40:41]
    ds_read_b64_tr_b16 a[168:169], v18 offset:2048
    v_pk_add_f32 v[66:67], v[66:67], s[40:41]
    v_cvt_pk_bf16_f32 v24, v64, v65
    v_cvt_pk_bf16_f32 v25, v66, v67
    ds_read_b64_tr_b16 a[170:171], v18 offset:2560
    v_pk_fma_f32 v[68:69], v[100:101], v[12:13], v[68:69] op_sel:[0,0,0] op_sel_hi:[1,0,1]
    v_pk_fma_f32 v[70:71], v[102:103], v[12:13], v[70:71] op_sel:[0,0,0] op_sel_hi:[1,0,1]
    v_pk_mul_f32 v[56:57], v[68:69], v[116:117]
    ds_read_b64_tr_b16 a[172:173], v19 offset:2048
    v_pk_mul_f32 v[58:59], v[70:71], v[118:119]
    v_exp_f32 v56, v56 clamp
    v_exp_f32 v57, v57 clamp
    ds_read_b64_tr_b16 a[174:175], v19 offset:2560
    v_exp_f32 v58, v58 clamp
    v_exp_f32 v59, v59 clamp
    v_max_f32 v68, 0, v68
    ds_read_b64_tr_b16 a[176:177], v18 offset:16384
    v_max_f32 v69, 0, v69
    v_max_f32 v70, 0, v70
    v_max_f32 v71, 0, v71
    ds_read_b64_tr_b16 a[178:179], v18 offset:16896
    s_waitcnt vmcnt(1)
L_pc_9:
    v_cmp_ne_u32 vcc, s35, v17
    s_cbranch_vccz L_pcok_10
    s_mov_b64 exec, vcc
    buffer_load_dword v17, v16, s[28:31], s86 offen sc1
    s_mov_b64 exec, -1
    s_waitcnt vmcnt(0)
    s_sub_u32 s38, s38, 1
    s_cbranch_scc0 L_pc_9
    s_mov_b32 s38, 0
L_pcok_10:
    v_pk_fma_f32 v[68:69], v[68:69], v[108:109], v[56:57]
    v_pk_fma_f32 v[70:71], v[70:71], v[110:111], v[58:59]
    v_pk_add_f32 v[68:69], v[68:69], s[40:41]
    ds_read_b64_tr_b16 a[180:181], v19 offset:16384
    v_pk_add_f32 v[70:71], v[70:71], s[40:41]
    v_cvt_pk_bf16_f32 v26, v68, v69
    v_cvt_pk_bf16_f32 v27, v70, v71
    ds_read_b64_tr_b16 a[182:183], v19 offset:16896
    v_pk_fma_f32 v[72:73], v[96:97], v[12:13], v[72:73] op_sel:[0,1,0] op_sel_hi:[1,1,1]
    v_pk_fma_f32 v[74:75], v[98:99], v[12:13], v[74:75] op_sel:[0,1,0] op_sel_hi:[1,1,1]
    v_pk_mul_f32 v[56:57], v[72:73], v[112:113]
    s_lshl2_add_u32 s86, s75, s32
    s_mul_i32 s86, s86, 57344
    s_add_u32 s86, s86, 20971520
    s_add_u32 s87, s86, 0
    buffer_load_dwordx4 a[0:3], v1, s[28:31], s87 offen offset:0 sc1
    ds_read_b64_tr_b16 a[184:185], v18 offset:18432
    v_pk_mul_f32 v[58:59], v[74:75], v[114:115]
    v_exp_f32 v56, v56 clamp
    v_exp_f32 v57, v57 clamp
    ds_read_b64_tr_b16 a[186:187], v18 offset:18944
    v_exp_f32 v58, v58 clamp
    v_exp_f32 v59, v59 clamp
    v_max_f32 v72, 0, v72
    ds_read_b64_tr_b16 a[188:189], v19 offset:18432
    v_max_f32 v73, 0, v73
    v_max_f32 v74, 0, v74
    buffer_load_dwordx4 a[4:7], v1, s[28:31], s87 offen offset:1024 sc1
    v_max_f32 v75, 0, v75
    ds_read_b64_tr_b16 a[190:191], v19 offset:18944
    v_pk_fma_f32 v[72:73], v[72:73], v[104:105], v[56:57]
    v_pk_fma_f32 v[74:75], v[74:75], v[106:107], v[58:59]
    v_pk_add_f32 v[72:73], v[72:73], s[40:41]
    ds_read_b64_tr_b16 a[128:129], v18 offset:32768
    v_pk_add_f32 v[74:75], v[74:75], s[40:41]
    v_cvt_pk_bf16_f32 v28, v72, v73
    v_cvt_pk_bf16_f32 v29, v74, v75
    ds_read_b64_tr_b16 a[130:131], v18 offset:33280
    v_pk_fma_f32 v[76:77], v[100:101], v[12:13], v[76:77] op_sel:[0,1,0] op_sel_hi:[1,1,1]
    buffer_load_dwordx4 a[8:11], v1, s[28:31], s87 offen offset:2048 sc1
    v_pk_fma_f32 v[78:79], v[102:103], v[12:13], v[78:79] op_sel:[0,1,0] op_sel_hi:[1,1,1]
    v_pk_mul_f32 v[56:57], v[76:77], v[116:117]
    ds_read_b64_tr_b16 a[132:133], v19 offset:32768
    v_pk_mul_f32 v[58:59], v[78:79], v[118:119]
    v_exp_f32 v56, v56 clamp
    v_exp_f32 v57, v57 clamp
    ds_read_b64_tr_b16 a[134:135], v19 offset:33280
    v_exp_f32 v58, v58 clamp
    v_exp_f32 v59, v59 clamp
    v_max_f32 v76, 0, v76
    ds_read_b64_tr_b16 a[136:137], v18 offset:34816
    buffer_load_dwordx4 a[12:15], v1, s[28:31], s87 offen offset:3072 sc1
    v_max_f32 v77, 0, v77
    v_max_f32 v78, 0, v78
    v_max_f32 v79, 0, v79
    ds_read_b64_tr_b16 a[138:139], v18 offset:35328
    v_pk_fma_f32 v[76:77], v[76:77], v[108:109], v[56:57]
    v_pk_fma_f32 v[78:79], v[78:79], v[110:111], v[58:59]
    v_pk_add_f32 v[76:77], v[76:77], s[40:41]
    ds_read_b64_tr_b16 a[140:141], v19 offset:34816
    v_pk_add_f32 v[78:79], v[78:79], s[40:41]
    v_cvt_pk_bf16_f32 v30, v76, v77
    v_cvt_pk_bf16_f32 v31, v78, v79
    s_add_u32 s87, s86, 4096
    buffer_load_dwordx4 a[16:19], v1, s[28:31], s87 offen offset:0 sc1
    ds_read_b64_tr_b16 a[142:143], v19 offset:35328
    v_pk_fma_f32 v[80:81], v[96:97], v[14:15], v[80:81] op_sel:[0,0,0] op_sel_hi:[1,0,1]
    v_pk_fma_f32 v[82:83], v[98:99], v[14:15], v[82:83] op_sel:[0,0,0] op_sel_hi:[1,0,1]
    v_pk_mul_f32 v[80:81], v[80:81], v[104:105]
    ds_read_b64_tr_b16 a[144:145], v18 offset:49152
    v_pk_mul_f32 v[82:83], v[82:83], v[106:107]
    v_cvt_pk_bf16_f32 v64, v80, v81
    v_cvt_pk_bf16_f32 v65, v82, v83
    ds_read_b64_tr_b16 a[146:147], v18 offset:49664
    v_mfma_f32_16x16x32_bf16 v[72:75], v[24:27], a[248:251], 0
    v_pk_fma_f32 v[84:85], v[100:101], v[14:15], v[84:85] op_sel:[0,0,0] op_sel_hi:[1,0,1]
    buffer_load_dwordx4 a[20:23], v1, s[28:31], s87 offen offset:1024 sc1
    v_pk_fma_f32 v[86:87], v[102:103], v[14:15], v[86:87] op_sel:[0,0,0] op_sel_hi:[1,0,1]
    ds_read_b64_tr_b16 a[148:149], v19 offset:49152
    v_pk_mul_f32 v[84:85], v[84:85], v[108:109]
    v_pk_mul_f32 v[86:87], v[86:87], v[110:111]
    v_cvt_pk_bf16_f32 v66, v84, v85
    ds_read_b64_tr_b16 a[150:151], v19 offset:49664
    v_cvt_pk_bf16_f32 v67, v86, v87
    v_pk_fma_f32 v[88:89], v[96:97], v[14:15], v[88:89] op_sel:[0,1,0] op_sel_hi:[1,1,1]
    v_pk_fma_f32 v[90:91], v[98:99], v[14:15], v[90:91] op_sel:[0,1,0] op_sel_hi:[1,1,1]
    ds_read_b64_tr_b16 a[152:153], v18 offset:51200
    v_pk_mul_f32 v[88:89], v[88:89], v[104:105]
    buffer_load_dwordx4 a[24:27], v1, s[28:31], s87 offen offset:2048 sc1
    v_pk_mul_f32 v[90:91], v[90:91], v[106:107]
    v_cvt_pk_bf16_f32 v68, v88, v89
    ds_read_b64_tr_b16 a[154:155], v18 offset:51712
    v_cvt_pk_bf16_f32 v69, v90, v91
    v_mfma_f32_16x16x32_bf16 v[76:79], v[28:31], a[248:251], 0
    v_pk_fma_f32 v[92:93], v[100:101], v[14:15], v[92:93] op_sel:[0,1,0] op_sel_hi:[1,1,1]
    ds_read_b64_tr_b16 a[156:157], v19 offset:51200
    v_pk_fma_f32 v[94:95], v[102:103], v[14:15], v[94:95] op_sel:[0,1,0] op_sel_hi:[1,1,1]
    v_pk_mul_f32 v[92:93], v[92:93], v[108:109]
    v_pk_mul_f32 v[94:95], v[94:95], v[110:111]
    ds_read_b64_tr_b16 a[158:159], v19 offset:51712
    buffer_load_dwordx4 a[28:31], v1, s[28:31], s87 offen offset:3072 sc1
    v_cvt_pk_bf16_f32 v70, v92, v93
    v_cvt_pk_bf16_f32 v71, v94, v95
    ds_write_b128 v54, v[72:75] offset:32768
    v_mfma_f32_16x16x32_bf16 v[80:83], v[24:27], v[64:67], 0
    v_mfma_f32_16x16x32_bf16 v[84:87], v[28:31], v[68:71], 0
L_pad2:
    s_cbranch_execz L_pad6
    ds_write_b128 v54, v[76:79] offset:49152
    v_accvgpr_read_b32 v53, a236
    s_nop 4
    ds_write_b128 v54, v[80:83] offset:0
    ds_write_b128 v54, v[84:87] offset:16384
    s_waitcnt lgkmcnt(0)
    s_barrier
    ds_read_b128 v[32:35], v55 offset:0
    ds_read_b128 v[36:39], v55 offset:1024
    ds_read_b128 v[40:43], v55 offset:2048
    ds_read_b128 v[44:47], v55 offset:3072
    s_waitcnt lgkmcnt(2)
    v_pk_add_f32 v[32:33], v[32:33], v[36:37]
    v_pk_add_f32 v[34:35], v[34:35], v[38:39]
    s_waitcnt lgkmcnt(0)
    v_pk_add_f32 v[40:41], v[40:41], v[44:45]
    v_pk_add_f32 v[42:43], v[42:43], v[46:47]
    v_pk_add_f32 v[96:97], v[32:33], v[40:41]
    v_pk_add_f32 v[98:99], v[34:35], v[42:43]
    v_and_b32 v96, 0xffffff00, v96
    v_or_b32 v96, s77, v96
    s_mov_b64 exec, s[96:97]
    buffer_store_dwordx4 v[96:99], v53, s[28:31], s73 offen sc1
    s_mov_b64 exec, -1
    v_bfe_u32 v28, v0, 4, 1
    v_lshlrev_b32 v28, 10, v28
    v_lshrrev_b32 v29, 5, v0
    v_mul_u32_u24 v29, 0x120, v29
    v_add_u32 v28, v28, v29
    v_and_b32 v29, 0xd8, v2
    s_lshl_b32 s47, s32, 11
    s_add_u32 s47, s47, 65536
    v_add3_u32 v28, v28, v29, s47
    v_xor_b32 v29, 32, v28
    v_add_u32 v24, 65536, v2
    v_add_u32 v25, 65536, v3
    s_and_b32 s42, s32, 1
    s_lshl_b32 s43, s42, 5
    v_xor_b32 v26, s43, v24
    ds_read_b64_tr_b16 v[32:33], v26 offset:0
    ds_read_b64_tr_b16 v[34:35], v26 offset:1024
    ds_read_b64_tr_b16 v[36:37], v26 offset:2048
    ds_read_b64_tr_b16 v[38:39], v26 offset:3072
    ds_read_b64_tr_b16 v[40:41], v26 offset:4096
    ds_read_b64_tr_b16 v[42:43], v26 offset:5120
    ds_read_b64_tr_b16 v[44:45], v26 offset:6144
    ds_read_b64_tr_b16 v[46:47], v26 offset:7168
    ds_read_b64_tr_b16 v[48:49], v26 offset:8192
    ds_read_b64_tr_b16 v[50:51], v26 offset:9216
    ds_read_b64_tr_b16 v[52:53], v26 offset:10240
    ds_read_b64_tr_b16 v[54:55], v26 offset:11264
    s_waitcnt lgkmcnt(8)
    v_mfma_f32_16x16x32_bf16 a[252:255], a[248:251], v[32:35], 0
    ds_read_b64_tr_b16 v[56:57], v26 offset:12288
    ds_read_b64_tr_b16 v[58:59], v26 offset:13312
    v_mfma_f32_16x16x32_bf16 a[252:255], a[248:251], v[36:39], a[252:255]
    ds_read_b64_tr_b16 v[60:61], v26 offset:14336
    ds_read_b64_tr_b16 v[62:63], v26 offset:15360
    s_waitcnt lgkmcnt(8)
    v_mfma_f32_16x16x32_bf16 a[252:255], a[248:251], v[40:43], a[252:255]
    ds_read_b64_tr_b16 v[32:33], v26 offset:16384
    ds_read_b64_tr_b16 v[34:35], v26 offset:17408
    v_mfma_f32_16x16x32_bf16 a[252:255], a[248:251], v[44:47], a[252:255]
    ds_read_b64_tr_b16 v[36:37], v26 offset:18432
    ds_read_b64_tr_b16 v[38:39], v26 offset:19456
    v_accvgpr_read_b32 v12, a245
    s_waitcnt lgkmcnt(8)
    v_mfma_f32_16x16x32_bf16 a[252:255], a[248:251], v[48:51], a[252:255]
    ds_read_b64_tr_b16 v[40:41], v26 offset:20480
    ds_read_b64_tr_b16 v[42:43], v26 offset:21504
    buffer_load_dwordx4 v[16:19], v12, s[4:7], 0 offen offset:0
    v_mfma_f32_16x16x32_bf16 a[252:255], a[248:251], v[52:55], a[252:255]
    ds_read_b64_tr_b16 v[44:45], v26 offset:22528
    ds_read_b64_tr_b16 v[46:47], v26 offset:23552
    buffer_load_dwordx4 v[20:23], v12, s[4:7], 0 offen offset:64
    s_waitcnt lgkmcnt(8)
    v_mfma_f32_16x16x32_bf16 a[252:255], a[248:251], v[56:59], a[252:255]
    ds_read_b64_tr_b16 v[48:49], v26 offset:24576
    ds_read_b64_tr_b16 v[50:51], v26 offset:25600
    s_mul_i32 s82, s32, 16384
    s_add_u32 s78, s82, s84
    s_mul_i32 s79, s74, 2228224
    s_sub_u32 s78, s78, s79
    s_add_u32 m0, s82, 0
    s_add_u32 s79, s78, 212992
    buffer_load_dwordx4 v1, s[28:31], s79 offen offset:0 sc1 lds
    v_mfma_f32_16x16x32_bf16 a[252:255], a[248:251], v[60:63], a[252:255]
    ds_read_b64_tr_b16 v[52:53], v26 offset:26624
    ds_read_b64_tr_b16 v[54:55], v26 offset:27648
    s_waitcnt lgkmcnt(8)
    v_mfma_f32_16x16x32_bf16 a[252:255], a[248:251], v[32:35], a[252:255]
    ds_read_b64_tr_b16 v[56:57], v26 offset:28672
    ds_read_b64_tr_b16 v[58:59], v26 offset:29696
    buffer_load_dwordx4 v1, s[28:31], s79 offen offset:1024 sc1 lds
    v_mfma_f32_16x16x32_bf16 a[252:255], a[248:251], v[36:39], a[252:255]
    ds_read_b64_tr_b16 v[60:61], v26 offset:30720
    ds_read_b64_tr_b16 v[62:63], v26 offset:31744
    s_waitcnt lgkmcnt(8)
    v_mfma_f32_16x16x32_bf16 a[252:255], a[248:251], v[40:43], a[252:255]
    ds_read_b64_tr_b16 v[32:33], v24 offset:0
    ds_read_b64_tr_b16 v[34:35], v24 offset:1024
    buffer_load_dwordx4 v1, s[28:31], s79 offen offset:2048 sc1 lds
    v_mfma_f32_16x16x32_bf16 a[252:255], a[248:251], v[44:47], a[252:255]
    ds_read_b64_tr_b16 v[36:37], v25 offset:0
    ds_read_b64_tr_b16 v[38:39], v25 offset:1024
    s_waitcnt lgkmcnt(8)
    v_mfma_f32_16x16x32_bf16 a[252:255], a[248:251], v[48:51], a[252:255]
    ds_read_b64_tr_b16 v[40:41], v24 offset:2048
    ds_read_b64_tr_b16 v[42:43], v24 offset:3072
    buffer_load_dwordx4 v1, s[28:31], s79 offen offset:3072 sc1 lds
    v_mfma_f32_16x16x32_bf16 a[252:255], a[248:251], v[52:55], a[252:255]
    ds_read_b64_tr_b16 v[44:45], v25 offset:2048
    ds_read_b64_tr_b16 v[46:47], v25 offset:3072
    s_waitcnt lgkmcnt(8)
    v_mfma_f32_16x16x32_bf16 a[252:255], a[248:251], v[56:59], a[252:255]
    ds_read_b64_tr_b16 v[48:49], v24 offset:4096
    ds_read_b64_tr_b16 v[50:51], v24 offset:5120
    s_add_u32 m0, s82, 4096
    s_add_u32 s79, s78, 217088
    buffer_load_dwordx4 v1, s[28:31], s79 offen offset:0 sc1 lds
    v_mfma_f32_16x16x32_bf16 a[252:255], a[248:251], v[60:63], a[252:255]
    ds_read_b64_tr_b16 v[52:53], v25 offset:4096
    ds_read_b64_tr_b16 v[54:55], v25 offset:5120
    s_waitcnt lgkmcnt(8)
    v_mfma_f32_16x16x32_bf16 v[64:67], v[32:35], v[128:131], 0
    ds_read_b64_tr_b16 v[56:57], v24 offset:6144
    buffer_load_dwordx4 v1, s[28:31], s79 offen offset:1024 sc1 lds
    v_mfma_f32_16x16x32_bf16 v[68:71], v[32:35], v[132:135], 0
    ds_read_b64_tr_b16 v[58:59], v24 offset:7168
    v_mfma_f32_16x16x32_bf16 v[72:75], v[36:39], v[128:131], 0
    ds_read_b64_tr_b16 v[60:61], v25 offset:6144
    buffer_load_dwordx4 v1, s[28:31], s79 offen offset:2048 sc1 lds
    v_mfma_f32_16x16x32_bf16 v[76:79], v[36:39], v[132:135], 0
    ds_read_b64_tr_b16 v[62:63], v25 offset:7168
    s_waitcnt lgkmcnt(8)
    v_mfma_f32_16x16x32_bf16 v[64:67], v[40:43], v[136:139], v[64:67]
    ds_read_b64_tr_b16 v[32:33], v24 offset:8192
    buffer_load_dwordx4 v1, s[28:31], s79 offen offset:3072 sc1 lds
    v_mfma_f32_16x16x32_bf16 v[68:71], v[40:43], v[140:143], v[68:71]
    ds_read_b64_tr_b16 v[34:35], v24 offset:9216
    v_mfma_f32_16x16x32_bf16 v[72:75], v[44:47], v[136:139], v[72:75]
    ds_read_b64_tr_b16 v[36:37], v25 offset:8192
    s_add_u32 m0, s82, 8192
    s_add_u32 s79, s78, 221184
    buffer_load_dwordx4 v1, s[28:31], s79 offen offset:0 sc1 lds
    v_mfma_f32_16x16x32_bf16 v[76:79], v[44:47], v[140:143], v[76:79]
    ds_read_b64_tr_b16 v[38:39], v25 offset:9216
    ds_read_b64_tr_b16 a[192:193], v28 offset:0
    s_waitcnt lgkmcnt(9)
    v_mfma_f32_16x16x32_bf16 v[64:67], v[48:51], v[144:147], v[64:67]
    ds_read_b64_tr_b16 v[40:41], v24 offset:10240
    buffer_load_dwordx4 v1, s[28:31], s79 offen offset:1024 sc1 lds
    v_mfma_f32_16x16x32_bf16 v[68:71], v[48:51], v[148:151], v[68:71]
    ds_read_b64_tr_b16 v[42:43], v24 offset:11264
    v_mfma_f32_16x16x32_bf16 v[72:75], v[52:55], v[144:147], v[72:75]
    ds_read_b64_tr_b16 v[44:45], v25 offset:10240
    buffer_load_dwordx4 v1, s[28:31], s79 offen offset:2048 sc1 lds
    ds_read_b64_tr_b16 a[194:195], v28 offset:512
    v_mfma_f32_16x16x32_bf16 v[76:79], v[52:55], v[148:151], v[76:79]
    ds_read_b64_tr_b16 v[46:47], v25 offset:11264
    s_waitcnt lgkmcnt(10)
    v_mfma_f32_16x16x32_bf16 v[64:67], v[56:59], v[152:155], v[64:67]
    ds_read_b64_tr_b16 v[48:49], v24 offset:12288
    buffer_load_dwordx4 v1, s[28:31], s79 offen offset:3072 sc1 lds
    v_mfma_f32_16x16x32_bf16 v[68:71], v[56:59], v[156:159], v[68:71]
    ds_read_b64_tr_b16 v[50:51], v24 offset:13312
    ds_read_b64_tr_b16 a[196:197], v29 offset:0
    v_mfma_f32_16x16x32_bf16 v[72:75], v[60:63], v[152:155], v[72:75]
    ds_read_b64_tr_b16 v[52:53], v25 offset:12288
    s_add_u32 m0, s82, 12288
    s_add_u32 s79, s78, 225280
    buffer_load_dwordx4 v1, s[28:31], s79 offen offset:0 sc1 lds
    v_mfma_f32_16x16x32_bf16 v[76:79], v[60:63], v[156:159], v[76:79]
    ds_read_b64_tr_b16 v[54:55], v25 offset:13312
    s_waitcnt lgkmcnt(11)
    v_mfma_f32_16x16x32_bf16 v[64:67], v[32:35], v[160:163], v[64:67]
    ds_read_b64_tr_b16 v[56:57], v24 offset:14336
    buffer_load_dwordx4 v1, s[28:31], s79 offen offset:1024 sc1 lds
    ds_read_b64_tr_b16 a[198:199], v29 offset:512
    v_mfma_f32_16x16x32_bf16 v[68:71], v[32:35], v[164:167], v[68:71]
    ds_read_b64_tr_b16 v[58:59], v24 offset:15360
    v_mfma_f32_16x16x32_bf16 v[72:75], v[36:39], v[160:163], v[72:75]
    ds_read_b64_tr_b16 v[60:61], v25 offset:14336
    buffer_load_dwordx4 v1, s[28:31], s79 offen offset:2048 sc1 lds
    v_mfma_f32_16x16x32_bf16 v[76:79], v[36:39], v[164:167], v[76:79]
    ds_read_b64_tr_b16 v[62:63], v25 offset:15360
    ds_read_b64_tr_b16 a[200:201], v28 offset:8192
    s_waitcnt lgkmcnt(11)
    v_mfma_f32_16x16x32_bf16 v[64:67], v[40:43], v[168:171], v[64:67]
    ds_read_b64_tr_b16 v[32:33], v24 offset:16384
    buffer_load_dwordx4 v1, s[28:31], s79 offen offset:3072 sc1 lds
    v_mfma_f32_16x16x32_bf16 v[68:71], v[40:43], v[172:175], v[68:71]
    ds_read_b64_tr_b16 v[34:35], v24 offset:17408
    v_mfma_f32_16x16x32_bf16 v[72:75], v[44:47], v[168:171], v[72:75]
    ds_read_b64_tr_b16 v[36:37], v25 offset:16384
    s_add_u32 s87, s86, 8192
    buffer_load_dwordx4 a[32:35], v1, s[28:31], s87 offen offset:0 sc1
    ds_read_b64_tr_b16 a[202:203], v28 offset:8704
    v_mfma_f32_16x16x32_bf16 v[76:79], v[44:47], v[172:175], v[76:79]
    ds_read_b64_tr_b16 v[38:39], v25 offset:17408
    s_waitcnt lgkmcnt(11)
    v_mfma_f32_16x16x32_bf16 v[64:67], v[48:51], v[176:179], v[64:67]
    ds_read_b64_tr_b16 v[40:41], v24 offset:18432
    ds_read_b64_tr_b16 a[204:205], v29 offset:8192
    v_mfma_f32_16x16x32_bf16 v[68:71], v[48:51], v[180:183], v[68:71]
    ds_read_b64_tr_b16 v[42:43], v24 offset:19456
    v_mfma_f32_16x16x32_bf16 v[72:75], v[52:55], v[176:179], v[72:75]
    ds_read_b64_tr_b16 v[44:45], v25 offset:18432
    buffer_load_dwordx4 a[36:39], v1, s[28:31], s87 offen offset:1024 sc1
    v_mfma_f32_16x16x32_bf16 v[76:79], v[52:55], v[180:183], v[76:79]
    ds_read_b64_tr_b16 v[46:47], v25 offset:19456
    s_waitcnt lgkmcnt(11)
    v_mfma_f32_16x16x32_bf16 v[64:67], v[56:59], v[184:187], v[64:67]
    ds_read_b64_tr_b16 v[48:49], v24 offset:20480
    ds_read_b64_tr_b16 a[206:207], v29 offset:8704
    v_mfma_f32_16x16x32_bf16 v[68:71], v[56:59], v[188:191], v[68:71]
    ds_read_b64_tr_b16 v[50:51], v24 offset:21504
    v_mfma_f32_16x16x32_bf16 v[72:75], v[60:63], v[184:187], v[72:75]
    ds_read_b64_tr_b16 v[52:53], v25 offset:20480
    buffer_load_dwordx4 a[40:43], v1, s[28:31], s87 offen offset:2048 sc1
    v_mfma_f32_16x16x32_bf16 v[76:79], v[60:63], v[188:191], v[76:79]
    ds_read_b64_tr_b16 v[54:55], v25 offset:21504
    ds_read_b64_tr_b16 a[208:209], v28 offset:16384
    s_waitcnt lgkmcnt(11)
    v_mfma_f32_16x16x32_bf16 v[64:67], v[32:35], v[192:195], v[64:67]
    ds_read_b64_tr_b16 v[56:57], v24 offset:22528
    v_mfma_f32_16x16x32_bf16 v[68:71], v[32:35], v[196:199], v[68:71]
    ds_read_b64_tr_b16 v[58:59], v24 offset:23552
    v_mfma_f32_16x16x32_bf16 v[72:75], v[36:39], v[192:195], v[72:75]
    ds_read_b64_tr_b16 v[60:61], v25 offset:22528
    buffer_load_dwordx4 a[44:47], v1, s[28:31], s87 offen offset:3072 sc1
    ds_read_b64_tr_b16 a[210:211], v28 offset:16896
    v_mfma_f32_16x16x32_bf16 v[76:79], v[36:39], v[196:199], v[76:79]
    ds_read_b64_tr_b16 v[62:63], v25 offset:23552
    s_waitcnt lgkmcnt(11)
    v_mfma_f32_16x16x32_bf16 v[64:67], v[40:43], v[200:203], v[64:67]
    ds_read_b64_tr_b16 v[32:33], v24 offset:24576
    ds_read_b64_tr_b16 a[212:213], v29 offset:16384
    v_mfma_f32_16x16x32_bf16 v[68:71], v[40:43], v[204:207], v[68:71]
    ds_read_b64_tr_b16 v[34:35], v24 offset:25600
    v_mfma_f32_16x16x32_bf16 v[72:75], v[44:47], v[200:203], v[72:75]
    ds_read_b64_tr_b16 v[36:37], v25 offset:24576
    s_add_u32 s87, s86, 12288
    buffer_load_dwordx4 a[48:51], v1, s[28:31], s87 offen offset:0 sc1
    v_mfma_f32_16x16x32_bf16 v[76:79], v[44:47], v[204:207], v[76:79]
    ds_read_b64_tr_b16 v[38:39], v25 offset:25600
    s_waitcnt lgkmcnt(11)
    v_mfma_f32_16x16x32_bf16 v[64:67], v[48:51], v[208:211], v[64:67]
    ds_read_b64_tr_b16 v[40:41], v24 offset:26624
    ds_read_b64_tr_b16 a[214:215], v29 offset:16896
    v_mfma_f32_16x16x32_bf16 v[68:71], v[48:51], v[212:215], v[68:71]
    ds_read_b64_tr_b16 v[42:43], v24 offset:27648
    v_mfma_f32_16x16x32_bf16 v[72:75], v[52:55], v[208:211], v[72:75]
    ds_read_b64_tr_b16 v[44:45], v25 offset:26624
    buffer_load_dwordx4 a[52:55], v1, s[28:31], s87 offen offset:1024 sc1
    v_mfma_f32_16x16x32_bf16 v[76:79], v[52:55], v[212:215], v[76:79]
    ds_read_b64_tr_b16 v[46:47], v25 offset:27648
    ds_read_b64_tr_b16 a[216:217], v28 offset:24576
    s_waitcnt lgkmcnt(11)
    v_mfma_f32_16x16x32_bf16 v[64:67], v[56:59], v[216:219], v[64:67]
    ds_read_b64_tr_b16 v[48:49], v24 offset:28672
    v_mfma_f32_16x16x32_bf16 v[68:71], v[56:59], v[220:223], v[68:71]
    ds_read_b64_tr_b16 v[50:51], v24 offset:29696
    v_mfma_f32_16x16x32_bf16 v[72:75], v[60:63], v[216:219], v[72:75]
    ds_read_b64_tr_b16 v[52:53], v25 offset:28672
    buffer_load_dwordx4 a[56:59], v1, s[28:31], s87 offen offset:2048 sc1
    ds_read_b64_tr_b16 a[218:219], v28 offset:25088
    v_mfma_f32_16x16x32_bf16 v[76:79], v[60:63], v[220:223], v[76:79]
    ds_read_b64_tr_b16 v[54:55], v25 offset:29696
    s_waitcnt lgkmcnt(11)
    v_mfma_f32_16x16x32_bf16 v[64:67], v[32:35], v[224:227], v[64:67]
    ds_read_b64_tr_b16 v[56:57], v24 offset:30720
    ds_read_b64_tr_b16 a[220:221], v29 offset:24576
    v_mfma_f32_16x16x32_bf16 v[68:71], v[32:35], v[228:231], v[68:71]
    ds_read_b64_tr_b16 v[58:59], v24 offset:31744
L_pad3:
    s_cbranch_execz L_pad7
    v_mfma_f32_16x16x32_bf16 v[72:75], v[36:39], v[224:227], v[72:75]
    ds_read_b64_tr_b16 v[60:61], v25 offset:30720
    buffer_load_dwordx4 a[60:63], v1, s[28:31], s87 offen offset:3072 sc1
    v_mfma_f32_16x16x32_bf16 v[76:79], v[36:39], v[228:231], v[76:79]
    ds_read_b64_tr_b16 v[62:63], v25 offset:31744
    s_waitcnt lgkmcnt(11)
    v_mfma_f32_16x16x32_bf16 v[64:67], v[40:43], v[232:235], v[64:67]
    ds_read_b64_tr_b16 a[222:223], v29 offset:25088
    v_mfma_f32_16x16x32_bf16 v[68:71], v[40:43], v[236:239], v[68:71]
    v_mfma_f32_16x16x32_bf16 v[72:75], v[44:47], v[232:235], v[72:75]
    v_mfma_f32_16x16x32_bf16 v[76:79], v[44:47], v[236:239], v[76:79]
    s_waitcnt lgkmcnt(6)
    v_mfma_f32_16x16x32_bf16 v[64:67], v[48:51], v[240:243], v[64:67]
    v_mfma_f32_16x16x32_bf16 v[68:71], v[48:51], v[244:247], v[68:71]
    v_mfma_f32_16x16x32_bf16 v[72:75], v[52:55], v[240:243], v[72:75]
    v_mfma_f32_16x16x32_bf16 v[76:79], v[52:55], v[244:247], v[76:79]
    s_waitcnt lgkmcnt(1)
    v_mfma_f32_16x16x32_bf16 v[64:67], v[56:59], v[248:251], v[64:67]
    v_mfma_f32_16x16x32_bf16 v[68:71], v[56:59], v[252:255], v[68:71]
    v_mfma_f32_16x16x32_bf16 v[72:75], v[60:63], v[248:251], v[72:75]
    v_mfma_f32_16x16x32_bf16 v[76:79], v[60:63], v[252:255], v[76:79]
    v_accvgpr_read_b32 v12, a224
    s_lshl_b32 s47, s42, 6
    v_add_u32 v12, s47, v12
    ds_write_b32 v12, a252 offset:256
    s_waitcnt lgkmcnt(0)
    s_barrier
    v_accvgpr_read_b32 v12, a225
    ds_read_b128 v[88:91], v12 offset:256
    ds_read_b128 v[92:95], v12 offset:320
    v_accvgpr_read_b32 v14, a246
    s_add_u32 s44, s72, 4096
    buffer_load_dwordx4 v[160:163], v14, s[28:31], s72 offen sc1
    buffer_load_dwordx4 v[128:131], v1, s[28:31], s72 offen offset:0 sc1
    buffer_load_dwordx4 v[132:135], v1, s[28:31], s72 offen offset:1024 sc1
    buffer_load_dwordx4 v[136:139], v1, s[28:31], s72 offen offset:2048 sc1
    buffer_load_dwordx4 v[140:143], v1, s[28:31], s72 offen offset:3072 sc1
    s_waitcnt lgkmcnt(0)
    v_pk_fma_f32 v[64:65], v[88:89], v[124:125], v[64:65] op_sel:[0,0,0] op_sel_hi:[1,0,1]
    v_pk_fma_f32 v[66:67], v[90:91], v[124:125], v[66:67] op_sel:[0,0,0] op_sel_hi:[1,0,1]
    v_pk_mul_f32 v[32:33], v[64:65], v[120:121] op_sel:[0,0] op_sel_hi:[1,0]
    v_pk_mul_f32 v[34:35], v[66:67], v[120:121] op_sel:[0,0] op_sel_hi:[1,0]
    v_exp_f32 v32, v32 clamp
    v_exp_f32 v33, v33 clamp
    v_exp_f32 v34, v34 clamp
    v_exp_f32 v35, v35 clamp
    v_max_f32 v64, 0, v64
    v_max_f32 v65, 0, v65
    buffer_load_dwordx4 v[144:147], v1, s[28:31], s44 offen offset:0 sc1
    v_max_f32 v66, 0, v66
    v_max_f32 v67, 0, v67
    v_pk_fma_f32 v[64:65], v[64:65], v[126:127], v[32:33] op_sel:[0,0,0] op_sel_hi:[1,0,1]
    v_pk_fma_f32 v[66:67], v[66:67], v[126:127], v[34:35] op_sel:[0,0,0] op_sel_hi:[1,0,1]
    v_pk_add_f32 v[64:65], v[64:65], s[40:41]
    v_pk_add_f32 v[66:67], v[66:67], s[40:41]
    v_cvt_pk_bf16_f32 v24, v64, v65
    v_cvt_pk_bf16_f32 v25, v66, v67
    v_pk_fma_f32 v[68:69], v[88:89], v[124:125], v[68:69] op_sel:[0,1,0] op_sel_hi:[1,1,1]
    v_pk_fma_f32 v[70:71], v[90:91], v[124:125], v[70:71] op_sel:[0,1,0] op_sel_hi:[1,1,1]
    buffer_load_dwordx4 v[148:151], v1, s[28:31], s44 offen offset:1024 sc1
    v_pk_mul_f32 v[32:33], v[68:69], v[120:121] op_sel:[0,1] op_sel_hi:[1,1]
    v_pk_mul_f32 v[34:35], v[70:71], v[120:121] op_sel:[0,1] op_sel_hi:[1,1]
    v_exp_f32 v32, v32 clamp
    v_exp_f32 v33, v33 clamp
    v_exp_f32 v34, v34 clamp
    v_exp_f32 v35, v35 clamp
    v_max_f32 v68, 0, v68
    v_max_f32 v69, 0, v69
    v_max_f32 v70, 0, v70
    v_max_f32 v71, 0, v71
    buffer_load_dwordx4 v[152:155], v1, s[28:31], s44 offen offset:2048 sc1
    v_pk_fma_f32 v[68:69], v[68:69], v[126:127], v[32:33] op_sel:[0,1,0] op_sel_hi:[1,1,1]
    v_pk_fma_f32 v[70:71], v[70:71], v[126:127], v[34:35] op_sel:[0,1,0] op_sel_hi:[1,1,1]
    v_pk_add_f32 v[68:69], v[68:69], s[40:41]
    v_pk_add_f32 v[70:71], v[70:71], s[40:41]
    v_cvt_pk_bf16_f32 v26, v68, v69
    v_cvt_pk_bf16_f32 v27, v70, v71
    v_pk_fma_f32 v[72:73], v[92:93], v[124:125], v[72:73] op_sel:[0,0,0] op_sel_hi:[1,0,1]
    v_pk_fma_f32 v[74:75], v[94:95], v[124:125], v[74:75] op_sel:[0,0,0] op_sel_hi:[1,0,1]
    v_pk_mul_f32 v[32:33], v[72:73], v[120:121] op_sel:[0,0] op_sel_hi:[1,0]
    v_pk_mul_f32 v[34:35], v[74:75], v[120:121] op_sel:[0,0] op_sel_hi:[1,0]
    buffer_load_dwordx4 v[156:159], v1, s[28:31], s44 offen offset:3072 sc1
    v_exp_f32 v32, v32 clamp
    v_exp_f32 v33, v33 clamp
    v_exp_f32 v34, v34 clamp
    v_exp_f32 v35, v35 clamp
    v_max_f32 v72, 0, v72
    v_max_f32 v73, 0, v73
    v_max_f32 v74, 0, v74
    v_max_f32 v75, 0, v75
    v_pk_fma_f32 v[72:73], v[72:73], v[126:127], v[32:33] op_sel:[0,0,0] op_sel_hi:[1,0,1]
    v_pk_fma_f32 v[74:75], v[74:75], v[126:127], v[34:35] op_sel:[0,0,0] op_sel_hi:[1,0,1]
    s_mul_i32 s82, s32, 16384
    s_add_u32 s78, s82, s84
    s_add_u32 m0, s82, 65536
    s_add_u32 s79, s78, 98304
    buffer_load_dwordx4 v1, s[28:31], s79 offen offset:0 sc1 lds
    v_pk_add_f32 v[72:73], v[72:73], s[40:41]
    v_pk_add_f32 v[74:75], v[74:75], s[40:41]
    v_cvt_pk_bf16_f32 v28, v72, v73
    v_cvt_pk_bf16_f32 v29, v74, v75
    v_pk_fma_f32 v[76:77], v[92:93], v[124:125], v[76:77] op_sel:[0,1,0] op_sel_hi:[1,1,1]
    v_pk_fma_f32 v[78:79], v[94:95], v[124:125], v[78:79] op_sel:[0,1,0] op_sel_hi:[1,1,1]
    v_pk_mul_f32 v[32:33], v[76:77], v[120:121] op_sel:[0,1] op_sel_hi:[1,1]
    v_pk_mul_f32 v[34:35], v[78:79], v[120:121] op_sel:[0,1] op_sel_hi:[1,1]
    v_exp_f32 v32, v32 clamp
    v_exp_f32 v33, v33 clamp
    buffer_load_dwordx4 v1, s[28:31], s79 offen offset:1024 sc1 lds
    v_exp_f32 v34, v34 clamp
    v_exp_f32 v35, v35 clamp
    v_max_f32 v76, 0, v76
    v_max_f32 v77, 0, v77
    v_max_f32 v78, 0, v78
    v_max_f32 v79, 0, v79
    v_pk_fma_f32 v[76:77], v[76:77], v[126:127], v[32:33] op_sel:[0,1,0] op_sel_hi:[1,1,1]
    v_pk_fma_f32 v[78:79], v[78:79], v[126:127], v[34:35] op_sel:[0,1,0] op_sel_hi:[1,1,1]
    v_pk_add_f32 v[76:77], v[76:77], s[40:41]
    v_pk_add_f32 v[78:79], v[78:79], s[40:41]
    buffer_load_dwordx4 v1, s[28:31], s79 offen offset:2048 sc1 lds
    v_cvt_pk_bf16_f32 v30, v76, v77
    v_cvt_pk_bf16_f32 v31, v78, v79
    buffer_load_dwordx4 v1, s[28:31], s79 offen offset:3072 sc1 lds
    v_accvgpr_read_b32 v13, a237
    v_accvgpr_read_b32 v50, a247
    v_accvgpr_read_b32 v48, a238
    v_accvgpr_read_b32 v49, a239
    s_branch L_kp_11_s
L_kp_11:
    buffer_load_dwordx4 v[160:163], v14, s[28:31], s72 offen sc1
    buffer_load_dwordx4 v[128:131], v1, s[28:31], s72 offen offset:0 sc1
    buffer_load_dwordx4 v[132:135], v1, s[28:31], s72 offen offset:1024 sc1
    buffer_load_dwordx4 v[136:139], v1, s[28:31], s72 offen offset:2048 sc1
    buffer_load_dwordx4 v[140:143], v1, s[28:31], s72 offen offset:3072 sc1
    buffer_load_dwordx4 v[144:147], v1, s[28:31], s44 offen offset:0 sc1
    buffer_load_dwordx4 v[148:151], v1, s[28:31], s44 offen offset:1024 sc1
    buffer_load_dwordx4 v[152:155], v1, s[28:31], s44 offen offset:2048 sc1
    buffer_load_dwordx4 v[156:159], v1, s[28:31], s44 offen offset:3072 sc1
    s_waitcnt vmcnt(0)
L_kp_11_s:
    s_waitcnt vmcnt(12)
    v_xor_b32 v160, s77, v160
    v_mov_b32 v44, v160
    v_permlane32_swap_b32 v162, v163
    v_permlane32_swap_b32 v160, v161
    v_add_f32 v160, v160, v161
    v_add_f32 v162, v162, v163
    s_nop 1
    v_permlane16_swap_b32 v160, v162
    v_add_f32 v160, v160, v162
    s_nop 1
    v_add_f32_dpp v160, v160, v160 row_ror:4 row_mask:0xf bank_mask:0xf
    s_nop 1
    v_add_f32_dpp v160, v160, v160 row_ror:8 row_mask:0xf bank_mask:0xf
    v_cvt_pk_bf16_f32 v160, v160, v160
    ds_write_b16 v50, v160
    s_waitcnt vmcnt(10)
    v_xor_b32 v128, s77, v128
    v_xor_b32 v132, s77, v132
    v_or3_b32 v44, v44, v128, v132
    v_pk_add_f32 v[40:41], v[128:129], v[132:133]
    v_pk_add_f32 v[42:43], v[130:131], v[134:135]
    s_waitcnt vmcnt(8)
    v_xor_b32 v136, s77, v136
    v_xor_b32 v140, s77, v140
    v_or3_b32 v44, v44, v136, v140
    v_pk_add_f32 v[136:137], v[136:137], v[140:141]
    v_pk_add_f32 v[138:139], v[138:139], v[142:143]
    v_pk_add_f32 v[40:41], v[40:41], v[136:137]
    v_pk_add_f32 v[42:43], v[42:43], v[138:139]
    s_waitcnt vmcnt(6)
    v_xor_b32 v144, s77, v144
    v_xor_b32 v148, s77, v148
    v_or3_b32 v44, v44, v144, v148
    v_pk_add_f32 v[144:145], v[144:145], v[148:149]
    v_pk_add_f32 v[146:147], v[146:147], v[150:151]
    v_pk_add_f32 v[40:41], v[40:41], v[144:145]
    v_pk_add_f32 v[42:43], v[42:43], v[146:147]
    s_waitcnt vmcnt(4)
    v_xor_b32 v152, s77, v152
    v_xor_b32 v156, s77, v156
    v_or3_b32 v44, v44, v152, v156
    v_pk_add_f32 v[152:153], v[152:153], v[156:157]
    v_pk_add_f32 v[154:155], v[154:155], v[158:159]
    v_pk_add_f32 v[40:41], v[40:41], v[152:153]
    v_pk_add_f32 v[42:43], v[42:43], v[154:155]
    ds_write_b128 v13, v[40:43]
    v_and_b32 v44, 0xff, v44
    v_cmp_ne_u32 vcc, 0, v44
    s_cbranch_vccz L_kd_12
    s_waitcnt lgkmcnt(0)
    s_sub_u32 s38, s38, 4
    s_cbranch_scc0 L_kp_11
    s_mov_b32 s38, 0
L_kd_12:
    s_add_u32 m0, s82, 69632
    s_add_u32 s79, s78, 102400
    buffer_load_dwordx4 v1, s[28:31], s79 offen offset:0 sc1 lds
    buffer_load_dwordx4 v1, s[28:31], s79 offen offset:1024 sc1 lds
    buffer_load_dwordx4 v1, s[28:31], s79 offen offset:2048 sc1 lds
    buffer_load_dwordx4 v1, s[28:31], s79 offen offset:3072 sc1 lds
    s_waitcnt lgkmcnt(0)
    s_barrier
    ds_read_b64 v[34:35], v49 offset:0
    ds_read_b64 v[38:39], v49 offset:32
    ds_read_b128 v[128:131], v48 offset:0
    ds_read_b128 v[132:135], v48 offset:1024
    ds_read_b128 v[136:139], v48 offset:2048
    ds_read_b128 v[140:143], v48 offset:3072
    s_waitcnt lgkmcnt(4)
    v_mfma_f32_16x16x16_bf16 v[84:87], v[34:35], v[24:25], 0
    v_mfma_f32_16x16x16_bf16 v[92:95], v[38:39], v[28:29], 0
    v_mfma_f32_16x16x16_bf16 v[100:103], v[34:35], v[26:27], 0
    v_mfma_f32_16x16x16_bf16 v[108:111], v[38:39], v[30:31], 0
    s_waitcnt lgkmcnt(0)
    v_pk_add_f32 v[128:129], v[128:129], v[132:133]
    v_pk_add_f32 v[130:131], v[130:131], v[134:135]
    v_pk_add_f32 v[136:137], v[136:137], v[140:141]
    v_pk_add_f32 v[138:139], v[138:139], v[142:143]
    v_cvt_pk_bf16_f32 v32, v128, v129
    v_cvt_pk_bf16_f32 v33, v130, v131
    v_cvt_pk_bf16_f32 v36, v136, v137
    v_cvt_pk_bf16_f32 v37, v138, v139
    v_add_f32 v84, s40, v84
    v_add_f32 v92, s40, v92
    v_add_f32 v100, s40, v100
    v_add_f32 v108, s40, v108
    v_mfma_f32_16x16x16_bf16 v[80:83], v[32:33], v[24:25], 0
    v_mfma_f32_16x16x16_bf16 v[88:91], v[36:37], v[28:29], 0
    v_mfma_f32_16x16x16_bf16 v[96:99], v[32:33], v[26:27], 0
    v_mfma_f32_16x16x16_bf16 v[104:107], v[36:37], v[30:31], 0
    v_rcp_f32 v84, v84
    v_rcp_f32 v92, v92
    v_rcp_f32 v100, v100
    v_rcp_f32 v108, v108
    s_nop 1
    v_pk_mul_f32 v[80:81], v[80:81], v[84:85] op_sel_hi:[1,0]
    v_pk_mul_f32 v[82:83], v[82:83], v[84:85] op_sel_hi:[1,0]
    v_cvt_pk_bf16_f32 v24, v80, v81
    v_cvt_pk_bf16_f32 v25, v82, v83
    v_pk_mul_f32 v[88:89], v[88:89], v[92:93] op_sel_hi:[1,0]
    v_pk_mul_f32 v[90:91], v[90:91], v[92:93] op_sel_hi:[1,0]
    v_cvt_pk_bf16_f32 v26, v88, v89
    v_cvt_pk_bf16_f32 v27, v90, v91
    v_pk_mul_f32 v[96:97], v[96:97], v[100:101] op_sel_hi:[1,0]
    v_pk_mul_f32 v[98:99], v[98:99], v[100:101] op_sel_hi:[1,0]
    v_cvt_pk_bf16_f32 v28, v96, v97
    v_cvt_pk_bf16_f32 v29, v98, v99
    v_pk_mul_f32 v[104:105], v[104:105], v[108:109] op_sel_hi:[1,0]
    v_pk_mul_f32 v[106:107], v[106:107], v[108:109] op_sel_hi:[1,0]
    v_cvt_pk_bf16_f32 v30, v104, v105
    v_cvt_pk_bf16_f32 v31, v106, v107
    s_cmp_lg_u32 s36, 0
    s_cbranch_scc1 L_ss_13
    buffer_store_dwordx4 v[24:27], v1, s[28:31], s52 offen
    buffer_store_dwordx4 v[28:31], v1, s[28:31], s53 offen
L_se_14:
    s_add_u32 m0, s82, 73728
    s_add_u32 s79, s78, 106496
    buffer_load_dwordx4 v1, s[28:31], s79 offen offset:0 sc1 lds
    buffer_load_dwordx4 v1, s[28:31], s79 offen offset:1024 sc1 lds
    buffer_load_dwordx4 v1, s[28:31], s79 offen offset:2048 sc1 lds
    buffer_load_dwordx4 v1, s[28:31], s79 offen offset:3072 sc1 lds
    s_add_u32 m0, s82, 77824
    s_add_u32 s79, s78, 110592
    buffer_load_dwordx4 v1, s[28:31], s79 offen offset:0 sc1 lds
    buffer_load_dwordx4 v1, s[28:31], s79 offen offset:1024 sc1 lds
    v_permlane16_swap_b32 v16, v18
    v_permlane16_swap_b32 v17, v19
    v_permlane16_swap_b32 v20, v22
    v_permlane16_swap_b32 v21, v23
    v_accvgpr_read_b32 v15, a226
    v_mov_b32 v13, s35
    s_waitcnt vmcnt(6)
    s_mov_b64 exec, 1
    s_cmp_lg_u32 s36, 0
    s_cbranch_scc1 L_ss_15
    buffer_store_dword v13, v1, s[28:31], s54 offen offset:0
L_se_16:
    s_mov_b64 exec, -1
    buffer_load_dword v12, v15, s[28:31], s55 offen offset:0 sc1
    ds_read_b128 v[32:35], v1 offset:0
    ds_read_b128 v[36:39], v1 offset:1024
    ds_read_b128 v[40:43], v1 offset:2048
    ds_read_b128 v[44:47], v1 offset:3072
    ds_read_b128 v[48:51], v1 offset:4096
    ds_read_b128 v[52:55], v1 offset:5120
    ds_read_b128 v[56:59], v1 offset:6144
    v_lshlrev_b32 v64, 16, v16
    v_and_b32 v65, 0xffff0000, v16
    v_lshlrev_b32 v66, 16, v17
    v_and_b32 v67, 0xffff0000, v17
    v_lshlrev_b32 v68, 16, v18
    v_and_b32 v69, 0xffff0000, v18
    v_lshlrev_b32 v70, 16, v19
    v_and_b32 v71, 0xffff0000, v19
    v_lshlrev_b32 v72, 16, v20
    v_and_b32 v73, 0xffff0000, v20
    v_lshlrev_b32 v74, 16, v21
    v_and_b32 v75, 0xffff0000, v21
    v_lshlrev_b32 v76, 16, v22
    v_and_b32 v77, 0xffff0000, v22
    v_lshlrev_b32 v78, 16, v23
    v_and_b32 v79, 0xffff0000, v23
L_poll_17:
    buffer_load_dword v14, v15, s[28:31], s55 offen offset:0 sc1
    s_waitcnt vmcnt(1)
    v_cmp_ne_u32 vcc, s35, v12
    s_cbranch_vccz L_pd_18
L_pad4:
    s_cbranch_execz L_pad8
    buffer_load_dword v12, v15, s[28:31], s55 offen offset:0 sc1
    s_waitcnt vmcnt(1)
    v_cmp_ne_u32 vcc, s35, v14
    s_cbranch_vccz L_pd_18
    s_sub_u32 s38, s38, 1
    s_cbranch_scc0 L_poll_17
    s_mov_b32 s38, 0
L_pd_18:
    s_add_u32 s44, s50, 163840
    buffer_load_dwordx4 v[128:131], v1, s[28:31], s44 offen offset:0 sc1
    buffer_load_dwordx4 v[132:135], v1, s[28:31], s44 offen offset:1024 sc1
    buffer_load_dwordx4 v[136:139], v1, s[28:31], s44 offen offset:2048 sc1
    buffer_load_dwordx4 v[140:143], v1, s[28:31], s44 offen offset:3072 sc1
    s_add_u32 s44, s50, 167936
    buffer_load_dwordx4 v[144:147], v1, s[28:31], s44 offen offset:0 sc1
    buffer_load_dwordx4 v[148:151], v1, s[28:31], s44 offen offset:1024 sc1
    buffer_load_dwordx4 v[152:155], v1, s[28:31], s44 offen offset:2048 sc1
    buffer_load_dwordx4 v[156:159], v1, s[28:31], s44 offen offset:3072 sc1
    s_waitcnt lgkmcnt(5) vmcnt(7)
    v_mfma_f32_16x16x32_bf16 v[64:67], v[32:35], v[128:131], v[64:67]
    ds_read_b128 v[60:63], v1 offset:7168
    v_mfma_f32_16x16x32_bf16 v[68:71], v[36:39], v[128:131], v[68:71]
    ds_read_b128 v[32:35], v1 offset:8192
    s_waitcnt lgkmcnt(5)
    v_mfma_f32_16x16x32_bf16 v[72:75], v[40:43], v[128:131], v[72:75]
    ds_read_b128 v[36:39], v1 offset:9216
    v_mfma_f32_16x16x32_bf16 v[76:79], v[44:47], v[128:131], v[76:79]
    ds_read_b128 v[40:43], v1 offset:10240
    s_add_u32 s44, s50, 172032
    buffer_load_dwordx4 v[160:163], v1, s[28:31], s44 offen offset:0 sc1
    s_waitcnt lgkmcnt(5) vmcnt(7)
    v_mfma_f32_16x16x32_bf16 v[64:67], v[48:51], v[132:135], v[64:67]
    ds_read_b128 v[44:47], v1 offset:11264
    v_mfma_f32_16x16x32_bf16 v[68:71], v[52:55], v[132:135], v[68:71]
    ds_read_b128 v[48:51], v1 offset:12288
    s_waitcnt lgkmcnt(5)
    v_mfma_f32_16x16x32_bf16 v[72:75], v[56:59], v[132:135], v[72:75]
    ds_read_b128 v[52:55], v1 offset:13312
    buffer_load_dwordx4 v[164:167], v1, s[28:31], s44 offen offset:1024 sc1
    v_mfma_f32_16x16x32_bf16 v[76:79], v[60:63], v[132:135], v[76:79]
    ds_read_b128 v[56:59], v1 offset:14336
    s_waitcnt lgkmcnt(5) vmcnt(7)
    v_mfma_f32_16x16x32_bf16 v[64:67], v[32:35], v[136:139], v[64:67]
    ds_read_b128 v[60:63], v1 offset:15360
    v_mfma_f32_16x16x32_bf16 v[68:71], v[36:39], v[136:139], v[68:71]
    ds_read_b128 v[32:35], v1 offset:16384
    buffer_load_dwordx4 v[168:171], v1, s[28:31], s44 offen offset:2048 sc1
    s_waitcnt lgkmcnt(5)
    v_mfma_f32_16x16x32_bf16 v[72:75], v[40:43], v[136:139], v[72:75]
    ds_read_b128 v[36:39], v1 offset:17408
    v_mfma_f32_16x16x32_bf16 v[76:79], v[44:47], v[136:139], v[76:79]
    ds_read_b128 v[40:43], v1 offset:18432
    s_waitcnt lgkmcnt(5) vmcnt(7)
    v_mfma_f32_16x16x32_bf16 v[64:67], v[48:51], v[140:143], v[64:67]
    ds_read_b128 v[44:47], v1 offset:19456
    buffer_load_dwordx4 v[172:175], v1, s[28:31], s44 offen offset:3072 sc1
    v_mfma_f32_16x16x32_bf16 v[68:71], v[52:55], v[140:143], v[68:71]
    ds_read_b128 v[48:51], v1 offset:20480
    s_waitcnt lgkmcnt(5)
    v_mfma_f32_16x16x32_bf16 v[72:75], v[56:59], v[140:143], v[72:75]
    ds_read_b128 v[52:55], v1 offset:21504
    v_mfma_f32_16x16x32_bf16 v[76:79], v[60:63], v[140:143], v[76:79]
    ds_read_b128 v[56:59], v1 offset:22528
    s_add_u32 s44, s50, 176128
    buffer_load_dwordx4 v[176:179], v1, s[28:31], s44 offen offset:0 sc1
    s_waitcnt lgkmcnt(5) vmcnt(8)
    v_mfma_f32_16x16x32_bf16 v[64:67], v[32:35], v[144:147], v[64:67]
    ds_read_b128 v[60:63], v1 offset:23552
    v_mfma_f32_16x16x32_bf16 v[68:71], v[36:39], v[144:147], v[68:71]
    ds_read_b128 v[32:35], v1 offset:24576
    s_waitcnt lgkmcnt(5)
    v_mfma_f32_16x16x32_bf16 v[72:75], v[40:43], v[144:147], v[72:75]
    ds_read_b128 v[36:39], v1 offset:25600
    buffer_load_dwordx4 v[180:183], v1, s[28:31], s44 offen offset:1024 sc1
    v_mfma_f32_16x16x32_bf16 v[76:79], v[44:47], v[144:147], v[76:79]
    ds_read_b128 v[40:43], v1 offset:26624
    s_waitcnt lgkmcnt(5) vmcnt(8)
    v_mfma_f32_16x16x32_bf16 v[64:67], v[48:51], v[148:151], v[64:67]
    ds_read_b128 v[44:47], v1 offset:27648
    v_mfma_f32_16x16x32_bf16 v[68:71], v[52:55], v[148:151], v[68:71]
    ds_read_b128 v[48:51], v1 offset:28672
    buffer_load_dwordx4 v[184:187], v1, s[28:31], s44 offen offset:2048 sc1
    s_waitcnt lgkmcnt(5)
    v_mfma_f32_16x16x32_bf16 v[72:75], v[56:59], v[148:151], v[72:75]
    ds_read_b128 v[52:55], v1 offset:29696
    v_mfma_f32_16x16x32_bf16 v[76:79], v[60:63], v[148:151], v[76:79]
    ds_read_b128 v[56:59], v1 offset:30720
    s_waitcnt lgkmcnt(5) vmcnt(8)
    v_mfma_f32_16x16x32_bf16 v[64:67], v[32:35], v[152:155], v[64:67]
    ds_read_b128 v[60:63], v1 offset:31744
    buffer_load_dwordx4 v[188:191], v1, s[28:31], s44 offen offset:3072 sc1
    v_mfma_f32_16x16x32_bf16 v[68:71], v[36:39], v[152:155], v[68:71]
    ds_read_b128 v[32:35], v1 offset:32768
    s_waitcnt lgkmcnt(5)
    v_mfma_f32_16x16x32_bf16 v[72:75], v[40:43], v[152:155], v[72:75]
    ds_read_b128 v[36:39], v1 offset:33792
    v_mfma_f32_16x16x32_bf16 v[76:79], v[44:47], v[152:155], v[76:79]
    ds_read_b128 v[40:43], v1 offset:34816
    buffer_load_dwordx4 v1, s[28:31], s79 offen offset:2048 sc1 lds
    s_waitcnt lgkmcnt(5) vmcnt(9)
    v_mfma_f32_16x16x32_bf16 v[64:67], v[48:51], v[156:159], v[64:67]
    ds_read_b128 v[44:47], v1 offset:35840
    v_mfma_f32_16x16x32_bf16 v[68:71], v[52:55], v[156:159], v[68:71]
    ds_read_b128 v[48:51], v1 offset:36864
    s_waitcnt lgkmcnt(5)
    v_mfma_f32_16x16x32_bf16 v[72:75], v[56:59], v[156:159], v[72:75]
    ds_read_b128 v[52:55], v1 offset:37888
    buffer_load_dwordx4 v1, s[28:31], s79 offen offset:3072 sc1 lds
    v_mfma_f32_16x16x32_bf16 v[76:79], v[60:63], v[156:159], v[76:79]
    ds_read_b128 v[56:59], v1 offset:38912
    s_waitcnt lgkmcnt(5) vmcnt(9)
    v_mfma_f32_16x16x32_bf16 v[64:67], v[32:35], v[160:163], v[64:67]
    ds_read_b128 v[60:63], v1 offset:39936
    v_mfma_f32_16x16x32_bf16 v[68:71], v[36:39], v[160:163], v[68:71]
    ds_read_b128 v[32:35], v1 offset:40960
    s_mul_i32 s82, s32, 6144
    s_add_u32 s78, s82, s84
    s_add_u32 m0, s82, 131072
    s_add_u32 s79, s78, 163840
    buffer_load_dwordx4 v1, s[28:31], s79 offen offset:0 sc1 lds
    s_waitcnt lgkmcnt(5)
    v_mfma_f32_16x16x32_bf16 v[72:75], v[40:43], v[160:163], v[72:75]
    ds_read_b128 v[36:39], v1 offset:41984
    v_mfma_f32_16x16x32_bf16 v[76:79], v[44:47], v[160:163], v[76:79]
    ds_read_b128 v[40:43], v1 offset:43008
    s_waitcnt lgkmcnt(5) vmcnt(9)
    v_mfma_f32_16x16x32_bf16 v[64:67], v[48:51], v[164:167], v[64:67]
    ds_read_b128 v[44:47], v1 offset:44032
    buffer_load_dwordx4 v1, s[28:31], s79 offen offset:1024 sc1 lds
    v_mfma_f32_16x16x32_bf16 v[68:71], v[52:55], v[164:167], v[68:71]
    ds_read_b128 v[48:51], v1 offset:45056
    s_waitcnt lgkmcnt(5)
    v_mfma_f32_16x16x32_bf16 v[72:75], v[56:59], v[164:167], v[72:75]
    ds_read_b128 v[52:55], v1 offset:46080
    v_mfma_f32_16x16x32_bf16 v[76:79], v[60:63], v[164:167], v[76:79]
    ds_read_b128 v[56:59], v1 offset:47104
    buffer_load_dwordx4 v1, s[28:31], s79 offen offset:2048 sc1 lds
    s_waitcnt lgkmcnt(5) vmcnt(10)
    v_mfma_f32_16x16x32_bf16 v[64:67], v[32:35], v[168:171], v[64:67]
    ds_read_b128 v[60:63], v1 offset:48128
    v_mfma_f32_16x16x32_bf16 v[68:71], v[36:39], v[168:171], v[68:71]
    ds_read_b128 v[32:35], v1 offset:49152
    s_waitcnt lgkmcnt(5)
    v_mfma_f32_16x16x32_bf16 v[72:75], v[40:43], v[168:171], v[72:75]
    ds_read_b128 v[36:39], v1 offset:50176
    buffer_load_dwordx4 v1, s[28:31], s79 offen offset:3072 sc1 lds
    v_mfma_f32_16x16x32_bf16 v[76:79], v[44:47], v[168:171], v[76:79]
    ds_read_b128 v[40:43], v1 offset:51200
    s_waitcnt lgkmcnt(5) vmcnt(10)
    v_mfma_f32_16x16x32_bf16 v[64:67], v[48:51], v[172:175], v[64:67]
    ds_read_b128 v[44:47], v1 offset:52224
    v_mfma_f32_16x16x32_bf16 v[68:71], v[52:55], v[172:175], v[68:71]
    ds_read_b128 v[48:51], v1 offset:53248
    s_add_u32 m0, s82, 135168
    s_add_u32 s79, s78, 167936
    buffer_load_dwordx4 v1, s[28:31], s79 offen offset:0 sc1 lds
    s_waitcnt lgkmcnt(5)
    v_mfma_f32_16x16x32_bf16 v[72:75], v[56:59], v[172:175], v[72:75]
    ds_read_b128 v[52:55], v1 offset:54272
    v_mfma_f32_16x16x32_bf16 v[76:79], v[60:63], v[172:175], v[76:79]
    ds_read_b128 v[56:59], v1 offset:55296
    s_waitcnt lgkmcnt(5) vmcnt(10)
    v_mfma_f32_16x16x32_bf16 v[64:67], v[32:35], v[176:179], v[64:67]
    ds_read_b128 v[60:63], v1 offset:56320
    buffer_load_dwordx4 v1, s[28:31], s79 offen offset:1024 sc1 lds
    v_mfma_f32_16x16x32_bf16 v[68:71], v[36:39], v[176:179], v[68:71]
    ds_read_b128 v[32:35], v1 offset:57344
    s_waitcnt lgkmcnt(5)
    v_mfma_f32_16x16x32_bf16 v[72:75], v[40:43], v[176:179], v[72:75]
    ds_read_b128 v[36:39], v1 offset:58368
    v_mfma_f32_16x16x32_bf16 v[76:79], v[44:47], v[176:179], v[76:79]
    ds_read_b128 v[40:43], v1 offset:59392
    s_lshl2_add_u32 s81, s33, s32
    v_lshlrev_b32 v8, 7, v0
    s_lshl_b32 s47, s81, 11
    s_add_u32 s47, s47, s37
    s_add_u32 s47, s47, 32768
    s_mov_b64 exec, 0xffff
    buffer_load_dword a227, v8, s[28:31], s47 offen sc1
    s_lshl_b32 s81, s81, 7
    s_add_u32 s81, s81, s37
    s_mov_b64 exec, 1
    s_add_u32 s81, s81, 4096
    buffer_load_dword a227, v8, s[28:31], s81 offen sc1
    s_mov_b64 exec, -1
    s_waitcnt lgkmcnt(5) vmcnt(12)
    v_mfma_f32_16x16x32_bf16 v[64:67], v[48:51], v[180:183], v[64:67]
    ds_read_b128 v[44:47], v1 offset:60416
    v_mfma_f32_16x16x32_bf16 v[68:71], v[52:55], v[180:183], v[68:71]
    ds_read_b128 v[48:51], v1 offset:61440
    s_waitcnt lgkmcnt(5)
    v_mfma_f32_16x16x32_bf16 v[72:75], v[56:59], v[180:183], v[72:75]
    ds_read_b128 v[52:55], v1 offset:62464
    v_mfma_f32_16x16x32_bf16 v[76:79], v[60:63], v[180:183], v[76:79]
    ds_read_b128 v[56:59], v1 offset:63488
    s_waitcnt lgkmcnt(5) vmcnt(11)
    v_mfma_f32_16x16x32_bf16 v[64:67], v[32:35], v[184:187], v[64:67]
    ds_read_b128 v[60:63], v1 offset:64512
    v_mfma_f32_16x16x32_bf16 v[68:71], v[36:39], v[184:187], v[68:71]
    s_waitcnt lgkmcnt(4)
    v_mfma_f32_16x16x32_bf16 v[72:75], v[40:43], v[184:187], v[72:75]
    v_mfma_f32_16x16x32_bf16 v[76:79], v[44:47], v[184:187], v[76:79]
    s_waitcnt lgkmcnt(2) vmcnt(10)
    v_mfma_f32_16x16x32_bf16 v[64:67], v[48:51], v[188:191], v[64:67]
    v_mfma_f32_16x16x32_bf16 v[68:71], v[52:55], v[188:191], v[68:71]
    s_waitcnt lgkmcnt(0)
    v_mfma_f32_16x16x32_bf16 v[72:75], v[56:59], v[188:191], v[72:75]
    v_mfma_f32_16x16x32_bf16 v[76:79], v[60:63], v[188:191], v[76:79]
    v_add_u32 v3, 65536, v1
    s_nop 6
    v_cvt_pk_bf16_f32 v16, v64, v65
    v_cvt_pk_bf16_f32 v17, v66, v67
    v_cvt_pk_bf16_f32 v18, v68, v69
    v_cvt_pk_bf16_f32 v19, v70, v71
    v_cvt_pk_bf16_f32 v20, v72, v73
    v_cvt_pk_bf16_f32 v21, v74, v75
    v_cvt_pk_bf16_f32 v22, v76, v77
    v_cvt_pk_bf16_f32 v23, v78, v79
    s_add_u32 s43, s51, 32768
    s_cmp_lg_u32 s36, 0
    s_cbranch_scc1 L_ss_19
    buffer_store_dwordx4 v[16:19], v1, s[28:31], s43 offen offset:0
    buffer_store_dwordx4 v[20:23], v1, s[28:31], s43 offen offset:1024
L_se_20:
    v_mov_b32 v41, 0x3f803f80
    v_dot2_f32_bf16 v13, v16, v16, 0
    v_dot2_f32_bf16 v15, v20, v20, 0
    v_dot2_f32_bf16 v12, v41, v16, 0
    v_dot2_f32_bf16 v14, v41, v20, 0
    v_dot2_f32_bf16 v13, v17, v17, v13
    v_dot2_f32_bf16 v15, v21, v21, v15
    v_dot2_f32_bf16 v12, v41, v17, v12
    v_dot2_f32_bf16 v14, v41, v21, v14
    v_dot2_f32_bf16 v13, v18, v18, v13
    v_dot2_f32_bf16 v15, v22, v22, v15
    v_dot2_f32_bf16 v12, v41, v18, v12
    v_dot2_f32_bf16 v14, v41, v22, v14
    v_dot2_f32_bf16 v13, v19, v19, v13
    v_dot2_f32_bf16 v15, v23, v23, v15
    v_dot2_f32_bf16 v12, v41, v19, v12
    v_dot2_f32_bf16 v14, v41, v23, v14
    v_accvgpr_read_b32 v40, a228
    s_add_u32 s45, s58, 4096
    v_add_f32 v13, v13, v15
    v_add_f32 v12, v12, v14
    s_nop 1
    v_permlane16_swap_b32 v12, v13
    v_add_f32 v12, v12, v13
    v_mov_b32 v13, v12
    s_nop 1
    v_permlane32_swap_b32 v12, v13
    v_add_f32 v14, v12, v13
    s_add_u32 s93, s93, 1
    s_and_b32 s93, s93, 0xff
    v_and_b32 v14, 0xffffff00, v14
    v_or_b32 v14, s93, v14
    s_mov_b32 exec_hi, 0
    s_cmp_lg_u32 s36, 0
    s_cbranch_scc1 L_ss_21
    buffer_store_dword v14, v40, s[28:31], s45 offen
L_se_22:
    s_mov_b64 exec, -1
    v_accvgpr_read_b32 v15, a226
    v_mov_b32 v13, s35
    s_waitcnt vmcnt(1)
    s_mov_b64 exec, 1
    s_cmp_lg_u32 s36, 0
    s_cbranch_scc1 L_ss_23
    buffer_store_dword v13, v1, s[28:31], s56 offen offset:512
L_se_24:
    s_mov_b64 exec, -1
    s_barrier
    s_lshl_b32 s44, s32, 10
    v_add_u32 v24, s44, v3
    ds_read_b128 v[32:35], v24 offset:0
    ds_read_b128 v[36:39], v24 offset:4096
    ds_read_b128 v[40:43], v24 offset:8192
    ds_read_b128 v[44:47], v24 offset:12288
    ds_read_b128 v[48:51], v24 offset:16384
    ds_read_b128 v[52:55], v24 offset:20480
    ds_read_b128 v[56:59], v24 offset:24576
    s_waitcnt lgkmcnt(5)
    v_mfma_f32_16x16x32_bf16 a[252:255], a[248:251], v[32:35], 0
    ds_read_b128 v[60:63], v24 offset:28672
    v_mfma_f32_16x16x32_bf16 a[252:255], a[248:251], v[36:39], a[252:255]
    ds_read_b128 v[32:35], v24 offset:32768
    s_waitcnt lgkmcnt(5)
    v_mfma_f32_16x16x32_bf16 a[252:255], a[248:251], v[40:43], a[252:255]
    ds_read_b128 v[36:39], v24 offset:36864
    v_mfma_f32_16x16x32_bf16 a[252:255], a[248:251], v[44:47], a[252:255]
    ds_read_b128 v[40:43], v24 offset:40960
    s_waitcnt lgkmcnt(5)
    v_mfma_f32_16x16x32_bf16 a[252:255], a[248:251], v[48:51], a[252:255]
    ds_read_b128 v[44:47], v24 offset:45056
    v_mfma_f32_16x16x32_bf16 a[252:255], a[248:251], v[52:55], a[252:255]
    ds_read_b128 v[48:51], v24 offset:49152
    s_waitcnt lgkmcnt(5)
    v_mfma_f32_16x16x32_bf16 a[252:255], a[248:251], v[56:59], a[252:255]
    ds_read_b128 v[52:55], v24 offset:53248
L_pad5:
    s_cbranch_execz L_pad9
    v_mfma_f32_16x16x32_bf16 a[252:255], a[248:251], v[60:63], a[252:255]
    ds_read_b128 v[56:59], v24 offset:57344
    s_waitcnt lgkmcnt(5)
    v_mfma_f32_16x16x32_bf16 a[252:255], a[248:251], v[32:35], a[252:255]
    ds_read_b128 v[60:63], v24 offset:61440
    v_mfma_f32_16x16x32_bf16 a[252:255], a[248:251], v[36:39], a[252:255]
    s_waitcnt lgkmcnt(4)
    v_mfma_f32_16x16x32_bf16 a[252:255], a[248:251], v[40:43], a[252:255]
    v_mfma_f32_16x16x32_bf16 a[252:255], a[248:251], v[44:47], a[252:255]
    s_waitcnt lgkmcnt(2)
    v_mfma_f32_16x16x32_bf16 a[252:255], a[248:251], v[48:51], a[252:255]
    v_mfma_f32_16x16x32_bf16 a[252:255], a[248:251], v[52:55], a[252:255]
    s_waitcnt lgkmcnt(0)
    v_mfma_f32_16x16x32_bf16 a[252:255], a[248:251], v[56:59], a[252:255]
    v_mfma_f32_16x16x32_bf16 a[252:255], a[248:251], v[60:63], a[252:255]
    s_lshl_b32 s47, s32, 12
    v_add_u32 v25, s47, v1
    ds_write_b128 v25, a[128:131] offset:32768
    ds_write_b128 v25, a[132:135] offset:33792
    ds_write_b128 v25, a[136:139] offset:34816
    ds_write_b128 v25, a[140:143] offset:35840
    ds_write_b128 v25, a[144:147] offset:49152
    ds_write_b128 v25, a[148:151] offset:50176
    ds_write_b128 v25, a[152:155] offset:51200
    ds_write_b128 v25, a[156:159] offset:52224
    s_nop 5
    v_accvgpr_read_b32 v12, a224
    s_lshl_b32 s47, s32, 6
    v_add_u32 v12, s47, v12
    ds_write_b32 v12, a252 offset:384
    v_add_u32 v10, 131072, v1
    s_min_u32 s85, s32, 2
    s_lshl_b32 s44, s85, 10
    v_add_u32 v9, s44, v1
    v_add_u32 v8, 131072, v9
    buffer_load_dword v12, v15, s[28:31], s57 offen offset:512 sc1
    ds_read_b128 v[32:35], v3 offset:0
    ds_read_b128 v[36:39], v3 offset:1024
    ds_read_b128 v[40:43], v3 offset:2048
    ds_read_b128 v[44:47], v3 offset:3072
    ds_read_b128 v[48:51], v3 offset:4096
    ds_read_b128 v[52:55], v3 offset:5120
L_poll_25:
    buffer_load_dword v14, v15, s[28:31], s57 offen offset:512 sc1
    s_waitcnt vmcnt(1)
    v_cmp_ne_u32 vcc, s35, v12
    s_cbranch_vccz L_pd_26
    buffer_load_dword v12, v15, s[28:31], s57 offen offset:512 sc1
    s_waitcnt vmcnt(1)
    v_cmp_ne_u32 vcc, s35, v14
    s_cbranch_vccz L_pd_26
    s_sub_u32 s38, s38, 1
    s_cbranch_scc0 L_poll_25
    s_mov_b32 s38, 0
L_pd_26:
    s_add_u32 s44, s48, 32768
    buffer_load_dwordx4 v[128:131], v1, s[28:31], s44 offen offset:0 sc1
    s_add_u32 s45, s49, 32768
    buffer_load_dwordx4 v[132:135], v1, s[28:31], s45 offen offset:0 sc1
    buffer_load_dwordx4 v[136:139], v1, s[28:31], s44 offen offset:1024 sc1
    buffer_load_dwordx4 v[140:143], v1, s[28:31], s45 offen offset:1024 sc1
    buffer_load_dwordx4 v[144:147], v1, s[28:31], s44 offen offset:2048 sc1
    buffer_load_dwordx4 v[148:151], v1, s[28:31], s45 offen offset:2048 sc1
    buffer_load_dwordx4 v[152:155], v1, s[28:31], s44 offen offset:3072 sc1
    buffer_load_dwordx4 v[156:159], v1, s[28:31], s45 offen offset:3072 sc1
    s_waitcnt lgkmcnt(4) vmcnt(7)
    v_mfma_f32_16x16x32_bf16 v[64:67], v[32:35], v[128:131], 0
    ds_read_b128 v[56:59], v3 offset:6144
    s_add_u32 s46, s59, 4096
    buffer_load_dwordx4 v[24:27], v1, s[28:31], s46 offen offset:0 sc1
    s_waitcnt vmcnt(7)
    v_mfma_f32_16x16x32_bf16 v[68:71], v[32:35], v[132:135], 0
    v_mfma_f32_16x16x32_bf16 v[72:75], v[36:39], v[128:131], 0
    ds_read_b128 v[60:63], v3 offset:7168
    v_mfma_f32_16x16x32_bf16 v[76:79], v[36:39], v[132:135], 0
    s_waitcnt lgkmcnt(4)
    v_mfma_f32_16x16x32_bf16 v[80:83], v[40:43], v[128:131], 0
    ds_read_b128 v[32:35], v3 offset:8192
    v_mfma_f32_16x16x32_bf16 v[84:87], v[40:43], v[132:135], 0
    buffer_load_dwordx4 v[28:31], v1, s[28:31], s46 offen offset:1024 sc1
    v_mfma_f32_16x16x32_bf16 v[88:91], v[44:47], v[128:131], 0
    ds_read_b128 v[36:39], v3 offset:9216
    v_mfma_f32_16x16x32_bf16 v[92:95], v[44:47], v[132:135], 0
    s_waitcnt lgkmcnt(4) vmcnt(6)
    v_mfma_f32_16x16x32_bf16 v[64:67], v[48:51], v[136:139], v[64:67]
    ds_read_b128 v[40:43], v3 offset:10240
    v_mfma_f32_16x16x32_bf16 v[68:71], v[48:51], v[140:143], v[68:71]
    s_add_u32 s44, s48, 36864
    buffer_load_dwordx4 v[160:163], v1, s[28:31], s44 offen offset:0 sc1
    v_mfma_f32_16x16x32_bf16 v[72:75], v[52:55], v[136:139], v[72:75]
    ds_read_b128 v[44:47], v3 offset:11264
    v_mfma_f32_16x16x32_bf16 v[76:79], v[52:55], v[140:143], v[76:79]
    s_waitcnt lgkmcnt(4)
    v_mfma_f32_16x16x32_bf16 v[80:83], v[56:59], v[136:139], v[80:83]
    ds_read_b128 v[48:51], v3 offset:12288
    v_mfma_f32_16x16x32_bf16 v[84:87], v[56:59], v[140:143], v[84:87]
    s_add_u32 s45, s49, 36864
    buffer_load_dwordx4 v[164:167], v1, s[28:31], s45 offen offset:0 sc1
    v_mfma_f32_16x16x32_bf16 v[88:91], v[60:63], v[136:139], v[88:91]
    ds_read_b128 v[52:55], v3 offset:13312
    v_mfma_f32_16x16x32_bf16 v[92:95], v[60:63], v[140:143], v[92:95]
    s_waitcnt lgkmcnt(4) vmcnt(6)
    v_mfma_f32_16x16x32_bf16 v[64:67], v[32:35], v[144:147], v[64:67]
    ds_read_b128 v[56:59], v3 offset:14336
    v_mfma_f32_16x16x32_bf16 v[68:71], v[32:35], v[148:151], v[68:71]
    buffer_load_dwordx4 v[168:171], v1, s[28:31], s44 offen offset:1024 sc1
    v_mfma_f32_16x16x32_bf16 v[72:75], v[36:39], v[144:147], v[72:75]
    ds_read_b128 v[60:63], v3 offset:15360
    v_mfma_f32_16x16x32_bf16 v[76:79], v[36:39], v[148:151], v[76:79]
    s_waitcnt lgkmcnt(4)
    v_mfma_f32_16x16x32_bf16 v[80:83], v[40:43], v[144:147], v[80:83]
    ds_read_b128 v[32:35], v8 offset:0
    v_mfma_f32_16x16x32_bf16 v[84:87], v[40:43], v[148:151], v[84:87]
    buffer_load_dwordx4 v[172:175], v1, s[28:31], s45 offen offset:1024 sc1
    v_mfma_f32_16x16x32_bf16 v[88:91], v[44:47], v[144:147], v[88:91]
    ds_read_b128 v[36:39], v8 offset:3072
    v_mfma_f32_16x16x32_bf16 v[92:95], v[44:47], v[148:151], v[92:95]
    s_waitcnt lgkmcnt(4) vmcnt(6)
    v_mfma_f32_16x16x32_bf16 v[64:67], v[48:51], v[152:155], v[64:67]
    ds_read_b128 v[40:43], v3 offset:16384
    buffer_load_dwordx4 v[176:179], v1, s[28:31], s44 offen offset:2048 sc1
    v_mfma_f32_16x16x32_bf16 v[68:71], v[48:51], v[156:159], v[68:71]
    buffer_load_dwordx4 v[180:183], v1, s[28:31], s45 offen offset:2048 sc1
    v_mfma_f32_16x16x32_bf16 v[72:75], v[52:55], v[152:155], v[72:75]
    ds_read_b128 v[44:47], v3 offset:17408
    v_mfma_f32_16x16x32_bf16 v[76:79], v[52:55], v[156:159], v[76:79]
    s_waitcnt lgkmcnt(4)
    v_mfma_f32_16x16x32_bf16 v[80:83], v[56:59], v[152:155], v[80:83]
    ds_read_b128 v[48:51], v3 offset:18432
    v_mfma_f32_16x16x32_bf16 v[84:87], v[56:59], v[156:159], v[84:87]
    buffer_load_dwordx4 v[184:187], v1, s[28:31], s44 offen offset:3072 sc1
    v_mfma_f32_16x16x32_bf16 v[88:91], v[60:63], v[152:155], v[88:91]
    ds_read_b128 v[52:55], v3 offset:19456
    v_mfma_f32_16x16x32_bf16 v[92:95], v[60:63], v[156:159], v[92:95]
    s_waitcnt lgkmcnt(4)
    v_mfma_f32_16x16x32_bf16 a[252:255], a[248:251], v[32:35], 0
    ds_read_b128 v[56:59], v3 offset:20480
    v_mfma_f32_16x16x32_bf16 a[252:255], a[248:251], v[36:39], a[252:255]
    ds_read_b128 v[60:63], v3 offset:21504
    s_waitcnt lgkmcnt(4) vmcnt(5)
    v_mfma_f32_16x16x32_bf16 v[64:67], v[40:43], v[160:163], v[64:67]
    ds_read_b128 v[32:35], v3 offset:22528
    v_mfma_f32_16x16x32_bf16 v[68:71], v[40:43], v[164:167], v[68:71]
    buffer_load_dwordx4 v[188:191], v1, s[28:31], s45 offen offset:3072 sc1
    v_mfma_f32_16x16x32_bf16 v[72:75], v[44:47], v[160:163], v[72:75]
    ds_read_b128 v[36:39], v3 offset:23552
    v_mfma_f32_16x16x32_bf16 v[76:79], v[44:47], v[164:167], v[76:79]
    s_waitcnt lgkmcnt(4)
    v_mfma_f32_16x16x32_bf16 v[80:83], v[48:51], v[160:163], v[80:83]
    ds_read_b128 v[40:43], v8 offset:6144
    v_mfma_f32_16x16x32_bf16 v[84:87], v[48:51], v[164:167], v[84:87]
    s_add_u32 s44, s48, 40960
    buffer_load_dwordx4 v[192:195], v1, s[28:31], s44 offen offset:0 sc1
    v_mfma_f32_16x16x32_bf16 v[88:91], v[52:55], v[160:163], v[88:91]
    ds_read_b128 v[44:47], v8 offset:9216
    v_mfma_f32_16x16x32_bf16 v[92:95], v[52:55], v[164:167], v[92:95]
    s_waitcnt lgkmcnt(4) vmcnt(5)
    v_mfma_f32_16x16x32_bf16 v[64:67], v[56:59], v[168:171], v[64:67]
    ds_read_b128 v[48:51], v3 offset:24576
    s_add_u32 s45, s49, 40960
    buffer_load_dwordx4 v[196:199], v1, s[28:31], s45 offen offset:0 sc1
    v_mfma_f32_16x16x32_bf16 v[68:71], v[56:59], v[172:175], v[68:71]
    buffer_load_dwordx4 v[200:203], v1, s[28:31], s44 offen offset:1024 sc1
    v_mfma_f32_16x16x32_bf16 v[72:75], v[60:63], v[168:171], v[72:75]
    ds_read_b128 v[52:55], v3 offset:25600
    v_mfma_f32_16x16x32_bf16 v[76:79], v[60:63], v[172:175], v[76:79]
    v_xor_b32 v24, s93, v24
    s_waitcnt lgkmcnt(4)
    v_mfma_f32_16x16x32_bf16 v[80:83], v[32:35], v[168:171], v[80:83]
    ds_read_b128 v[56:59], v3 offset:26624
    v_mfma_f32_16x16x32_bf16 v[84:87], v[32:35], v[172:175], v[84:87]
    buffer_load_dwordx4 v[204:207], v1, s[28:31], s45 offen offset:1024 sc1
    v_mfma_f32_16x16x32_bf16 v[88:91], v[36:39], v[168:171], v[88:91]
    ds_read_b128 v[60:63], v3 offset:27648
    v_xor_b32 v25, s93, v25
    v_mfma_f32_16x16x32_bf16 v[92:95], v[36:39], v[172:175], v[92:95]
    v_xor_b32 v26, s93, v26
    s_waitcnt lgkmcnt(4)
    v_mfma_f32_16x16x32_bf16 a[252:255], a[248:251], v[40:43], a[252:255]
    ds_read_b128 v[32:35], v3 offset:28672
    v_xor_b32 v27, s93, v27
    v_mfma_f32_16x16x32_bf16 a[252:255], a[248:251], v[44:47], a[252:255]
    ds_read_b128 v[36:39], v3 offset:29696
    s_waitcnt lgkmcnt(4) vmcnt(6)
    v_mfma_f32_16x16x32_bf16 v[64:67], v[48:51], v[176:179], v[64:67]
    ds_read_b128 v[40:43], v3 offset:30720
    v_mfma_f32_16x16x32_bf16 v[68:71], v[48:51], v[180:183], v[68:71]
    buffer_load_dwordx4 v[208:211], v1, s[28:31], s44 offen offset:2048 sc1
    v_xor_b32 v28, s93, v28
    v_mfma_f32_16x16x32_bf16 v[72:75], v[52:55], v[176:179], v[72:75]
    ds_read_b128 v[44:47], v3 offset:31744
    v_xor_b32 v29, s93, v29
    v_mfma_f32_16x16x32_bf16 v[76:79], v[52:55], v[180:183], v[76:79]
    v_xor_b32 v30, s93, v30
    s_waitcnt lgkmcnt(4)
    v_mfma_f32_16x16x32_bf16 v[80:83], v[56:59], v[176:179], v[80:83]
    ds_read_b128 v[48:51], v8 offset:12288
    v_mfma_f32_16x16x32_bf16 v[84:87], v[56:59], v[180:183], v[84:87]
    buffer_load_dwordx4 v[212:215], v1, s[28:31], s45 offen offset:2048 sc1
    v_xor_b32 v31, s93, v31
    v_mfma_f32_16x16x32_bf16 v[88:91], v[60:63], v[176:179], v[88:91]
    ds_read_b128 v[52:55], v8 offset:15360
    v_or3_b32 v120, v24, v25, v26
    v_mfma_f32_16x16x32_bf16 v[92:95], v[60:63], v[180:183], v[92:95]
    v_or3_b32 v121, v27, v28, v29
    s_waitcnt lgkmcnt(4) vmcnt(6)
    v_mfma_f32_16x16x32_bf16 v[64:67], v[32:35], v[184:187], v[64:67]
    ds_read_b128 v[56:59], v3 offset:32768
    buffer_load_dwordx4 v[216:219], v1, s[28:31], s44 offen offset:3072 sc1
    v_mfma_f32_16x16x32_bf16 v[68:71], v[32:35], v[188:191], v[68:71]
    v_or3_b32 v120, v120, v30, v31
    v_or_b32 v120, v120, v121
    v_mfma_f32_16x16x32_bf16 v[72:75], v[36:39], v[184:187], v[72:75]
    ds_read_b128 v[60:63], v3 offset:33792
    v_and_b32 v120, 0xff, v120
    v_mfma_f32_16x16x32_bf16 v[76:79], v[36:39], v[188:191], v[76:79]
    s_waitcnt lgkmcnt(4)
    v_mfma_f32_16x16x32_bf16 v[80:83], v[40:43], v[184:187], v[80:83]
    ds_read_b128 v[32:35], v3 offset:34816
    buffer_load_dwordx4 v[220:223], v1, s[28:31], s45 offen offset:3072 sc1
    v_mfma_f32_16x16x32_bf16 v[84:87], v[40:43], v[188:191], v[84:87]
    v_cmp_ne_u32 vcc, 0, v120
    s_cbranch_vccnz L_sg_27
L_sgok_28:
    v_mfma_f32_16x16x32_bf16 v[88:91], v[44:47], v[184:187], v[88:91]
    ds_read_b128 v[36:39], v3 offset:35840
    v_add_f32 v120, v24, v28
    v_mfma_f32_16x16x32_bf16 v[92:95], v[44:47], v[188:191], v[92:95]
    s_add_u32 s44, s48, 45056
    buffer_load_dwordx4 v[224:227], v1, s[28:31], s44 offen offset:0 sc1
    v_add_f32 v121, v25, v29
    s_waitcnt lgkmcnt(4)
    v_mfma_f32_16x16x32_bf16 a[252:255], a[248:251], v[48:51], a[252:255]
    ds_read_b128 v[40:43], v3 offset:36864
    v_add_f32 v122, v26, v30
    v_mfma_f32_16x16x32_bf16 a[252:255], a[248:251], v[52:55], a[252:255]
    ds_read_b128 v[44:47], v3 offset:37888
    s_waitcnt lgkmcnt(4) vmcnt(7)
    v_mfma_f32_16x16x32_bf16 v[64:67], v[56:59], v[192:195], v[64:67]
    ds_read_b128 v[48:51], v3 offset:38912
    v_add_f32 v123, v27, v31
    v_mfma_f32_16x16x32_bf16 v[68:71], v[56:59], v[196:199], v[68:71]
    s_add_u32 s45, s49, 45056
    buffer_load_dwordx4 v[228:231], v1, s[28:31], s45 offen offset:0 sc1
    v_accvgpr_read_b32 v13, a229
    v_mfma_f32_16x16x32_bf16 v[72:75], v[60:63], v[192:195], v[72:75]
    ds_read_b128 v[52:55], v3 offset:39936
    v_accvgpr_read_b32 v12, a230
    v_mfma_f32_16x16x32_bf16 v[76:79], v[60:63], v[196:199], v[76:79]
    v_permlane32_swap_b32 v120, v122
    s_waitcnt lgkmcnt(4)
    v_mfma_f32_16x16x32_bf16 v[80:83], v[32:35], v[192:195], v[80:83]
    ds_read_b128 v[56:59], v8 offset:18432
    v_mfma_f32_16x16x32_bf16 v[84:87], v[32:35], v[196:199], v[84:87]
    buffer_load_dwordx4 v[232:235], v1, s[28:31], s44 offen offset:1024 sc1
    v_permlane32_swap_b32 v121, v123
    v_mfma_f32_16x16x32_bf16 v[88:91], v[36:39], v[192:195], v[88:91]
    ds_read_b128 v[60:63], v8 offset:21504
    v_add_f32 v120, v120, v122
    v_mfma_f32_16x16x32_bf16 v[92:95], v[36:39], v[196:199], v[92:95]
    s_waitcnt lgkmcnt(4) vmcnt(7)
    v_mfma_f32_16x16x32_bf16 v[64:67], v[40:43], v[200:203], v[64:67]
    ds_read_b128 v[32:35], v3 offset:40960
    buffer_load_dwordx4 v[236:239], v1, s[28:31], s45 offen offset:1024 sc1
    v_add_f32 v121, v121, v123
    v_mfma_f32_16x16x32_bf16 v[68:71], v[40:43], v[204:207], v[68:71]
    v_mov_b32 v122, v120
    v_mov_b32 v123, v121
    v_mfma_f32_16x16x32_bf16 v[72:75], v[44:47], v[200:203], v[72:75]
    ds_read_b128 v[36:39], v3 offset:41984
    v_mfma_f32_16x16x32_bf16 v[76:79], v[44:47], v[204:207], v[76:79]
    s_waitcnt lgkmcnt(4)
    v_mfma_f32_16x16x32_bf16 v[80:83], v[48:51], v[200:203], v[80:83]
    ds_read_b128 v[40:43], v3 offset:43008
    buffer_load_dwordx4 v[240:243], v1, s[28:31], s44 offen offset:2048 sc1
    s_nop 0
    v_mfma_f32_16x16x32_bf16 v[84:87], v[48:51], v[204:207], v[84:87]
    v_permlane16_swap_b32 v120, v122
    v_permlane16_swap_b32 v121, v123
    v_mfma_f32_16x16x32_bf16 v[88:91], v[52:55], v[200:203], v[88:91]
    ds_read_b128 v[44:47], v3 offset:44032
    v_mfma_f32_16x16x32_bf16 v[92:95], v[52:55], v[204:207], v[92:95]
    buffer_load_dwordx4 v[244:247], v1, s[28:31], s45 offen offset:2048 sc1
    v_add_f32 v120, v120, v122
    s_waitcnt lgkmcnt(4)
    v_mfma_f32_16x16x32_bf16 a[252:255], a[248:251], v[56:59], a[252:255]
    ds_read_b128 v[48:51], v3 offset:45056
    v_add_f32 v121, v121, v123
    v_mfma_f32_16x16x32_bf16 a[252:255], a[248:251], v[60:63], a[252:255]
    ds_read_b128 v[52:55], v3 offset:46080
    s_waitcnt lgkmcnt(4) vmcnt(8)
    v_mfma_f32_16x16x32_bf16 v[64:67], v[32:35], v[208:211], v[64:67]
    ds_read_b128 v[56:59], v3 offset:47104
    v_mul_f32 v120, 0xbb000000, v120
    v_mfma_f32_16x16x32_bf16 v[68:71], v[32:35], v[212:215], v[68:71]
L_pad6:
    s_cbranch_execz L_pad10
    buffer_load_dwordx4 v[248:251], v1, s[28:31], s44 offen offset:3072 sc1
    v_mul_f32 v121, 0x3b000000, v121
    v_mfma_f32_16x16x32_bf16 v[72:75], v[36:39], v[208:211], v[72:75]
    ds_read_b128 v[60:63], v3 offset:48128
    v_fma_f32 v121, -v120, v120, v121
    v_mfma_f32_16x16x32_bf16 v[76:79], v[36:39], v[212:215], v[76:79]
    s_waitcnt lgkmcnt(4)
    v_mfma_f32_16x16x32_bf16 v[80:83], v[40:43], v[208:211], v[80:83]
    ds_read_b128 v[32:35], v3 offset:49152
    buffer_load_dwordx4 v[252:255], v1, s[28:31], s45 offen offset:3072 sc1
    v_max_f32 v121, 0, v121
    v_mfma_f32_16x16x32_bf16 v[84:87], v[40:43], v[212:215], v[84:87]
    v_add_f32 v121, 0x3727c5ac, v121
    v_mfma_f32_16x16x32_bf16 v[88:91], v[44:47], v[208:211], v[88:91]
    ds_read_b128 v[36:39], v3 offset:50176
    v_mfma_f32_16x16x32_bf16 v[92:95], v[44:47], v[212:215], v[92:95]
    v_rsq_f32 v121, v121
    s_waitcnt lgkmcnt(4) vmcnt(8)
    v_mfma_f32_16x16x32_bf16 v[64:67], v[48:51], v[216:219], v[64:67]
    ds_read_b128 v[40:43], v3 offset:51200
    s_nop 0
    s_mul_i32 s82, s32, 6144
    s_add_u32 s78, s82, s84
    s_add_u32 m0, s82, 0
    s_add_u32 s79, s78, 188416
    buffer_load_dwordx4 v1, s[28:31], s79 offen offset:0 sc1 lds
    v_mfma_f32_16x16x32_bf16 v[68:71], v[48:51], v[220:223], v[68:71]
    ds_write2_b32 v13, v120, v121 offset0:0 offset1:32
    ds_read2_b32 v[124:125], v12 offset0:0 offset1:16
    v_mfma_f32_16x16x32_bf16 v[72:75], v[52:55], v[216:219], v[72:75]
    ds_read_b128 v[44:47], v3 offset:52224
    v_mfma_f32_16x16x32_bf16 v[76:79], v[52:55], v[220:223], v[76:79]
    buffer_load_dwordx4 v1, s[28:31], s79 offen offset:1024 sc1 lds
    s_waitcnt lgkmcnt(6)
    v_mfma_f32_16x16x32_bf16 v[80:83], v[56:59], v[216:219], v[80:83]
    ds_read_b128 v[48:51], v3 offset:53248
    v_mfma_f32_16x16x32_bf16 v[84:87], v[56:59], v[220:223], v[84:87]
    buffer_load_dwordx4 v1, s[28:31], s79 offen offset:2048 sc1 lds
    v_mfma_f32_16x16x32_bf16 v[88:91], v[60:63], v[216:219], v[88:91]
    ds_read_b128 v[52:55], v3 offset:54272
    v_mfma_f32_16x16x32_bf16 v[92:95], v[60:63], v[220:223], v[92:95]
    s_waitcnt lgkmcnt(6) vmcnt(9)
    v_mfma_f32_16x16x32_bf16 v[64:67], v[32:35], v[224:227], v[64:67]
    ds_read_b128 v[56:59], v3 offset:55296
    v_mfma_f32_16x16x32_bf16 v[68:71], v[32:35], v[228:231], v[68:71]
    buffer_load_dwordx4 v1, s[28:31], s79 offen offset:3072 sc1 lds
    v_mfma_f32_16x16x32_bf16 v[72:75], v[36:39], v[224:227], v[72:75]
    ds_read_b128 v[60:63], v3 offset:56320
    s_barrier
    v_mfma_f32_16x16x32_bf16 v[76:79], v[36:39], v[228:231], v[76:79]
    s_waitcnt lgkmcnt(4)
    v_mfma_f32_16x16x32_bf16 v[80:83], v[40:43], v[224:227], v[80:83]
    ds_read_b128 v[32:35], v3 offset:57344
    s_add_u32 m0, s82, 4096
    s_add_u32 s79, s78, 192512
    buffer_load_dwordx4 v1, s[28:31], s79 offen offset:0 sc1 lds
    v_mfma_f32_16x16x32_bf16 v[84:87], v[40:43], v[228:231], v[84:87]
    buffer_load_dwordx4 v1, s[28:31], s79 offen offset:1024 sc1 lds
    v_mfma_f32_16x16x32_bf16 v[88:91], v[44:47], v[224:227], v[88:91]
    ds_read_b128 v[36:39], v3 offset:58368
    v_mfma_f32_16x16x32_bf16 v[92:95], v[44:47], v[228:231], v[92:95]
    s_waitcnt lgkmcnt(4) vmcnt(10)
    v_mfma_f32_16x16x32_bf16 v[64:67], v[48:51], v[232:235], v[64:67]
    ds_read_b128 v[40:43], v3 offset:59392
    v_mfma_f32_16x16x32_bf16 v[68:71], v[48:51], v[236:239], v[68:71]
    s_add_u32 s87, s86, 16384
    buffer_load_dwordx4 a[64:67], v1, s[28:31], s87 offen offset:0 sc1
    v_mfma_f32_16x16x32_bf16 v[72:75], v[52:55], v[232:235], v[72:75]
    ds_read_b128 v[44:47], v3 offset:60416
    v_mfma_f32_16x16x32_bf16 v[76:79], v[52:55], v[236:239], v[76:79]
    s_waitcnt lgkmcnt(4)
    v_mfma_f32_16x16x32_bf16 v[80:83], v[56:59], v[232:235], v[80:83]
    ds_read_b128 v[48:51], v3 offset:61440
    v_mfma_f32_16x16x32_bf16 v[84:87], v[56:59], v[236:239], v[84:87]
    buffer_load_dwordx4 a[68:71], v1, s[28:31], s87 offen offset:1024 sc1
    v_mfma_f32_16x16x32_bf16 v[88:91], v[60:63], v[232:235], v[88:91]
    ds_read_b128 v[52:55], v3 offset:62464
    v_mfma_f32_16x16x32_bf16 v[92:95], v[60:63], v[236:239], v[92:95]
    s_waitcnt lgkmcnt(4) vmcnt(10)
    v_mfma_f32_16x16x32_bf16 v[64:67], v[32:35], v[240:243], v[64:67]
    ds_read_b128 v[56:59], v3 offset:63488
    v_mfma_f32_16x16x32_bf16 v[68:71], v[32:35], v[244:247], v[68:71]
    v_mfma_f32_16x16x32_bf16 v[72:75], v[36:39], v[240:243], v[72:75]
    ds_read_b128 v[60:63], v3 offset:64512
    v_mfma_f32_16x16x32_bf16 v[76:79], v[36:39], v[244:247], v[76:79]
    s_waitcnt lgkmcnt(4)
    v_mfma_f32_16x16x32_bf16 v[80:83], v[40:43], v[240:243], v[80:83]
    ds_read_b128 v[32:35], v10 offset:0
    v_mfma_f32_16x16x32_bf16 v[84:87], v[40:43], v[244:247], v[84:87]
    buffer_load_dwordx4 a[72:75], v1, s[28:31], s87 offen offset:2048 sc1
    v_mfma_f32_16x16x32_bf16 v[88:91], v[44:47], v[240:243], v[88:91]
    ds_read_b128 v[36:39], v10 offset:1024
    v_mfma_f32_16x16x32_bf16 v[92:95], v[44:47], v[244:247], v[92:95]
    v_accvgpr_read_b32 v14, a225
    s_waitcnt lgkmcnt(4) vmcnt(9)
    v_mfma_f32_16x16x32_bf16 v[64:67], v[48:51], v[248:251], v[64:67]
    ds_read_b128 v[40:43], v10 offset:2048
    v_mfma_f32_16x16x32_bf16 v[68:71], v[48:51], v[252:255], v[68:71]
    buffer_load_dwordx4 a[76:79], v1, s[28:31], s87 offen offset:3072 sc1
    v_mfma_f32_16x16x32_bf16 v[72:75], v[52:55], v[248:251], v[72:75]
    ds_read_b128 v[44:47], v10 offset:3072
    ds_read_b128 v[24:27], v14 offset:384
    v_mfma_f32_16x16x32_bf16 v[76:79], v[52:55], v[252:255], v[76:79]
    ds_read_b128 v[28:31], v14 offset:448
    s_waitcnt lgkmcnt(6)
    v_mfma_f32_16x16x32_bf16 v[80:83], v[56:59], v[248:251], v[80:83]
    ds_read_b128 v[48:51], v10 offset:4096
    ds_read_b128 v[120:123], v14 offset:512
    v_mfma_f32_16x16x32_bf16 v[84:87], v[56:59], v[252:255], v[84:87]
    ds_read_b128 v[4:7], v14 offset:576
    v_mfma_f32_16x16x32_bf16 v[88:91], v[60:63], v[248:251], v[88:91]
    ds_read_b128 v[52:55], v10 offset:5120
    v_mfma_f32_16x16x32_bf16 v[92:95], v[60:63], v[252:255], v[92:95]
    s_add_u32 s87, s86, 20480
    buffer_load_dwordx4 a[80:83], v1, s[28:31], s87 offen offset:0 sc1
    s_waitcnt lgkmcnt(8)
    v_mfma_f32_16x16x32_bf16 v[96:99], v[32:35], v[128:131], 0
    ds_read_b128 v[56:59], v10 offset:6144
    v_mfma_f32_16x16x32_bf16 v[100:103], v[32:35], v[132:135], 0
    s_waitcnt lgkmcnt(2)
    v_fmac_f32 v64, v24, v124
    v_mfma_f32_16x16x32_bf16 v[104:107], v[36:39], v[128:131], 0
    ds_read_b128 v[60:63], v10 offset:7168
    v_fmac_f32 v65, v25, v124
    v_mfma_f32_16x16x32_bf16 v[108:111], v[36:39], v[132:135], 0
    v_fmac_f32 v66, v26, v124
    v_mfma_f32_16x16x32_bf16 v[112:115], v[40:43], v[128:131], 0
    ds_read_b128 v[32:35], v10 offset:8192
    buffer_load_dwordx4 a[84:87], v1, s[28:31], s87 offen offset:1024 sc1
    v_mfma_f32_16x16x32_bf16 v[116:119], v[40:43], v[132:135], 0
    v_fmac_f32 v67, v27, v124
    v_cvt_pk_bf16_f32 v64, v64, v65
    v_cvt_pk_bf16_f32 v65, v66, v67
    v_pk_max_i16 v64, v64, 0
    v_mfma_f32_16x16x32_bf16 v[96:99], v[44:47], v[136:139], v[96:99]
    ds_read_b128 v[36:39], v10 offset:9216
    v_pk_max_i16 v65, v65, 0
    v_fmac_f32 v72, v28, v124
    v_fmac_f32 v73, v29, v124
    v_fmac_f32 v74, v30, v124
    v_mfma_f32_16x16x32_bf16 v[100:103], v[44:47], v[140:143], v[100:103]
    v_fmac_f32 v75, v31, v124
    v_cvt_pk_bf16_f32 v66, v72, v73
    v_cvt_pk_bf16_f32 v67, v74, v75
    v_pk_max_i16 v66, v66, 0
    s_waitcnt lgkmcnt(4)
    v_mfma_f32_16x16x32_bf16 v[104:107], v[48:51], v[136:139], v[104:107]
    ds_read_b128 v[40:43], v10 offset:10240
    v_pk_max_i16 v67, v67, 0
    v_fmac_f32 v68, v24, v125
    v_fmac_f32 v69, v25, v125
    v_fmac_f32 v70, v26, v125
    v_mfma_f32_16x16x32_bf16 v[108:111], v[48:51], v[140:143], v[108:111]
    v_fmac_f32 v71, v27, v125
    v_cvt_pk_bf16_f32 v68, v68, v69
    v_cvt_pk_bf16_f32 v69, v70, v71
    v_pk_max_i16 v68, v68, 0
    v_mfma_f32_16x16x32_bf16 v[112:115], v[52:55], v[136:139], v[112:115]
    ds_read_b128 v[44:47], v10 offset:11264
    v_pk_max_i16 v69, v69, 0
    v_fmac_f32 v76, v28, v125
    v_fmac_f32 v77, v29, v125
    v_fmac_f32 v78, v30, v125
    buffer_load_dwordx4 a[88:91], v1, s[28:31], s87 offen offset:2048 sc1
    v_mfma_f32_16x16x32_bf16 v[116:119], v[52:55], v[140:143], v[116:119]
    v_fmac_f32 v79, v31, v125
    v_cvt_pk_bf16_f32 v70, v76, v77
    v_cvt_pk_bf16_f32 v71, v78, v79
    v_pk_max_i16 v70, v70, 0
    s_waitcnt lgkmcnt(4)
    v_mfma_f32_16x16x32_bf16 v[96:99], v[56:59], v[144:147], v[96:99]
    ds_read_b128 v[48:51], v10 offset:12288
    v_pk_max_i16 v71, v71, 0
    s_sub_u32 s44, s60, 1024
    s_sub_u32 s45, s61, 1024
    buffer_store_dwordx4 v[64:67], v1, s[28:31], s44 offen sc1
    buffer_store_dwordx4 v[68:71], v1, s[28:31], s45 offen sc1
    v_fmac_f32 v80, v120, v124
    v_fmac_f32 v81, v121, v124
    v_mfma_f32_16x16x32_bf16 v[100:103], v[56:59], v[148:151], v[100:103]
    v_fmac_f32 v82, v122, v124
    v_fmac_f32 v83, v123, v124
    v_cvt_pk_bf16_f32 v80, v80, v81
    v_cvt_pk_bf16_f32 v81, v82, v83
    v_mfma_f32_16x16x32_bf16 v[104:107], v[60:63], v[144:147], v[104:107]
    ds_read_b128 v[52:55], v10 offset:13312
    v_pk_max_i16 v80, v80, 0
    v_pk_max_i16 v81, v81, 0
    v_fmac_f32 v88, v4, v124
    v_fmac_f32 v89, v5, v124
    v_mfma_f32_16x16x32_bf16 v[108:111], v[60:63], v[148:151], v[108:111]
    v_fmac_f32 v90, v6, v124
    v_fmac_f32 v91, v7, v124
    v_cvt_pk_bf16_f32 v82, v88, v89
    v_cvt_pk_bf16_f32 v83, v90, v91
    buffer_load_dwordx4 a[92:95], v1, s[28:31], s87 offen offset:3072 sc1
    s_waitcnt lgkmcnt(4)
    v_mfma_f32_16x16x32_bf16 v[112:115], v[32:35], v[144:147], v[112:115]
    ds_read_b128 v[56:59], v10 offset:14336
    v_pk_max_i16 v82, v82, 0
    v_pk_max_i16 v83, v83, 0
    v_fmac_f32 v84, v120, v125
    v_fmac_f32 v85, v121, v125
    v_mfma_f32_16x16x32_bf16 v[116:119], v[32:35], v[148:151], v[116:119]
    v_fmac_f32 v86, v122, v125
    v_fmac_f32 v87, v123, v125
    v_cvt_pk_bf16_f32 v84, v84, v85
    v_cvt_pk_bf16_f32 v85, v86, v87
    v_mfma_f32_16x16x32_bf16 v[96:99], v[36:39], v[152:155], v[96:99]
    ds_read_b128 v[60:63], v10 offset:15360
    v_pk_max_i16 v84, v84, 0
    v_pk_max_i16 v85, v85, 0
    v_fmac_f32 v92, v4, v125
    v_fmac_f32 v93, v5, v125
    v_mfma_f32_16x16x32_bf16 v[100:103], v[36:39], v[156:159], v[100:103]
    v_fmac_f32 v94, v6, v125
    v_fmac_f32 v95, v7, v125
    v_cvt_pk_bf16_f32 v86, v92, v93
    v_cvt_pk_bf16_f32 v87, v94, v95
    s_waitcnt lgkmcnt(4)
    v_mfma_f32_16x16x32_bf16 v[104:107], v[40:43], v[152:155], v[104:107]
    ds_read_b128 v[32:35], v10 offset:16384
    v_pk_max_i16 v86, v86, 0
    v_pk_max_i16 v87, v87, 0
    buffer_store_dwordx4 v[80:83], v1, s[28:31], s60 offen offset:3072 sc1
    buffer_store_dwordx4 v[84:87], v1, s[28:31], s61 offen offset:3072 sc1
    s_lshl_b32 s43, s32, 13
    s_add_u32 s43, s43, s37
    s_add_u32 s87, s86, 24576
    buffer_load_dwordx4 a[96:99], v1, s[28:31], s87 offen offset:0 sc1
    v_mfma_f32_16x16x32_bf16 v[108:111], v[40:43], v[156:159], v[108:111]
    s_lshl_b32 s92, s32, 11
    s_add_u32 s92, s92, 28672
    v_mfma_f32_16x16x32_bf16 v[112:115], v[44:47], v[152:155], v[112:115]
    ds_read_b128 v[36:39], v10 offset:17408
    s_add_u32 s43, s43, 188416
    v_mfma_f32_16x16x32_bf16 v[116:119], v[44:47], v[156:159], v[116:119]
    s_add_u32 s42, s32, 0
    s_and_b32 s42, s42, 3
    s_waitcnt lgkmcnt(4)
    v_mfma_f32_16x16x32_bf16 v[96:99], v[48:51], v[160:163], v[96:99]
    ds_read_b128 v[40:43], v10 offset:18432
    s_lshl2_add_u32 s42, s74, s42
    s_mul_i32 s42, s42, 57344
    v_mfma_f32_16x16x32_bf16 v[100:103], v[48:51], v[164:167], v[100:103]
    s_add_u32 s68, s42, s43
    v_mfma_f32_16x16x32_bf16 v[104:107], v[52:55], v[160:163], v[104:107]
    ds_read_b128 v[44:47], v10 offset:19456
    s_add_u32 s42, s32, 1
    s_and_b32 s42, s42, 3
    buffer_load_dwordx4 a[100:103], v1, s[28:31], s87 offen offset:1024 sc1
    v_mfma_f32_16x16x32_bf16 v[108:111], v[52:55], v[164:167], v[108:111]
    s_lshl2_add_u32 s42, s74, s42
    s_mul_i32 s42, s42, 57344
    s_waitcnt lgkmcnt(4)
    v_mfma_f32_16x16x32_bf16 v[112:115], v[56:59], v[160:163], v[112:115]
    ds_read_b128 v[48:51], v10 offset:20480
    s_add_u32 s69, s42, s43
    v_mfma_f32_16x16x32_bf16 v[116:119], v[56:59], v[164:167], v[116:119]
    s_add_u32 s42, s32, 2
    s_and_b32 s42, s42, 3
    v_mfma_f32_16x16x32_bf16 v[96:99], v[60:63], v[168:171], v[96:99]
    ds_read_b128 v[52:55], v10 offset:21504
    s_lshl2_add_u32 s42, s74, s42
    s_mul_i32 s42, s42, 57344
    v_mfma_f32_16x16x32_bf16 v[100:103], v[60:63], v[172:175], v[100:103]
    s_add_u32 s70, s42, s43
    buffer_load_dwordx4 a[104:107], v1, s[28:31], s87 offen offset:2048 sc1
    s_waitcnt lgkmcnt(4)
    v_mfma_f32_16x16x32_bf16 v[104:107], v[32:35], v[168:171], v[104:107]
    ds_read_b128 v[56:59], v10 offset:22528
    s_add_u32 s42, s32, 3
    s_and_b32 s42, s42, 3
    v_mfma_f32_16x16x32_bf16 v[108:111], v[32:35], v[172:175], v[108:111]
    s_lshl2_add_u32 s42, s74, s42
    s_mul_i32 s42, s42, 57344
    v_mfma_f32_16x16x32_bf16 v[112:115], v[36:39], v[168:171], v[112:115]
    ds_read_b128 v[60:63], v10 offset:23552
    s_add_u32 s71, s42, s43
    v_mfma_f32_16x16x32_bf16 v[116:119], v[36:39], v[172:175], v[116:119]
    s_waitcnt vmcnt(15)
    s_barrier
    v_accvgpr_read_b32 v15, a226
    s_waitcnt lgkmcnt(4)
    v_mfma_f32_16x16x32_bf16 v[96:99], v[40:43], v[176:179], v[96:99]
    ds_read_b128 v[32:35], v9 offset:0
    v_and_b32 v15, 28, v15
    buffer_load_dwordx4 a[108:111], v1, s[28:31], s87 offen offset:3072 sc1
    v_mfma_f32_16x16x32_bf16 v[100:103], v[40:43], v[180:183], v[100:103]
    v_mfma_f32_16x16x32_bf16 v[104:107], v[44:47], v[176:179], v[104:107]
    ds_read_b128 v[36:39], v9 offset:3072
    v_mfma_f32_16x16x32_bf16 v[108:111], v[44:47], v[180:183], v[108:111]
    s_waitcnt lgkmcnt(4)
    v_mfma_f32_16x16x32_bf16 v[112:115], v[48:51], v[176:179], v[112:115]
    ds_read_b128 v[40:43], v1 offset:0
    v_mfma_f32_16x16x32_bf16 v[116:119], v[48:51], v[180:183], v[116:119]
L_pad7:
    s_cbranch_execz L_pad11
    s_add_u32 s87, s86, 28672
    buffer_load_dwordx4 a[112:115], v1, s[28:31], s87 offen offset:0 sc1
    v_mfma_f32_16x16x32_bf16 v[96:99], v[52:55], v[184:187], v[96:99]
    ds_read_b128 v[44:47], v1 offset:1024
    v_mfma_f32_16x16x32_bf16 v[100:103], v[52:55], v[188:191], v[100:103]
    s_waitcnt lgkmcnt(4)
    v_mfma_f32_16x16x32_bf16 v[104:107], v[56:59], v[184:187], v[104:107]
    ds_read_b128 v[48:51], v1 offset:2048
    v_mfma_f32_16x16x32_bf16 v[108:111], v[56:59], v[188:191], v[108:111]
    buffer_load_dwordx4 a[116:119], v1, s[28:31], s87 offen offset:1024 sc1
    v_mfma_f32_16x16x32_bf16 v[112:115], v[60:63], v[184:187], v[112:115]
    ds_read_b128 v[52:55], v9 offset:6144
    v_mfma_f32_16x16x32_bf16 v[116:119], v[60:63], v[188:191], v[116:119]
    s_waitcnt lgkmcnt(4)
    v_mfma_f32_16x16x32_bf16 a[252:255], a[248:251], v[32:35], a[252:255]
    ds_read_b128 v[56:59], v9 offset:9216
    v_mfma_f32_16x16x32_bf16 a[252:255], a[248:251], v[36:39], a[252:255]
    ds_read_b128 v[60:63], v1 offset:3072
    s_waitcnt lgkmcnt(4)
    v_mfma_f32_16x16x32_bf16 v[96:99], v[40:43], v[192:195], v[96:99]
    ds_read_b128 v[32:35], v1 offset:4096
    v_mfma_f32_16x16x32_bf16 v[100:103], v[40:43], v[196:199], v[100:103]
    buffer_load_dwordx4 a[120:123], v1, s[28:31], s87 offen offset:2048 sc1
    v_mfma_f32_16x16x32_bf16 v[104:107], v[44:47], v[192:195], v[104:107]
    ds_read_b128 v[36:39], v1 offset:5120
    v_mfma_f32_16x16x32_bf16 v[108:111], v[44:47], v[196:199], v[108:111]
    s_waitcnt lgkmcnt(4)
    v_mfma_f32_16x16x32_bf16 v[112:115], v[48:51], v[192:195], v[112:115]
    ds_read_b128 v[40:43], v9 offset:12288
    v_mfma_f32_16x16x32_bf16 v[116:119], v[48:51], v[196:199], v[116:119]
    buffer_load_dwordx4 a[124:127], v1, s[28:31], s87 offen offset:3072 sc1
    v_mfma_f32_16x16x32_bf16 a[252:255], a[248:251], v[52:55], a[252:255]
    ds_read_b128 v[44:47], v9 offset:15360
    s_waitcnt lgkmcnt(4)
    v_mfma_f32_16x16x32_bf16 a[252:255], a[248:251], v[56:59], a[252:255]
    ds_read_b128 v[48:51], v1 offset:6144
    v_mfma_f32_16x16x32_bf16 v[96:99], v[60:63], v[200:203], v[96:99]
    ds_read_b128 v[52:55], v1 offset:7168
    v_mfma_f32_16x16x32_bf16 v[100:103], v[60:63], v[204:207], v[100:103]
    s_waitcnt lgkmcnt(4)
    v_mfma_f32_16x16x32_bf16 v[104:107], v[32:35], v[200:203], v[104:107]
    ds_read_b128 v[56:59], v1 offset:8192
    v_mfma_f32_16x16x32_bf16 v[108:111], v[32:35], v[204:207], v[108:111]
    s_add_u32 s87, s86, 32768
    buffer_load_dwordx4 a[128:131], v1, s[28:31], s87 offen offset:0 sc1
    v_mfma_f32_16x16x32_bf16 v[112:115], v[36:39], v[200:203], v[112:115]
    ds_read_b128 v[60:63], v9 offset:18432
    v_mfma_f32_16x16x32_bf16 v[116:119], v[36:39], v[204:207], v[116:119]
    s_waitcnt lgkmcnt(4)
    v_mfma_f32_16x16x32_bf16 a[252:255], a[248:251], v[40:43], a[252:255]
    ds_read_b128 v[32:35], v9 offset:21504
    v_mfma_f32_16x16x32_bf16 a[252:255], a[248:251], v[44:47], a[252:255]
    ds_read_b128 v[36:39], v1 offset:9216
    s_waitcnt lgkmcnt(4)
    v_mfma_f32_16x16x32_bf16 v[96:99], v[48:51], v[208:211], v[96:99]
    ds_read_b128 v[40:43], v1 offset:10240
    v_mfma_f32_16x16x32_bf16 v[100:103], v[48:51], v[212:215], v[100:103]
    buffer_load_dwordx4 a[132:135], v1, s[28:31], s87 offen offset:1024 sc1
    v_mfma_f32_16x16x32_bf16 v[104:107], v[52:55], v[208:211], v[104:107]
    ds_read_b128 v[44:47], v1 offset:11264
    v_mfma_f32_16x16x32_bf16 v[108:111], v[52:55], v[212:215], v[108:111]
    s_waitcnt lgkmcnt(4)
    v_mfma_f32_16x16x32_bf16 v[112:115], v[56:59], v[208:211], v[112:115]
    ds_read_b128 v[48:51], v1 offset:12288
    v_mov_b32 v13, s35
    s_waitcnt vmcnt(10)
    s_mov_b64 exec, 1
    s_cmp_lg_u32 s36, 0
    s_cbranch_scc1 L_ss_29
    buffer_store_dword v13, v1, s[28:31], s66 offen offset:1536
L_se_30:
    s_mov_b64 exec, -1
    v_mfma_f32_16x16x32_bf16 v[116:119], v[56:59], v[212:215], v[116:119]
    buffer_load_dwordx4 a[136:139], v1, s[28:31], s87 offen offset:2048 sc1
    v_mfma_f32_16x16x32_bf16 a[252:255], a[248:251], v[60:63], a[252:255]
    ds_read_b128 v[52:55], v1 offset:13312
    s_waitcnt lgkmcnt(4)
    v_mfma_f32_16x16x32_bf16 a[252:255], a[248:251], v[32:35], a[252:255]
    ds_read_b128 v[56:59], v1 offset:14336
    v_mfma_f32_16x16x32_bf16 v[96:99], v[36:39], v[216:219], v[96:99]
    ds_read_b128 v[60:63], v1 offset:15360
    v_mfma_f32_16x16x32_bf16 v[100:103], v[36:39], v[220:223], v[100:103]
    s_waitcnt lgkmcnt(4)
    v_mfma_f32_16x16x32_bf16 v[104:107], v[40:43], v[216:219], v[104:107]
    ds_read_b128 v[32:35], v1 offset:16384
    v_mfma_f32_16x16x32_bf16 v[108:111], v[40:43], v[220:223], v[108:111]
    buffer_load_dwordx4 a[140:143], v1, s[28:31], s87 offen offset:3072 sc1
    v_mfma_f32_16x16x32_bf16 v[112:115], v[44:47], v[216:219], v[112:115]
    ds_read_b128 v[36:39], v1 offset:17408
    v_mfma_f32_16x16x32_bf16 v[116:119], v[44:47], v[220:223], v[116:119]
    s_waitcnt lgkmcnt(4)
    v_mfma_f32_16x16x32_bf16 v[96:99], v[48:51], v[224:227], v[96:99]
    ds_read_b128 v[40:43], v1 offset:18432
    v_mfma_f32_16x16x32_bf16 v[100:103], v[48:51], v[228:231], v[100:103]
    v_accvgpr_read_b32 v4, a224
    s_lshl_b32 s47, s85, 6
    v_add_u32 v4, s47, v4
    ds_write_b32 v4, a252 offset:640
    v_mfma_f32_16x16x32_bf16 v[104:107], v[52:55], v[224:227], v[104:107]
    ds_read_b128 v[44:47], v1 offset:19456
    v_mfma_f32_16x16x32_bf16 v[108:111], v[52:55], v[228:231], v[108:111]
    s_add_u32 s87, s86, 36864
    buffer_load_dwordx4 a[144:147], v1, s[28:31], s87 offen offset:0 sc1
    s_waitcnt lgkmcnt(5)
    v_mfma_f32_16x16x32_bf16 v[112:115], v[56:59], v[224:227], v[112:115]
    ds_read_b128 v[48:51], v1 offset:20480
    v_mfma_f32_16x16x32_bf16 v[116:119], v[56:59], v[228:231], v[116:119]
    v_mfma_f32_16x16x32_bf16 v[96:99], v[60:63], v[232:235], v[96:99]
    ds_read_b128 v[52:55], v1 offset:21504
    v_mfma_f32_16x16x32_bf16 v[100:103], v[60:63], v[236:239], v[100:103]
    s_waitcnt lgkmcnt(5)
    v_mfma_f32_16x16x32_bf16 v[104:107], v[32:35], v[232:235], v[104:107]
    ds_read_b128 v[56:59], v1 offset:22528
    v_mfma_f32_16x16x32_bf16 v[108:111], v[32:35], v[236:239], v[108:111]
    buffer_load_dwordx4 a[148:151], v1, s[28:31], s87 offen offset:1024 sc1
    v_mfma_f32_16x16x32_bf16 v[112:115], v[36:39], v[232:235], v[112:115]
    ds_read_b128 v[60:63], v1 offset:23552
    v_mfma_f32_16x16x32_bf16 v[116:119], v[36:39], v[236:239], v[116:119]
    s_waitcnt lgkmcnt(5)
    s_barrier
    s_waitcnt lgkmcnt(4)
    v_mfma_f32_16x16x32_bf16 v[96:99], v[40:43], v[240:243], v[96:99]
    ds_read_b128 v[24:27], v14 offset:640
    v_mfma_f32_16x16x32_bf16 v[100:103], v[40:43], v[244:247], v[100:103]
    buffer_load_dwordx4 a[152:155], v1, s[28:31], s87 offen offset:2048 sc1
    v_mfma_f32_16x16x32_bf16 v[104:107], v[44:47], v[240:243], v[104:107]
    ds_read_b128 v[28:31], v14 offset:704
    ds_read_b128 v[120:123], v14 offset:768
    v_mfma_f32_16x16x32_bf16 v[108:111], v[44:47], v[244:247], v[108:111]
    s_waitcnt lgkmcnt(5)
    v_mfma_f32_16x16x32_bf16 v[112:115], v[48:51], v[240:243], v[112:115]
    buffer_load_dwordx4 a[156:159], v1, s[28:31], s87 offen offset:3072 sc1
    v_mfma_f32_16x16x32_bf16 v[116:119], v[48:51], v[244:247], v[116:119]
    v_mfma_f32_16x16x32_bf16 v[96:99], v[52:55], v[248:251], v[96:99]
    v_mfma_f32_16x16x32_bf16 v[100:103], v[52:55], v[252:255], v[100:103]
    s_waitcnt lgkmcnt(3)
    v_mfma_f32_16x16x32_bf16 v[104:107], v[56:59], v[248:251], v[104:107]
    v_mfma_f32_16x16x32_bf16 v[108:111], v[56:59], v[252:255], v[108:111]
    v_mfma_f32_16x16x32_bf16 v[112:115], v[60:63], v[248:251], v[112:115]
    v_mfma_f32_16x16x32_bf16 v[116:119], v[60:63], v[252:255], v[116:119]
    buffer_load_dword v12, v15, s[28:31], s67 offen offset:1536 sc1
    s_nop 3
    s_waitcnt lgkmcnt(0)
    v_fmac_f32 v96, v24, v124
    v_fmac_f32 v97, v25, v124
    v_fmac_f32 v98, v26, v124
    v_fmac_f32 v99, v27, v124
    v_cvt_pk_bf16_f32 v48, v96, v97
    v_cvt_pk_bf16_f32 v49, v98, v99
    v_pk_max_i16 v48, v48, 0
    v_pk_max_i16 v49, v49, 0
    v_fmac_f32 v100, v24, v125
    v_fmac_f32 v101, v25, v125
    v_fmac_f32 v102, v26, v125
    v_fmac_f32 v103, v27, v125
    v_cvt_pk_bf16_f32 v56, v100, v101
    v_cvt_pk_bf16_f32 v57, v102, v103
    v_pk_max_i16 v56, v56, 0
    v_pk_max_i16 v57, v57, 0
    v_fmac_f32 v104, v28, v124
    v_fmac_f32 v105, v29, v124
    v_fmac_f32 v106, v30, v124
    v_fmac_f32 v107, v31, v124
    v_cvt_pk_bf16_f32 v50, v104, v105
    v_cvt_pk_bf16_f32 v51, v106, v107
    v_pk_max_i16 v50, v50, 0
    v_pk_max_i16 v51, v51, 0
    v_fmac_f32 v108, v28, v125
    v_fmac_f32 v109, v29, v125
    v_fmac_f32 v110, v30, v125
    v_fmac_f32 v111, v31, v125
    v_cvt_pk_bf16_f32 v58, v108, v109
    v_cvt_pk_bf16_f32 v59, v110, v111
    v_pk_max_i16 v58, v58, 0
    v_pk_max_i16 v59, v59, 0
    v_fmac_f32 v112, v120, v124
    v_fmac_f32 v113, v121, v124
    v_fmac_f32 v114, v122, v124
    v_fmac_f32 v115, v123, v124
    v_cvt_pk_bf16_f32 v52, v112, v113
    v_cvt_pk_bf16_f32 v53, v114, v115
    v_pk_max_i16 v52, v52, 0
    v_pk_max_i16 v53, v53, 0
    v_fmac_f32 v116, v120, v125
    v_fmac_f32 v117, v121, v125
    v_fmac_f32 v118, v122, v125
    v_fmac_f32 v119, v123, v125
    v_cvt_pk_bf16_f32 v60, v116, v117
    v_cvt_pk_bf16_f32 v61, v118, v119
    v_pk_max_i16 v60, v60, 0
    v_pk_max_i16 v61, v61, 0
    s_cmp_lg_u32 s36, 0
    s_cbranch_scc1 L_ss_31
    buffer_store_dwordx4 v[48:51], v1, s[28:31], s62 offen
    buffer_store_dwordx2 v[52:53], v1, s[28:31], s64 offen
    buffer_store_dwordx4 v[56:59], v1, s[28:31], s63 offen
    buffer_store_dwordx2 v[60:61], v1, s[28:31], s65 offen
L_se_32:
    s_waitcnt vmcnt(4)
    v_cmp_ne_u32 vcc, s35, v12
    s_cbranch_vccnz L_ap_34
L_aok_33:
    buffer_load_dwordx4 v[128:131], v1, s[28:31], s68 offen offset:0 sc1
    s_lshl_b32 s47, s32, 14
    s_add_u32 s47, s47, 65536
    v_add_u32 v9, s47, v1
    buffer_load_dwordx4 v[132:135], v1, s[28:31], s69 offen offset:0 sc1
    ds_read_b128 v[192:195], v9 offset:0
    ds_read_b128 v[196:199], v9 offset:1024
    buffer_load_dwordx4 v[136:139], v1, s[28:31], s70 offen offset:0 sc1
    ds_read_b128 v[200:203], v9 offset:2048
    ds_read_b128 v[204:207], v9 offset:3072
    buffer_load_dwordx4 v[140:143], v1, s[28:31], s71 offen offset:0 sc1
    ds_read_b128 v[208:211], v9 offset:4096
    ds_read_b128 v[212:215], v9 offset:5120
    buffer_load_dwordx4 v[144:147], v1, s[28:31], s68 offen offset:1024 sc1
    ds_read_b128 v[216:219], v9 offset:6144
    ds_read_b128 v[220:223], v9 offset:7168
    buffer_load_dwordx4 v[148:151], v1, s[28:31], s69 offen offset:1024 sc1
    ds_read_b128 v[224:227], v9 offset:8192
    ds_read_b128 v[228:231], v9 offset:9216
    buffer_load_dwordx4 v[152:155], v1, s[28:31], s70 offen offset:1024 sc1
    ds_read_b128 v[232:235], v9 offset:10240
    ds_read_b128 v[236:239], v9 offset:11264
    buffer_load_dwordx4 v[156:159], v1, s[28:31], s71 offen offset:1024 sc1
    ds_read_b128 v[240:243], v9 offset:12288
    ds_read_b128 v[244:247], v9 offset:13312
    buffer_load_dwordx4 v[160:163], v1, s[28:31], s68 offen offset:2048 sc1
    ds_read_b128 v[248:251], v9 offset:14336
    ds_read_b128 v[252:255], v9 offset:15360
    buffer_load_dwordx4 v[164:167], v1, s[28:31], s69 offen offset:2048 sc1
    s_lshr_b32 s78, s33, 1
    s_xor_b32 s78, s78, s34
    s_and_b32 s78, s78, 1
    s_and_b32 s79, s33, 1
    s_lshl1_add_u32 s78, s78, s79
    s_add_u32 s79, s78, 0
    s_and_b32 s79, s79, 3
    s_lshl_b32 s79, s79, 12
    s_add_u32 s88, s79, 32768
    s_add_u32 s79, s78, 1
    s_and_b32 s79, s79, 3
    s_lshl_b32 s79, s79, 12
    s_add_u32 s89, s79, 32768
    s_add_u32 s79, s78, 2
    s_and_b32 s79, s79, 3
    s_lshl_b32 s79, s79, 12
    s_add_u32 s90, s79, 32768
    s_add_u32 s79, s78, 3
    s_and_b32 s79, s79, 3
    s_lshl_b32 s79, s79, 12
    s_add_u32 s91, s79, 32768
    v_mov_b32 v13, s35
    s_waitcnt vmcnt(10)
    s_mov_b64 exec, 1
    s_cmp_lg_u32 s36, 0
    s_cbranch_scc1 L_ss_35
    buffer_store_dword v13, v1, s[28:31], s66 offen offset:2560
L_se_36:
    s_mov_b64 exec, -1
    v_accvgpr_read_b32 v25, a244
    ds_read_b32 v24, v25
    s_waitcnt vmcnt(10)
    v_mfma_f32_16x16x32_bf16 v[64:67], a[0:3], v[128:131], 0
    buffer_load_dwordx4 v[168:171], v1, s[28:31], s70 offen offset:2048 sc1
    v_mfma_f32_16x16x32_bf16 v[68:71], a[4:7], v[128:131], 0
    s_waitcnt lgkmcnt(1)
    s_barrier
    v_mfma_f32_16x16x32_bf16 v[72:75], a[8:11], v[128:131], 0
    v_mfma_f32_16x16x32_bf16 v[76:79], a[12:15], v[128:131], 0
    s_lshl_b32 s47, s32, 12
    v_add_u32 v8, s47, v1
    ds_write_b128 v8, a[160:163] offset:0
    s_waitcnt vmcnt(10)
    v_mfma_f32_16x16x32_bf16 v[80:83], a[0:3], v[132:135], 0
    buffer_load_dwordx4 v[172:175], v1, s[28:31], s71 offen offset:2048 sc1
    v_mfma_f32_16x16x32_bf16 v[84:87], a[4:7], v[132:135], 0
    ds_write_b128 v8, a[164:167] offset:1024
    v_mfma_f32_16x16x32_bf16 v[88:91], a[8:11], v[132:135], 0
    v_mfma_f32_16x16x32_bf16 v[92:95], a[12:15], v[132:135], 0
    ds_write_b128 v8, a[168:171] offset:2048
    s_waitcnt vmcnt(10)
    v_mfma_f32_16x16x32_bf16 v[96:99], a[0:3], v[136:139], 0
    buffer_load_dwordx4 v[176:179], v1, s[28:31], s68 offen offset:3072 sc1
    v_mfma_f32_16x16x32_bf16 v[100:103], a[4:7], v[136:139], 0
    ds_write_b128 v8, a[172:175] offset:3072
    v_mfma_f32_16x16x32_bf16 v[104:107], a[8:11], v[136:139], 0
    v_mfma_f32_16x16x32_bf16 v[108:111], a[12:15], v[136:139], 0
    ds_write_b128 v8, a[176:179] offset:16384
    s_waitcnt vmcnt(10)
    v_mfma_f32_16x16x32_bf16 v[112:115], a[0:3], v[140:143], 0
    buffer_load_dwordx4 v[180:183], v1, s[28:31], s69 offen offset:3072 sc1
    v_mfma_f32_16x16x32_bf16 v[116:119], a[4:7], v[140:143], 0
    ds_write_b128 v8, a[180:183] offset:17408
    v_mfma_f32_16x16x32_bf16 v[120:123], a[8:11], v[140:143], 0
    s_waitcnt lgkmcnt(2)
    s_add_u32 s87, s86, 40960
    buffer_load_dwordx4 a[160:163], v1, s[28:31], s87 offen offset:0 sc1
    v_mfma_f32_16x16x32_bf16 v[124:127], a[12:15], v[140:143], 0
    s_waitcnt vmcnt(11)
    v_mfma_f32_16x16x32_bf16 v[64:67], a[32:35], v[144:147], v[64:67]
    buffer_load_dwordx4 v[184:187], v1, s[28:31], s70 offen offset:3072 sc1
    v_mfma_f32_16x16x32_bf16 v[68:71], a[36:39], v[144:147], v[68:71]
    ds_write_b128 v8, a[184:187] offset:18432
    v_mfma_f32_16x16x32_bf16 v[72:75], a[40:43], v[144:147], v[72:75]
    buffer_load_dwordx4 a[164:167], v1, s[28:31], s87 offen offset:1024 sc1
L_pad8:
    s_cbranch_execz L_pad12
    v_mfma_f32_16x16x32_bf16 v[76:79], a[44:47], v[144:147], v[76:79]
    s_waitcnt vmcnt(12)
    v_mfma_f32_16x16x32_bf16 v[80:83], a[32:35], v[148:151], v[80:83]
    buffer_load_dwordx4 v[188:191], v1, s[28:31], s71 offen offset:3072 sc1
    v_mfma_f32_16x16x32_bf16 v[84:87], a[36:39], v[148:151], v[84:87]
    ds_write_b128 v8, a[188:191] offset:19456
    v_mfma_f32_16x16x32_bf16 v[88:91], a[40:43], v[148:151], v[88:91]
    buffer_load_dwordx4 a[168:171], v1, s[28:31], s87 offen offset:2048 sc1
    v_mfma_f32_16x16x32_bf16 v[92:95], a[44:47], v[148:151], v[92:95]
    s_waitcnt vmcnt(13)
    v_mfma_f32_16x16x32_bf16 v[96:99], a[32:35], v[152:155], v[96:99]
    s_add_u32 s68, s68, 4096
    buffer_load_dwordx4 v[128:131], v1, s[28:31], s68 offen offset:0 sc1
    v_mfma_f32_16x16x32_bf16 v[100:103], a[36:39], v[152:155], v[100:103]
    s_lshl_b32 s47, s32, 11
    s_add_u32 s47, s47, 65536
    v_add_u32 v8, s47, v1
    ds_write_b128 v8, a[192:195] offset:0
    v_mfma_f32_16x16x32_bf16 v[104:107], a[40:43], v[152:155], v[104:107]
    buffer_load_dwordx4 a[172:175], v1, s[28:31], s87 offen offset:3072 sc1
    v_mfma_f32_16x16x32_bf16 v[108:111], a[44:47], v[152:155], v[108:111]
    s_waitcnt vmcnt(14)
    v_mfma_f32_16x16x32_bf16 v[112:115], a[32:35], v[156:159], v[112:115]
    s_add_u32 s69, s69, 4096
    buffer_load_dwordx4 v[132:135], v1, s[28:31], s69 offen offset:0 sc1
    v_mfma_f32_16x16x32_bf16 v[116:119], a[36:39], v[156:159], v[116:119]
    ds_write_b128 v8, a[196:199] offset:1024
    v_mfma_f32_16x16x32_bf16 v[120:123], a[40:43], v[156:159], v[120:123]
    s_waitcnt lgkmcnt(2)
    s_add_u32 s87, s86, 45056
    buffer_load_dwordx4 a[176:179], v1, s[28:31], s87 offen offset:0 sc1
    v_mfma_f32_16x16x32_bf16 v[124:127], a[44:47], v[156:159], v[124:127]
    s_waitcnt vmcnt(15)
    v_mfma_f32_16x16x32_bf16 v[64:67], a[64:67], v[160:163], v[64:67]
    s_add_u32 s70, s70, 4096
    buffer_load_dwordx4 v[136:139], v1, s[28:31], s70 offen offset:0 sc1
    v_mfma_f32_16x16x32_bf16 v[68:71], a[68:71], v[160:163], v[68:71]
    ds_write_b128 v8, a[200:203] offset:8192
    v_lshlrev_b32 v32, 16, v16
    v_mfma_f32_16x16x32_bf16 v[72:75], a[72:75], v[160:163], v[72:75]
    buffer_load_dwordx4 a[180:183], v1, s[28:31], s87 offen offset:1024 sc1
    v_mfma_f32_16x16x32_bf16 v[76:79], a[76:79], v[160:163], v[76:79]
    s_waitcnt vmcnt(16)
    v_mfma_f32_16x16x32_bf16 v[80:83], a[64:67], v[164:167], v[80:83]
    s_add_u32 s71, s71, 4096
    buffer_load_dwordx4 v[140:143], v1, s[28:31], s71 offen offset:0 sc1
    v_mfma_f32_16x16x32_bf16 v[84:87], a[68:71], v[164:167], v[84:87]
    ds_write_b128 v8, a[204:207] offset:9216
    v_and_b32 v33, 0xffff0000, v16
    v_mfma_f32_16x16x32_bf16 v[88:91], a[72:75], v[164:167], v[88:91]
    buffer_load_dwordx4 a[184:187], v1, s[28:31], s87 offen offset:2048 sc1
    v_mfma_f32_16x16x32_bf16 v[92:95], a[76:79], v[164:167], v[92:95]
    s_waitcnt vmcnt(16)
    v_mfma_f32_16x16x32_bf16 v[96:99], a[64:67], v[168:171], v[96:99]
    buffer_load_dwordx4 v[144:147], v1, s[28:31], s68 offen offset:1024 sc1
    v_mfma_f32_16x16x32_bf16 v[100:103], a[68:71], v[168:171], v[100:103]
    ds_write_b128 v8, a[208:211] offset:16384
    v_lshlrev_b32 v34, 16, v17
    v_mfma_f32_16x16x32_bf16 v[104:107], a[72:75], v[168:171], v[104:107]
    buffer_load_dwordx4 a[188:191], v1, s[28:31], s87 offen offset:3072 sc1
    v_mfma_f32_16x16x32_bf16 v[108:111], a[76:79], v[168:171], v[108:111]
    s_waitcnt vmcnt(17)
    v_mfma_f32_16x16x32_bf16 v[112:115], a[64:67], v[172:175], v[112:115]
    buffer_load_dwordx4 v[148:151], v1, s[28:31], s69 offen offset:1024 sc1
    v_mfma_f32_16x16x32_bf16 v[116:119], a[68:71], v[172:175], v[116:119]
    ds_write_b128 v8, a[212:215] offset:17408
    v_and_b32 v35, 0xffff0000, v17
    v_mfma_f32_16x16x32_bf16 v[120:123], a[72:75], v[172:175], v[120:123]
    s_waitcnt lgkmcnt(2)
    s_add_u32 s87, s86, 49152
    buffer_load_dwordx4 a[192:195], v1, s[28:31], s87 offen offset:0 sc1
    v_mfma_f32_16x16x32_bf16 v[124:127], a[76:79], v[172:175], v[124:127]
    s_waitcnt vmcnt(18)
    v_mfma_f32_16x16x32_bf16 v[64:67], a[96:99], v[176:179], v[64:67]
    buffer_load_dwordx4 v[152:155], v1, s[28:31], s70 offen offset:1024 sc1
    v_mfma_f32_16x16x32_bf16 v[68:71], a[100:103], v[176:179], v[68:71]
    ds_write_b128 v8, a[216:219] offset:24576
    v_lshlrev_b32 v36, 16, v18
    v_mfma_f32_16x16x32_bf16 v[72:75], a[104:107], v[176:179], v[72:75]
    buffer_load_dwordx4 a[196:199], v1, s[28:31], s87 offen offset:1024 sc1
    v_mfma_f32_16x16x32_bf16 v[76:79], a[108:111], v[176:179], v[76:79]
    s_waitcnt vmcnt(19)
    v_mfma_f32_16x16x32_bf16 v[80:83], a[96:99], v[180:183], v[80:83]
    buffer_load_dwordx4 v[156:159], v1, s[28:31], s71 offen offset:1024 sc1
    v_mfma_f32_16x16x32_bf16 v[84:87], a[100:103], v[180:183], v[84:87]
    ds_write_b128 v8, a[220:223] offset:25600
    v_and_b32 v37, 0xffff0000, v18
    v_mfma_f32_16x16x32_bf16 v[88:91], a[104:107], v[180:183], v[88:91]
    buffer_load_dwordx4 a[200:203], v1, s[28:31], s87 offen offset:2048 sc1
    v_mfma_f32_16x16x32_bf16 v[92:95], a[108:111], v[180:183], v[92:95]
    s_waitcnt vmcnt(19)
    v_mfma_f32_16x16x32_bf16 v[96:99], a[96:99], v[184:187], v[96:99]
    buffer_load_dwordx4 v[160:163], v1, s[28:31], s68 offen offset:2048 sc1
    v_mfma_f32_16x16x32_bf16 v[100:103], a[100:103], v[184:187], v[100:103]
    v_lshlrev_b32 v38, 16, v19
    v_mfma_f32_16x16x32_bf16 v[104:107], a[104:107], v[184:187], v[104:107]
    buffer_load_dwordx4 a[204:207], v1, s[28:31], s87 offen offset:3072 sc1
    v_mfma_f32_16x16x32_bf16 v[108:111], a[108:111], v[184:187], v[108:111]
    s_waitcnt vmcnt(19)
    v_mfma_f32_16x16x32_bf16 v[112:115], a[96:99], v[188:191], v[112:115]
    buffer_load_dword v12, v15, s[28:31], s67 offen offset:2560 sc1
    buffer_load_dwordx4 v[164:167], v1, s[28:31], s69 offen offset:2048 sc1
    v_mfma_f32_16x16x32_bf16 v[116:119], a[100:103], v[188:191], v[116:119]
    v_and_b32 v39, 0xffff0000, v19
    v_mfma_f32_16x16x32_bf16 v[120:123], a[104:107], v[188:191], v[120:123]
    s_waitcnt lgkmcnt(0)
    s_add_u32 s87, s86, 53248
    buffer_load_dwordx4 a[208:211], v1, s[28:31], s87 offen offset:0 sc1
    v_mfma_f32_16x16x32_bf16 v[124:127], a[108:111], v[188:191], v[124:127]
    s_waitcnt vmcnt(20)
    v_mfma_f32_16x16x32_bf16 v[64:67], a[16:19], v[128:131], v[64:67]
    buffer_load_dwordx4 v[168:171], v1, s[28:31], s70 offen offset:2048 sc1
    v_mfma_f32_16x16x32_bf16 v[68:71], a[20:23], v[128:131], v[68:71]
    v_lshlrev_b32 v40, 16, v20
    v_mfma_f32_16x16x32_bf16 v[72:75], a[24:27], v[128:131], v[72:75]
    buffer_load_dwordx4 a[212:215], v1, s[28:31], s87 offen offset:1024 sc1
    v_mfma_f32_16x16x32_bf16 v[76:79], a[28:31], v[128:131], v[76:79]
    s_waitcnt vmcnt(20)
    v_mfma_f32_16x16x32_bf16 v[80:83], a[16:19], v[132:135], v[80:83]
    buffer_load_dwordx4 v[172:175], v1, s[28:31], s71 offen offset:2048 sc1
    v_mfma_f32_16x16x32_bf16 v[84:87], a[20:23], v[132:135], v[84:87]
    v_and_b32 v41, 0xffff0000, v20
    v_mfma_f32_16x16x32_bf16 v[88:91], a[24:27], v[132:135], v[88:91]
    buffer_load_dwordx4 a[216:219], v1, s[28:31], s87 offen offset:2048 sc1
    v_mfma_f32_16x16x32_bf16 v[92:95], a[28:31], v[132:135], v[92:95]
    s_waitcnt vmcnt(20)
    v_mfma_f32_16x16x32_bf16 v[96:99], a[16:19], v[136:139], v[96:99]
    buffer_load_dwordx4 v[176:179], v1, s[28:31], s68 offen offset:3072 sc1
    v_mfma_f32_16x16x32_bf16 v[100:103], a[20:23], v[136:139], v[100:103]
    v_lshlrev_b32 v42, 16, v21
    v_mfma_f32_16x16x32_bf16 v[104:107], a[24:27], v[136:139], v[104:107]
    buffer_load_dwordx4 a[220:223], v1, s[28:31], s87 offen offset:3072 sc1
    v_mfma_f32_16x16x32_bf16 v[108:111], a[28:31], v[136:139], v[108:111]
    s_waitcnt vmcnt(20)
    v_mfma_f32_16x16x32_bf16 v[112:115], a[16:19], v[140:143], v[112:115]
    buffer_load_dwordx4 v[180:183], v1, s[28:31], s69 offen offset:3072 sc1
    v_mfma_f32_16x16x32_bf16 v[116:119], a[20:23], v[140:143], v[116:119]
    v_and_b32 v43, 0xffff0000, v21
    v_mfma_f32_16x16x32_bf16 v[120:123], a[24:27], v[140:143], v[120:123]
    v_mfma_f32_16x16x32_bf16 v[124:127], a[28:31], v[140:143], v[124:127]
    s_waitcnt vmcnt(19)
    v_mfma_f32_16x16x32_bf16 v[64:67], a[48:51], v[144:147], v[64:67]
    buffer_load_dwordx4 v[184:187], v1, s[28:31], s70 offen offset:3072 sc1
    v_mfma_f32_16x16x32_bf16 v[68:71], a[52:55], v[144:147], v[68:71]
    v_lshlrev_b32 v44, 16, v22
    v_mfma_f32_16x16x32_bf16 v[72:75], a[56:59], v[144:147], v[72:75]
    v_mfma_f32_16x16x32_bf16 v[76:79], a[60:63], v[144:147], v[76:79]
    s_waitcnt vmcnt(18)
    v_mfma_f32_16x16x32_bf16 v[80:83], a[48:51], v[148:151], v[80:83]
    buffer_load_dwordx4 v[188:191], v1, s[28:31], s71 offen offset:3072 sc1
    v_mfma_f32_16x16x32_bf16 v[84:87], a[52:55], v[148:151], v[84:87]
    v_and_b32 v45, 0xffff0000, v22
    v_mfma_f32_16x16x32_bf16 v[88:91], a[56:59], v[148:151], v[88:91]
    v_mfma_f32_16x16x32_bf16 v[92:95], a[60:63], v[148:151], v[92:95]
    s_waitcnt vmcnt(17)
    v_mfma_f32_16x16x32_bf16 v[96:99], a[48:51], v[152:155], v[96:99]
    s_waitcnt vmcnt(11)
    v_cmp_ne_u32 vcc, s35, v12
    s_cbranch_vccnz L_ap_38
L_aok_37:
    s_sub_u32 s68, s68, s92
    buffer_load_dwordx4 v[128:131], v1, s[28:31], s68 offen offset:0 sc1
    v_mfma_f32_16x16x32_bf16 v[100:103], a[52:55], v[152:155], v[100:103]
    v_lshlrev_b32 v46, 16, v23
    v_mfma_f32_16x16x32_bf16 v[104:107], a[56:59], v[152:155], v[104:107]
    v_mfma_f32_16x16x32_bf16 v[108:111], a[60:63], v[152:155], v[108:111]
    v_mfma_f32_16x16x32_bf16 v[112:115], a[48:51], v[156:159], v[112:115]
    s_sub_u32 s69, s69, s92
    buffer_load_dwordx4 v[132:135], v1, s[28:31], s69 offen offset:0 sc1
    v_mfma_f32_16x16x32_bf16 v[116:119], a[52:55], v[156:159], v[116:119]
    v_and_b32 v47, 0xffff0000, v23
    v_mfma_f32_16x16x32_bf16 v[120:123], a[56:59], v[156:159], v[120:123]
    v_mfma_f32_16x16x32_bf16 v[124:127], a[60:63], v[156:159], v[124:127]
    v_mfma_f32_16x16x32_bf16 v[64:67], a[80:83], v[160:163], v[64:67]
    s_sub_u32 s70, s70, s92
    buffer_load_dwordx4 v[136:139], v1, s[28:31], s70 offen offset:0 sc1
    v_mfma_f32_16x16x32_bf16 v[68:71], a[84:87], v[160:163], v[68:71]
    v_accvgpr_read_b32 v28, a240
    v_mfma_f32_16x16x32_bf16 v[72:75], a[88:91], v[160:163], v[72:75]
    v_mfma_f32_16x16x32_bf16 v[76:79], a[92:95], v[160:163], v[76:79]
    s_waitcnt vmcnt(13)
    v_mfma_f32_16x16x32_bf16 v[80:83], a[80:83], v[164:167], v[80:83]
    s_sub_u32 s71, s71, s92
    buffer_load_dwordx4 v[140:143], v1, s[28:31], s71 offen offset:0 sc1
    v_mfma_f32_16x16x32_bf16 v[84:87], a[84:87], v[164:167], v[84:87]
    v_accvgpr_read_b32 v29, a241
    v_mfma_f32_16x16x32_bf16 v[88:91], a[88:91], v[164:167], v[88:91]
    v_mfma_f32_16x16x32_bf16 v[92:95], a[92:95], v[164:167], v[92:95]
    s_waitcnt vmcnt(12)
    v_mfma_f32_16x16x32_bf16 v[96:99], a[80:83], v[168:171], v[96:99]
    buffer_load_dwordx4 v[144:147], v1, s[28:31], s68 offen offset:1024 sc1
    v_mfma_f32_16x16x32_bf16 v[100:103], a[84:87], v[168:171], v[100:103]
    v_accvgpr_read_b32 v30, a242
    v_mfma_f32_16x16x32_bf16 v[104:107], a[88:91], v[168:171], v[104:107]
    v_mfma_f32_16x16x32_bf16 v[108:111], a[92:95], v[168:171], v[108:111]
    s_waitcnt vmcnt(11)
    v_mfma_f32_16x16x32_bf16 v[112:115], a[80:83], v[172:175], v[112:115]
    buffer_load_dwordx4 v[148:151], v1, s[28:31], s69 offen offset:1024 sc1
    v_mfma_f32_16x16x32_bf16 v[116:119], a[84:87], v[172:175], v[116:119]
    v_accvgpr_read_b32 v31, a243
    v_mfma_f32_16x16x32_bf16 v[120:123], a[88:91], v[172:175], v[120:123]
    v_mfma_f32_16x16x32_bf16 v[124:127], a[92:95], v[172:175], v[124:127]
    s_waitcnt vmcnt(10)
    v_mfma_f32_16x16x32_bf16 v[64:67], a[112:115], v[176:179], v[64:67]
    buffer_load_dwordx4 v[152:155], v1, s[28:31], s70 offen offset:1024 sc1
    v_mfma_f32_16x16x32_bf16 v[68:71], a[116:119], v[176:179], v[68:71]
    v_mfma_f32_16x16x32_bf16 v[72:75], a[120:123], v[176:179], v[72:75]
    v_mfma_f32_16x16x32_bf16 v[76:79], a[124:127], v[176:179], v[76:79]
    s_waitcnt vmcnt(9)
    v_mfma_f32_16x16x32_bf16 v[80:83], a[112:115], v[180:183], v[80:83]
    buffer_load_dwordx4 v[156:159], v1, s[28:31], s71 offen offset:1024 sc1
    v_mfma_f32_16x16x32_bf16 v[84:87], a[116:119], v[180:183], v[84:87]
    v_mfma_f32_16x16x32_bf16 v[88:91], a[120:123], v[180:183], v[88:91]
    v_mfma_f32_16x16x32_bf16 v[92:95], a[124:127], v[180:183], v[92:95]
    s_waitcnt vmcnt(9)
    v_mfma_f32_16x16x32_bf16 v[96:99], a[112:115], v[184:187], v[96:99]
    buffer_load_dwordx4 v[160:163], v1, s[28:31], s68 offen offset:2048 sc1
    v_mfma_f32_16x16x32_bf16 v[100:103], a[116:119], v[184:187], v[100:103]
    v_mfma_f32_16x16x32_bf16 v[104:107], a[120:123], v[184:187], v[104:107]
    v_mfma_f32_16x16x32_bf16 v[108:111], a[124:127], v[184:187], v[108:111]
    s_waitcnt vmcnt(9)
    v_mfma_f32_16x16x32_bf16 v[112:115], a[112:115], v[188:191], v[112:115]
    buffer_load_dwordx4 v[164:167], v1, s[28:31], s69 offen offset:2048 sc1
    v_mfma_f32_16x16x32_bf16 v[116:119], a[116:119], v[188:191], v[116:119]
    v_mfma_f32_16x16x32_bf16 v[120:123], a[120:123], v[188:191], v[120:123]
    v_mfma_f32_16x16x32_bf16 v[124:127], a[124:127], v[188:191], v[124:127]
    s_waitcnt vmcnt(9)
    v_mfma_f32_16x16x32_bf16 v[64:67], a[128:131], v[128:131], v[64:67]
    buffer_load_dwordx4 v[168:171], v1, s[28:31], s70 offen offset:2048 sc1
    v_mfma_f32_16x16x32_bf16 v[68:71], a[132:135], v[128:131], v[68:71]
    v_mfma_f32_16x16x32_bf16 v[72:75], a[136:139], v[128:131], v[72:75]
    v_mfma_f32_16x16x32_bf16 v[76:79], a[140:143], v[128:131], v[76:79]
    s_waitcnt vmcnt(9)
    v_mfma_f32_16x16x32_bf16 v[80:83], a[128:131], v[132:135], v[80:83]
    buffer_load_dwordx4 v[172:175], v1, s[28:31], s71 offen offset:2048 sc1
    v_mfma_f32_16x16x32_bf16 v[84:87], a[132:135], v[132:135], v[84:87]
    v_mfma_f32_16x16x32_bf16 v[88:91], a[136:139], v[132:135], v[88:91]
    v_mfma_f32_16x16x32_bf16 v[92:95], a[140:143], v[132:135], v[92:95]
    s_waitcnt vmcnt(9)
    v_mfma_f32_16x16x32_bf16 v[96:99], a[128:131], v[136:139], v[96:99]
    buffer_load_dwordx4 v[176:179], v1, s[28:31], s69 offen offset:3072 sc1
    v_mfma_f32_16x16x32_bf16 v[100:103], a[132:135], v[136:139], v[100:103]
    v_mfma_f32_16x16x32_bf16 v[104:107], a[136:139], v[136:139], v[104:107]
    v_mfma_f32_16x16x32_bf16 v[108:111], a[140:143], v[136:139], v[108:111]
    s_waitcnt vmcnt(9)
    v_mfma_f32_16x16x32_bf16 v[112:115], a[128:131], v[140:143], v[112:115]
    s_add_u32 s69, s69, 4096
    buffer_load_dwordx4 v[180:183], v1, s[28:31], s69 offen offset:0 sc1
    v_mfma_f32_16x16x32_bf16 v[116:119], a[132:135], v[140:143], v[116:119]
    v_mfma_f32_16x16x32_bf16 v[120:123], a[136:139], v[140:143], v[120:123]
    v_mfma_f32_16x16x32_bf16 v[124:127], a[140:143], v[140:143], v[124:127]
    s_waitcnt vmcnt(9)
    v_mfma_f32_16x16x32_bf16 v[64:67], a[144:147], v[144:147], v[64:67]
    buffer_load_dwordx4 v[184:187], v1, s[28:31], s69 offen offset:1024 sc1
    v_mfma_f32_16x16x32_bf16 v[68:71], a[148:151], v[144:147], v[68:71]
    v_mfma_f32_16x16x32_bf16 v[72:75], a[152:155], v[144:147], v[72:75]
    v_mfma_f32_16x16x32_bf16 v[76:79], a[156:159], v[144:147], v[76:79]
    s_waitcnt vmcnt(9)
    v_mfma_f32_16x16x32_bf16 v[80:83], a[144:147], v[148:151], v[80:83]
    buffer_load_dwordx4 v[188:191], v1, s[28:31], s70 offen offset:3072 sc1
    v_mfma_f32_16x16x32_bf16 v[84:87], a[148:151], v[148:151], v[84:87]
    v_mfma_f32_16x16x32_bf16 v[88:91], a[152:155], v[148:151], v[88:91]
    v_mfma_f32_16x16x32_bf16 v[92:95], a[156:159], v[148:151], v[92:95]
    s_waitcnt vmcnt(9)
    v_mfma_f32_16x16x32_bf16 v[96:99], a[144:147], v[152:155], v[96:99]
    s_add_u32 s70, s70, 4096
    buffer_load_dwordx4 v[128:131], v1, s[28:31], s70 offen offset:0 sc1
    v_mfma_f32_16x16x32_bf16 v[100:103], a[148:151], v[152:155], v[100:103]
    v_mfma_f32_16x16x32_bf16 v[104:107], a[152:155], v[152:155], v[104:107]
    v_mfma_f32_16x16x32_bf16 v[108:111], a[156:159], v[152:155], v[108:111]
    s_waitcnt vmcnt(9)
    v_mfma_f32_16x16x32_bf16 v[112:115], a[144:147], v[156:159], v[112:115]
    buffer_load_dwordx4 v[132:135], v1, s[28:31], s70 offen offset:1024 sc1
    v_mfma_f32_16x16x32_bf16 v[116:119], a[148:151], v[156:159], v[116:119]
    v_mfma_f32_16x16x32_bf16 v[120:123], a[152:155], v[156:159], v[120:123]
    v_mfma_f32_16x16x32_bf16 v[124:127], a[156:159], v[156:159], v[124:127]
    s_waitcnt vmcnt(9)
    v_mfma_f32_16x16x32_bf16 v[64:67], a[160:163], v[160:163], v[64:67]
    buffer_load_dwordx4 v[136:139], v1, s[28:31], s71 offen offset:3072 sc1
    v_mfma_f32_16x16x32_bf16 v[68:71], a[164:167], v[160:163], v[68:71]
    v_mfma_f32_16x16x32_bf16 v[72:75], a[168:171], v[160:163], v[72:75]
    v_mfma_f32_16x16x32_bf16 v[76:79], a[172:175], v[160:163], v[76:79]
    s_waitcnt vmcnt(9)
    v_mfma_f32_16x16x32_bf16 v[80:83], a[160:163], v[164:167], v[80:83]
L_pad9:
    s_cbranch_execz L_pad13
    s_add_u32 s71, s71, 4096
    buffer_load_dwordx4 v[140:143], v1, s[28:31], s71 offen offset:0 sc1
    v_mfma_f32_16x16x32_bf16 v[84:87], a[164:167], v[164:167], v[84:87]
    v_mfma_f32_16x16x32_bf16 v[88:91], a[168:171], v[164:167], v[88:91]
    v_mfma_f32_16x16x32_bf16 v[92:95], a[172:175], v[164:167], v[92:95]
    s_waitcnt vmcnt(9)
    v_mfma_f32_16x16x32_bf16 v[96:99], a[160:163], v[168:171], v[96:99]
    buffer_load_dwordx4 v[144:147], v1, s[28:31], s71 offen offset:1024 sc1
    v_mfma_f32_16x16x32_bf16 v[100:103], a[164:167], v[168:171], v[100:103]
    v_mfma_f32_16x16x32_bf16 v[104:107], a[168:171], v[168:171], v[104:107]
    v_mfma_f32_16x16x32_bf16 v[108:111], a[172:175], v[168:171], v[108:111]
    s_waitcnt vmcnt(9)
    v_mfma_f32_16x16x32_bf16 v[112:115], a[160:163], v[172:175], v[112:115]
    buffer_load_dwordx4 v[148:151], v1, s[28:31], s68 offen offset:3072 sc1
    v_mfma_f32_16x16x32_bf16 v[116:119], a[164:167], v[172:175], v[116:119]
    v_mfma_f32_16x16x32_bf16 v[120:123], a[168:171], v[172:175], v[120:123]
    v_mfma_f32_16x16x32_bf16 v[124:127], a[172:175], v[172:175], v[124:127]
    s_waitcnt vmcnt(9)
    v_mfma_f32_16x16x32_bf16 v[80:83], a[176:179], v[176:179], v[80:83]
    s_add_u32 s68, s68, 4096
    buffer_load_dwordx4 v[152:155], v1, s[28:31], s68 offen offset:0 sc1
    v_mfma_f32_16x16x32_bf16 v[84:87], a[180:183], v[176:179], v[84:87]
    v_mfma_f32_16x16x32_bf16 v[88:91], a[184:187], v[176:179], v[88:91]
    v_mfma_f32_16x16x32_bf16 v[92:95], a[188:191], v[176:179], v[92:95]
    s_waitcnt vmcnt(9)
    v_mfma_f32_16x16x32_bf16 v[80:83], a[192:195], v[180:183], v[80:83]
    buffer_load_dwordx4 v[156:159], v1, s[28:31], s68 offen offset:1024 sc1
    v_mfma_f32_16x16x32_bf16 v[84:87], a[196:199], v[180:183], v[84:87]
    v_mfma_f32_16x16x32_bf16 v[88:91], a[200:203], v[180:183], v[88:91]
    v_mfma_f32_16x16x32_bf16 v[92:95], a[204:207], v[180:183], v[92:95]
    s_waitcnt vmcnt(9)
    v_mfma_f32_16x16x32_bf16 v[80:83], a[208:211], v[184:187], v[80:83]
    v_mfma_f32_16x16x32_bf16 v[84:87], a[212:215], v[184:187], v[84:87]
    v_mfma_f32_16x16x32_bf16 v[88:91], a[216:219], v[184:187], v[88:91]
    v_mfma_f32_16x16x32_bf16 v[92:95], a[220:223], v[184:187], v[92:95]
    s_waitcnt vmcnt(8)
    v_mfma_f32_16x16x32_bf16 v[96:99], a[176:179], v[188:191], v[96:99]
    v_mfma_f32_16x16x32_bf16 v[100:103], a[180:183], v[188:191], v[100:103]
    v_mfma_f32_16x16x32_bf16 v[104:107], a[184:187], v[188:191], v[104:107]
    v_mfma_f32_16x16x32_bf16 v[108:111], a[188:191], v[188:191], v[108:111]
    s_waitcnt vmcnt(7)
    v_mfma_f32_16x16x32_bf16 v[96:99], a[192:195], v[128:131], v[96:99]
    v_mfma_f32_16x16x32_bf16 v[100:103], a[196:199], v[128:131], v[100:103]
    ds_write_b128 v29, v[80:83] offset:0
    v_mfma_f32_16x16x32_bf16 v[104:107], a[200:203], v[128:131], v[104:107]
    v_mfma_f32_16x16x32_bf16 v[108:111], a[204:207], v[128:131], v[108:111]
    ds_write_b128 v29, v[84:87] offset:1024
    s_waitcnt vmcnt(6)
    v_mfma_f32_16x16x32_bf16 v[96:99], a[208:211], v[132:135], v[96:99]
    v_mfma_f32_16x16x32_bf16 v[100:103], a[212:215], v[132:135], v[100:103]
    ds_write_b128 v29, v[88:91] offset:2048
    v_mfma_f32_16x16x32_bf16 v[104:107], a[216:219], v[132:135], v[104:107]
    v_mfma_f32_16x16x32_bf16 v[108:111], a[220:223], v[132:135], v[108:111]
    ds_write_b128 v29, v[92:95] offset:3072
    s_waitcnt vmcnt(5)
    v_mfma_f32_16x16x32_bf16 v[112:115], a[176:179], v[136:139], v[112:115]
    v_mfma_f32_16x16x32_bf16 v[116:119], a[180:183], v[136:139], v[116:119]
    v_mfma_f32_16x16x32_bf16 v[120:123], a[184:187], v[136:139], v[120:123]
    v_mfma_f32_16x16x32_bf16 v[124:127], a[188:191], v[136:139], v[124:127]
    s_waitcnt lgkmcnt(0)
    s_barrier
    ds_read_b128 v[80:83], v28 offset:0
    ds_read_b128 v[84:87], v28 offset:1024
    ds_read_b128 v[88:91], v28 offset:2048
    ds_read_b128 v[92:95], v28 offset:3072
    s_waitcnt vmcnt(4)
    v_mfma_f32_16x16x32_bf16 v[112:115], a[192:195], v[140:143], v[112:115]
    v_mfma_f32_16x16x32_bf16 v[116:119], a[196:199], v[140:143], v[116:119]
    ds_write_b128 v30, v[96:99] offset:0
    v_mfma_f32_16x16x32_bf16 v[120:123], a[200:203], v[140:143], v[120:123]
    v_mfma_f32_16x16x32_bf16 v[124:127], a[204:207], v[140:143], v[124:127]
    ds_write_b128 v30, v[100:103] offset:1024
    s_waitcnt vmcnt(3)
    v_mfma_f32_16x16x32_bf16 v[112:115], a[208:211], v[144:147], v[112:115]
    v_mfma_f32_16x16x32_bf16 v[116:119], a[212:215], v[144:147], v[116:119]
    ds_write_b128 v30, v[104:107] offset:2048
    v_mfma_f32_16x16x32_bf16 v[120:123], a[216:219], v[144:147], v[120:123]
    v_mfma_f32_16x16x32_bf16 v[124:127], a[220:223], v[144:147], v[124:127]
    ds_write_b128 v30, v[108:111] offset:3072
    s_waitcnt vmcnt(2)
    v_mfma_f32_16x16x32_bf16 v[64:67], a[176:179], v[148:151], v[64:67]
    v_mfma_f32_16x16x32_bf16 v[68:71], a[180:183], v[148:151], v[68:71]
    v_mfma_f32_16x16x32_bf16 v[72:75], a[184:187], v[148:151], v[72:75]
    v_mfma_f32_16x16x32_bf16 v[76:79], a[188:191], v[148:151], v[76:79]
    s_waitcnt lgkmcnt(4)
    s_barrier
    s_waitcnt vmcnt(1)
    v_mfma_f32_16x16x32_bf16 v[64:67], a[192:195], v[152:155], v[64:67]
    v_mfma_f32_16x16x32_bf16 v[68:71], a[196:199], v[152:155], v[68:71]
    ds_write_b128 v31, v[112:115] offset:0
    v_mfma_f32_16x16x32_bf16 v[72:75], a[200:203], v[152:155], v[72:75]
    v_mfma_f32_16x16x32_bf16 v[76:79], a[204:207], v[152:155], v[76:79]
    ds_write_b128 v31, v[116:119] offset:1024
    s_waitcnt vmcnt(0)
    v_mfma_f32_16x16x32_bf16 v[64:67], a[208:211], v[156:159], v[64:67]
    v_mfma_f32_16x16x32_bf16 v[68:71], a[212:215], v[156:159], v[68:71]
    ds_write_b128 v31, v[120:123] offset:2048
    v_mfma_f32_16x16x32_bf16 v[72:75], a[216:219], v[156:159], v[72:75]
    v_mfma_f32_16x16x32_bf16 v[76:79], a[220:223], v[156:159], v[76:79]
    ds_write_b128 v31, v[124:127] offset:3072
    s_nop 3
    v_pk_add_f32 v[64:65], v[64:65], v[80:81]
    v_pk_add_f32 v[66:67], v[66:67], v[82:83]
    v_pk_add_f32 v[68:69], v[68:69], v[84:85]
    v_pk_add_f32 v[70:71], v[70:71], v[86:87]
    v_pk_add_f32 v[72:73], v[72:73], v[88:89]
    v_pk_add_f32 v[74:75], v[74:75], v[90:91]
    v_pk_add_f32 v[76:77], v[76:77], v[92:93]
    v_pk_add_f32 v[78:79], v[78:79], v[94:95]
    s_waitcnt lgkmcnt(0)
    s_barrier
    ds_read_b128 v[96:99], v28 offset:0
    ds_read_b128 v[112:115], v28 offset:4096
    ds_read_b128 v[100:103], v28 offset:1024
    ds_read_b128 v[116:119], v28 offset:5120
    ds_read_b128 v[104:107], v28 offset:2048
    ds_read_b128 v[120:123], v28 offset:6144
    ds_read_b128 v[108:111], v28 offset:3072
    ds_read_b128 v[124:127], v28 offset:7168
    s_waitcnt lgkmcnt(6)
    v_pk_add_f32 v[64:65], v[64:65], v[96:97]
    v_pk_add_f32 v[66:67], v[66:67], v[98:99]
    v_pk_add_f32 v[64:65], v[64:65], v[112:113]
    v_pk_add_f32 v[66:67], v[66:67], v[114:115]
    v_pk_fma_f32 v[64:65], v[64:65], v[24:25], v[32:33] op_sel_hi:[1,0,1]
    v_pk_fma_f32 v[66:67], v[66:67], v[24:25], v[34:35] op_sel_hi:[1,0,1]
    v_cvt_pk_bf16_f32 v16, v64, v65
    v_cvt_pk_bf16_f32 v17, v66, v67
    s_waitcnt lgkmcnt(4)
    v_pk_add_f32 v[68:69], v[68:69], v[100:101]
    v_pk_add_f32 v[70:71], v[70:71], v[102:103]
    v_pk_add_f32 v[68:69], v[68:69], v[116:117]
    v_pk_add_f32 v[70:71], v[70:71], v[118:119]
    v_pk_fma_f32 v[68:69], v[68:69], v[24:25], v[36:37] op_sel_hi:[1,0,1]
    v_pk_fma_f32 v[70:71], v[70:71], v[24:25], v[38:39] op_sel_hi:[1,0,1]
    v_cvt_pk_bf16_f32 v18, v68, v69
    v_cvt_pk_bf16_f32 v19, v70, v71
    s_waitcnt lgkmcnt(2)
    v_pk_add_f32 v[72:73], v[72:73], v[104:105]
    v_pk_add_f32 v[74:75], v[74:75], v[106:107]
    v_pk_add_f32 v[72:73], v[72:73], v[120:121]
    v_pk_add_f32 v[74:75], v[74:75], v[122:123]
    v_pk_fma_f32 v[72:73], v[72:73], v[24:25], v[40:41] op_sel_hi:[1,0,1]
    v_pk_fma_f32 v[74:75], v[74:75], v[24:25], v[42:43] op_sel_hi:[1,0,1]
    v_cvt_pk_bf16_f32 v20, v72, v73
    v_cvt_pk_bf16_f32 v21, v74, v75
    s_waitcnt lgkmcnt(0)
    v_pk_add_f32 v[76:77], v[76:77], v[108:109]
    v_pk_add_f32 v[78:79], v[78:79], v[110:111]
    v_pk_add_f32 v[76:77], v[76:77], v[124:125]
    v_pk_add_f32 v[78:79], v[78:79], v[126:127]
    v_pk_fma_f32 v[76:77], v[76:77], v[24:25], v[44:45] op_sel_hi:[1,0,1]
    v_pk_fma_f32 v[78:79], v[78:79], v[24:25], v[46:47] op_sel_hi:[1,0,1]
    v_cvt_pk_bf16_f32 v22, v76, v77
    v_cvt_pk_bf16_f32 v23, v78, v79
    s_add_u32 s43, s51, 32768
    s_cmp_lg_u32 s36, 0
    s_cbranch_scc1 L_ss_39
    buffer_store_dwordx4 v[16:19], v1, s[28:31], s43 offen offset:0
    buffer_store_dwordx4 v[20:23], v1, s[28:31], s43 offen offset:1024
L_se_40:
    v_mov_b32 v41, 0x3f803f80
    v_dot2_f32_bf16 v13, v16, v16, 0
    v_dot2_f32_bf16 v15, v20, v20, 0
    v_dot2_f32_bf16 v12, v41, v16, 0
    v_dot2_f32_bf16 v14, v41, v20, 0
    v_dot2_f32_bf16 v13, v17, v17, v13
    v_dot2_f32_bf16 v15, v21, v21, v15
    v_dot2_f32_bf16 v12, v41, v17, v12
    v_dot2_f32_bf16 v14, v41, v21, v14
    v_dot2_f32_bf16 v13, v18, v18, v13
    v_dot2_f32_bf16 v15, v22, v22, v15
    v_dot2_f32_bf16 v12, v41, v18, v12
    v_dot2_f32_bf16 v14, v41, v22, v14
    v_dot2_f32_bf16 v13, v19, v19, v13
    v_dot2_f32_bf16 v15, v23, v23, v15
    v_dot2_f32_bf16 v12, v41, v19, v12
    v_dot2_f32_bf16 v14, v41, v23, v14
    v_accvgpr_read_b32 v40, a228
    s_add_u32 s45, s58, 4096
    v_add_f32 v13, v13, v15
    v_add_f32 v12, v12, v14
    s_nop 1
    v_permlane16_swap_b32 v12, v13
    v_add_f32 v12, v12, v13
    v_mov_b32 v13, v12
    s_nop 1
    v_permlane32_swap_b32 v12, v13
    v_add_f32 v14, v12, v13
    s_add_u32 s93, s93, 1
    s_and_b32 s93, s93, 0xff
    v_and_b32 v14, 0xffffff00, v14
    v_or_b32 v14, s93, v14
    s_mov_b32 exec_hi, 0
    s_cmp_lg_u32 s36, 0
    s_cbranch_scc1 L_ss_41
    buffer_store_dword v14, v40, s[28:31], s45 offen
L_se_42:
    s_mov_b64 exec, -1
    v_accvgpr_read_b32 v15, a226
    s_sub_u32 s42, s92, 8192
    s_add_u32 s68, s68, s42
    s_add_u32 s69, s69, s42
    s_add_u32 s70, s70, s42
    s_add_u32 s71, s71, s42
    s_add_u32 s72, s72, 0x100000
    s_add_u32 s73, s73, 0x100000
    v_mov_b32 v13, s35
    s_waitcnt vmcnt(1)
    s_mov_b64 exec, 1
    s_cmp_lg_u32 s36, 0
    s_cbranch_scc1 L_ss_43
    buffer_store_dword v13, v1, s[28:31], s56 offen offset:1024
L_se_44:
    s_mov_b64 exec, -1
    buffer_load_dword v12, v15, s[28:31], s57 offen offset:1024 sc1
    s_barrier
    v_add_u32 v2, 65536, v1
    ds_read_b128 v[32:35], v1 offset:0
    ds_read_b128 v[36:39], v1 offset:1024
    ds_read_b128 v[40:43], v1 offset:2048
    ds_read_b128 v[44:47], v1 offset:3072
    ds_read_b128 v[48:51], v2 offset:0
    ds_read_b128 v[52:55], v2 offset:1024
L_poll_45:
    buffer_load_dword v14, v15, s[28:31], s57 offen offset:1024 sc1
    s_waitcnt vmcnt(1)
    v_cmp_ne_u32 vcc, s35, v12
    s_cbranch_vccz L_pd_46
    buffer_load_dword v12, v15, s[28:31], s57 offen offset:1024 sc1
    s_waitcnt vmcnt(1)
    v_cmp_ne_u32 vcc, s35, v14
    s_cbranch_vccz L_pd_46
    s_sub_u32 s38, s38, 1
    s_cbranch_scc0 L_poll_45
    s_mov_b32 s38, 0
L_pd_46:
    s_add_u32 s44, s48, s88
    buffer_load_dwordx4 v[128:131], v1, s[28:31], s44 offen offset:0 sc1
    s_add_u32 s45, s49, s88
    buffer_load_dwordx4 v[132:135], v1, s[28:31], s45 offen offset:0 sc1
    buffer_load_dwordx4 v[136:139], v1, s[28:31], s44 offen offset:1024 sc1
    buffer_load_dwordx4 v[140:143], v1, s[28:31], s45 offen offset:1024 sc1
    s_add_u32 s35, s35, 1
    s_waitcnt lgkmcnt(4) vmcnt(3)
    v_mfma_f32_16x16x32_bf16 v[64:67], v[128:131], v[32:35], 0
    ds_read_b128 v[56:59], v1 offset:4096
    s_waitcnt vmcnt(2)
    v_mfma_f32_16x16x32_bf16 v[68:71], v[132:135], v[32:35], 0
    buffer_load_dwordx4 v[144:147], v1, s[28:31], s44 offen offset:2048 sc1
    v_mfma_f32_16x16x32_bf16 v[72:75], v[128:131], v[36:39], 0
    ds_read_b128 v[60:63], v1 offset:5120
    v_mfma_f32_16x16x32_bf16 v[76:79], v[132:135], v[36:39], 0
    s_waitcnt lgkmcnt(4)
    v_mfma_f32_16x16x32_bf16 v[80:83], v[128:131], v[40:43], 0
    ds_read_b128 v[32:35], v1 offset:6144
    v_mfma_f32_16x16x32_bf16 v[84:87], v[132:135], v[40:43], 0
    buffer_load_dwordx4 v[148:151], v1, s[28:31], s45 offen offset:2048 sc1
    v_mfma_f32_16x16x32_bf16 v[88:91], v[128:131], v[44:47], 0
    ds_read_b128 v[36:39], v1 offset:7168
    v_mfma_f32_16x16x32_bf16 v[92:95], v[132:135], v[44:47], 0
    s_waitcnt lgkmcnt(4)
    v_mfma_f32_16x16x32_bf16 v[176:179], v[48:51], v[128:131], 0
    ds_read_b128 v[40:43], v2 offset:2048
    v_mfma_f32_16x16x32_bf16 v[180:183], v[48:51], v[132:135], 0
    buffer_load_dwordx4 v[152:155], v1, s[28:31], s44 offen offset:3072 sc1
    v_mfma_f32_16x16x32_bf16 v[184:187], v[52:55], v[128:131], 0
    ds_read_b128 v[44:47], v2 offset:3072
    v_mfma_f32_16x16x32_bf16 v[188:191], v[52:55], v[132:135], 0
    s_waitcnt lgkmcnt(4) vmcnt(3)
    v_mfma_f32_16x16x32_bf16 v[64:67], v[136:139], v[56:59], v[64:67]
    ds_read_b128 v[48:51], v1 offset:8192
    v_mfma_f32_16x16x32_bf16 v[68:71], v[140:143], v[56:59], v[68:71]
    buffer_load_dwordx4 v[156:159], v1, s[28:31], s45 offen offset:3072 sc1
    v_mfma_f32_16x16x32_bf16 v[72:75], v[136:139], v[60:63], v[72:75]
    ds_read_b128 v[52:55], v1 offset:9216
    v_mfma_f32_16x16x32_bf16 v[76:79], v[140:143], v[60:63], v[76:79]
    s_waitcnt lgkmcnt(4)
    v_mfma_f32_16x16x32_bf16 v[80:83], v[136:139], v[32:35], v[80:83]
    ds_read_b128 v[56:59], v1 offset:10240
    v_mfma_f32_16x16x32_bf16 v[84:87], v[140:143], v[32:35], v[84:87]
    s_add_u32 s44, s48, s89
    buffer_load_dwordx4 v[160:163], v1, s[28:31], s44 offen offset:0 sc1
    v_mfma_f32_16x16x32_bf16 v[88:91], v[136:139], v[36:39], v[88:91]
    ds_read_b128 v[60:63], v1 offset:11264
    v_mfma_f32_16x16x32_bf16 v[92:95], v[140:143], v[36:39], v[92:95]
    s_waitcnt lgkmcnt(4)
    v_mfma_f32_16x16x32_bf16 v[176:179], v[40:43], v[136:139], v[176:179]
    ds_read_b128 v[32:35], v2 offset:4096
    v_mfma_f32_16x16x32_bf16 v[180:183], v[40:43], v[140:143], v[180:183]
    s_add_u32 s45, s49, s89
    buffer_load_dwordx4 v[164:167], v1, s[28:31], s45 offen offset:0 sc1
    v_mfma_f32_16x16x32_bf16 v[184:187], v[44:47], v[136:139], v[184:187]
    ds_read_b128 v[36:39], v2 offset:5120
    v_mfma_f32_16x16x32_bf16 v[188:191], v[44:47], v[140:143], v[188:191]
    s_waitcnt lgkmcnt(4) vmcnt(4)
    v_mfma_f32_16x16x32_bf16 v[64:67], v[144:147], v[48:51], v[64:67]
    ds_read_b128 v[40:43], v1 offset:12288
L_pad10:
    s_cbranch_execz L_pad14
    v_mfma_f32_16x16x32_bf16 v[68:71], v[148:151], v[48:51], v[68:71]
    buffer_load_dwordx4 v[168:171], v1, s[28:31], s44 offen offset:1024 sc1
    v_mfma_f32_16x16x32_bf16 v[72:75], v[144:147], v[52:55], v[72:75]
    ds_read_b128 v[44:47], v1 offset:13312
    v_mfma_f32_16x16x32_bf16 v[76:79], v[148:151], v[52:55], v[76:79]
    s_waitcnt lgkmcnt(4)
    v_mfma_f32_16x16x32_bf16 v[80:83], v[144:147], v[56:59], v[80:83]
    ds_read_b128 v[48:51], v1 offset:14336
    v_mfma_f32_16x16x32_bf16 v[84:87], v[148:151], v[56:59], v[84:87]
    buffer_load_dwordx4 v[172:175], v1, s[28:31], s45 offen offset:1024 sc1
    v_mfma_f32_16x16x32_bf16 v[88:91], v[144:147], v[60:63], v[88:91]
    ds_read_b128 v[52:55], v1 offset:15360
    v_mfma_f32_16x16x32_bf16 v[92:95], v[148:151], v[60:63], v[92:95]
    s_waitcnt lgkmcnt(4)
    v_mfma_f32_16x16x32_bf16 v[176:179], v[32:35], v[144:147], v[176:179]
    ds_read_b128 v[56:59], v2 offset:6144
    s_add_u32 s46, s59, 4096
    buffer_load_dwordx4 v[112:115], v1, s[28:31], s46 offen offset:0 sc1
    v_mfma_f32_16x16x32_bf16 v[180:183], v[32:35], v[148:151], v[180:183]
    v_mfma_f32_16x16x32_bf16 v[184:187], v[36:39], v[144:147], v[184:187]
    ds_read_b128 v[60:63], v2 offset:7168
    v_mfma_f32_16x16x32_bf16 v[188:191], v[36:39], v[148:151], v[188:191]
    s_waitcnt lgkmcnt(4) vmcnt(5)
    v_mfma_f32_16x16x32_bf16 v[64:67], v[152:155], v[40:43], v[64:67]
    ds_read_b128 v[32:35], v1 offset:16384
    v_mfma_f32_16x16x32_bf16 v[68:71], v[156:159], v[40:43], v[68:71]
    buffer_load_dwordx4 v[116:119], v1, s[28:31], s46 offen offset:1024 sc1
    v_mfma_f32_16x16x32_bf16 v[72:75], v[152:155], v[44:47], v[72:75]
    ds_read_b128 v[36:39], v1 offset:17408
    v_mfma_f32_16x16x32_bf16 v[76:79], v[156:159], v[44:47], v[76:79]
    s_waitcnt lgkmcnt(4)
    v_mfma_f32_16x16x32_bf16 v[80:83], v[152:155], v[48:51], v[80:83]
    ds_read_b128 v[40:43], v1 offset:18432
    v_mfma_f32_16x16x32_bf16 v[84:87], v[156:159], v[48:51], v[84:87]
    buffer_load_dwordx4 v[128:131], v1, s[28:31], s44 offen offset:2048 sc1
    v_mfma_f32_16x16x32_bf16 v[88:91], v[152:155], v[52:55], v[88:91]
    ds_read_b128 v[44:47], v1 offset:19456
    v_mfma_f32_16x16x32_bf16 v[92:95], v[156:159], v[52:55], v[92:95]
    s_waitcnt lgkmcnt(4)
    v_mfma_f32_16x16x32_bf16 v[176:179], v[56:59], v[152:155], v[176:179]
    ds_read_b128 v[48:51], v2 offset:8192
    v_mfma_f32_16x16x32_bf16 v[180:183], v[56:59], v[156:159], v[180:183]
    buffer_load_dwordx4 v[132:135], v1, s[28:31], s45 offen offset:2048 sc1
    v_mfma_f32_16x16x32_bf16 v[184:187], v[60:63], v[152:155], v[184:187]
    ds_read_b128 v[52:55], v2 offset:9216
    v_mfma_f32_16x16x32_bf16 v[188:191], v[60:63], v[156:159], v[188:191]
    s_waitcnt lgkmcnt(4) vmcnt(6)
    v_mfma_f32_16x16x32_bf16 v[64:67], v[160:163], v[32:35], v[64:67]
    ds_read_b128 v[56:59], v1 offset:20480
    v_mfma_f32_16x16x32_bf16 v[68:71], v[164:167], v[32:35], v[68:71]
    buffer_load_dwordx4 v[136:139], v1, s[28:31], s44 offen offset:3072 sc1
    v_mfma_f32_16x16x32_bf16 v[72:75], v[160:163], v[36:39], v[72:75]
    ds_read_b128 v[60:63], v1 offset:21504
    v_mfma_f32_16x16x32_bf16 v[76:79], v[164:167], v[36:39], v[76:79]
    s_waitcnt lgkmcnt(4)
    v_mfma_f32_16x16x32_bf16 v[80:83], v[160:163], v[40:43], v[80:83]
    ds_read_b128 v[32:35], v1 offset:22528
    buffer_load_dwordx4 v[140:143], v1, s[28:31], s45 offen offset:3072 sc1
    v_mfma_f32_16x16x32_bf16 v[84:87], v[164:167], v[40:43], v[84:87]
    s_add_u32 s44, s48, s90
    buffer_load_dwordx4 v[144:147], v1, s[28:31], s44 offen offset:0 sc1
    v_mfma_f32_16x16x32_bf16 v[88:91], v[160:163], v[44:47], v[88:91]
    ds_read_b128 v[36:39], v1 offset:23552
    v_mfma_f32_16x16x32_bf16 v[92:95], v[164:167], v[44:47], v[92:95]
    s_waitcnt lgkmcnt(4)
    v_mfma_f32_16x16x32_bf16 v[176:179], v[48:51], v[160:163], v[176:179]
    ds_read_b128 v[40:43], v2 offset:10240
    v_mfma_f32_16x16x32_bf16 v[180:183], v[48:51], v[164:167], v[180:183]
    s_add_u32 s45, s49, s90
    buffer_load_dwordx4 v[148:151], v1, s[28:31], s45 offen offset:0 sc1
    v_mfma_f32_16x16x32_bf16 v[184:187], v[52:55], v[160:163], v[184:187]
    ds_read_b128 v[44:47], v2 offset:11264
    v_mfma_f32_16x16x32_bf16 v[188:191], v[52:55], v[164:167], v[188:191]
    s_waitcnt lgkmcnt(4) vmcnt(8)
    v_mfma_f32_16x16x32_bf16 v[64:67], v[168:171], v[56:59], v[64:67]
    ds_read_b128 v[48:51], v1 offset:24576
    v_mfma_f32_16x16x32_bf16 v[68:71], v[172:175], v[56:59], v[68:71]
    buffer_load_dwordx4 v[152:155], v1, s[28:31], s44 offen offset:1024 sc1
    v_mfma_f32_16x16x32_bf16 v[72:75], v[168:171], v[60:63], v[72:75]
    ds_read_b128 v[52:55], v1 offset:25600
    s_waitcnt vmcnt(7)
    v_mfma_f32_16x16x32_bf16 v[76:79], v[172:175], v[60:63], v[76:79]
    s_waitcnt lgkmcnt(4)
    v_mfma_f32_16x16x32_bf16 v[80:83], v[168:171], v[32:35], v[80:83]
    ds_read_b128 v[56:59], v1 offset:26624
    buffer_load_dwordx4 v[156:159], v1, s[28:31], s45 offen offset:1024 sc1
    v_xor_b32 v112, s93, v112
    v_mfma_f32_16x16x32_bf16 v[84:87], v[172:175], v[32:35], v[84:87]
    v_xor_b32 v113, s93, v113
    v_xor_b32 v114, s93, v114
    v_mfma_f32_16x16x32_bf16 v[88:91], v[168:171], v[36:39], v[88:91]
    ds_read_b128 v[60:63], v1 offset:27648
    v_mfma_f32_16x16x32_bf16 v[92:95], v[172:175], v[36:39], v[92:95]
    buffer_load_dwordx4 v[160:163], v1, s[28:31], s44 offen offset:2048 sc1
    s_waitcnt lgkmcnt(4)
    v_mfma_f32_16x16x32_bf16 v[176:179], v[40:43], v[168:171], v[176:179]
    ds_read_b128 v[32:35], v2 offset:12288
    v_xor_b32 v115, s93, v115
    v_mfma_f32_16x16x32_bf16 v[180:183], v[40:43], v[172:175], v[180:183]
    v_xor_b32 v116, s93, v116
    v_mfma_f32_16x16x32_bf16 v[184:187], v[44:47], v[168:171], v[184:187]
    ds_read_b128 v[36:39], v2 offset:13312
    buffer_load_dwordx4 v[164:167], v1, s[28:31], s45 offen offset:2048 sc1
    v_xor_b32 v117, s93, v117
    v_mfma_f32_16x16x32_bf16 v[188:191], v[44:47], v[172:175], v[188:191]
    v_xor_b32 v118, s93, v118
    s_waitcnt lgkmcnt(4) vmcnt(8)
    v_mfma_f32_16x16x32_bf16 v[64:67], v[128:131], v[48:51], v[64:67]
    ds_read_b128 v[40:43], v1 offset:28672
    v_xor_b32 v119, s93, v119
    v_mfma_f32_16x16x32_bf16 v[68:71], v[132:135], v[48:51], v[68:71]
    buffer_load_dwordx4 v[168:171], v1, s[28:31], s44 offen offset:3072 sc1
    v_mfma_f32_16x16x32_bf16 v[72:75], v[128:131], v[52:55], v[72:75]
    ds_read_b128 v[44:47], v1 offset:29696
    v_or3_b32 v120, v112, v113, v114
    v_mfma_f32_16x16x32_bf16 v[76:79], v[132:135], v[52:55], v[76:79]
    v_or3_b32 v121, v115, v116, v117
    s_waitcnt lgkmcnt(4)
    v_mfma_f32_16x16x32_bf16 v[80:83], v[128:131], v[56:59], v[80:83]
    ds_read_b128 v[48:51], v1 offset:30720
    v_or3_b32 v120, v120, v118, v119
    v_mfma_f32_16x16x32_bf16 v[84:87], v[132:135], v[56:59], v[84:87]
    buffer_load_dwordx4 v[172:175], v1, s[28:31], s45 offen offset:3072 sc1
    v_mfma_f32_16x16x32_bf16 v[88:91], v[128:131], v[60:63], v[88:91]
    ds_read_b128 v[52:55], v1 offset:31744
    v_or_b32 v120, v120, v121
    v_mfma_f32_16x16x32_bf16 v[92:95], v[132:135], v[60:63], v[92:95]
    v_and_b32 v120, 0xff, v120
    s_waitcnt lgkmcnt(4)
    v_mfma_f32_16x16x32_bf16 v[176:179], v[32:35], v[128:131], v[176:179]
    ds_read_b128 v[56:59], v2 offset:14336
    v_mfma_f32_16x16x32_bf16 v[180:183], v[32:35], v[132:135], v[180:183]
    v_cmp_ne_u32 vcc, 0, v120
    s_cbranch_vccnz L_sg_47
L_sgok_48:
    v_mfma_f32_16x16x32_bf16 v[184:187], v[36:39], v[128:131], v[184:187]
    ds_read_b128 v[60:63], v2 offset:15360
    v_add_f32 v120, v112, v116
    v_mfma_f32_16x16x32_bf16 v[188:191], v[36:39], v[132:135], v[188:191]
    v_add_f32 v121, v113, v117
    s_waitcnt lgkmcnt(4) vmcnt(8)
    v_mfma_f32_16x16x32_bf16 v[64:67], v[136:139], v[40:43], v[64:67]
    ds_read_b128 v[32:35], v1 offset:32768
    v_add_f32 v122, v114, v118
    v_mfma_f32_16x16x32_bf16 v[68:71], v[140:143], v[40:43], v[68:71]
    s_add_u32 s44, s48, s91
    buffer_load_dwordx4 v[128:131], v1, s[28:31], s44 offen offset:0 sc1
    v_mfma_f32_16x16x32_bf16 v[72:75], v[136:139], v[44:47], v[72:75]
    ds_read_b128 v[36:39], v1 offset:33792
    v_add_f32 v123, v115, v119
    v_mfma_f32_16x16x32_bf16 v[76:79], v[140:143], v[44:47], v[76:79]
    v_accvgpr_read_b32 v13, a229
    s_waitcnt lgkmcnt(4)
    v_mfma_f32_16x16x32_bf16 v[80:83], v[136:139], v[48:51], v[80:83]
    ds_read_b128 v[40:43], v1 offset:34816
    v_accvgpr_read_b32 v12, a230
    v_mfma_f32_16x16x32_bf16 v[84:87], v[140:143], v[48:51], v[84:87]
    s_add_u32 s45, s49, s91
    buffer_load_dwordx4 v[132:135], v1, s[28:31], s45 offen offset:0 sc1
    v_mfma_f32_16x16x32_bf16 v[88:91], v[136:139], v[52:55], v[88:91]
    ds_read_b128 v[44:47], v1 offset:35840
    v_permlane32_swap_b32 v120, v122
    v_mfma_f32_16x16x32_bf16 v[92:95], v[140:143], v[52:55], v[92:95]
    v_permlane32_swap_b32 v121, v123
    s_waitcnt lgkmcnt(4)
    v_mfma_f32_16x16x32_bf16 v[176:179], v[56:59], v[136:139], v[176:179]
    ds_read_b128 v[48:51], v2 offset:16384
    v_add_f32 v120, v120, v122
    v_mfma_f32_16x16x32_bf16 v[180:183], v[56:59], v[140:143], v[180:183]
    v_add_f32 v121, v121, v123
    v_mov_b32 v122, v120
    v_mfma_f32_16x16x32_bf16 v[184:187], v[60:63], v[136:139], v[184:187]
    ds_read_b128 v[52:55], v2 offset:17408
    v_mov_b32 v123, v121
    v_mfma_f32_16x16x32_bf16 v[188:191], v[60:63], v[140:143], v[188:191]
    s_waitcnt lgkmcnt(4) vmcnt(8)
    v_mfma_f32_16x16x32_bf16 v[64:67], v[144:147], v[32:35], v[64:67]
    ds_read_b128 v[56:59], v1 offset:36864
    v_mfma_f32_16x16x32_bf16 v[68:71], v[148:151], v[32:35], v[68:71]
    buffer_load_dwordx4 v[136:139], v1, s[28:31], s44 offen offset:1024 sc1
    v_mfma_f32_16x16x32_bf16 v[72:75], v[144:147], v[36:39], v[72:75]
    ds_read_b128 v[60:63], v1 offset:37888
    s_nop 0
    v_mfma_f32_16x16x32_bf16 v[76:79], v[148:151], v[36:39], v[76:79]
    v_permlane16_swap_b32 v120, v122
    s_waitcnt lgkmcnt(4)
    v_mfma_f32_16x16x32_bf16 v[80:83], v[144:147], v[40:43], v[80:83]
    ds_read_b128 v[32:35], v1 offset:38912
    v_permlane16_swap_b32 v121, v123
    v_mfma_f32_16x16x32_bf16 v[84:87], v[148:151], v[40:43], v[84:87]
    v_add_f32 v120, v120, v122
    v_mfma_f32_16x16x32_bf16 v[88:91], v[144:147], v[44:47], v[88:91]
    ds_read_b128 v[36:39], v1 offset:39936
    buffer_load_dwordx4 v[140:143], v1, s[28:31], s45 offen offset:1024 sc1
    v_mfma_f32_16x16x32_bf16 v[92:95], v[148:151], v[44:47], v[92:95]
    v_add_f32 v121, v121, v123
    s_waitcnt lgkmcnt(4)
    v_mfma_f32_16x16x32_bf16 v[176:179], v[48:51], v[144:147], v[176:179]
    ds_read_b128 v[40:43], v2 offset:18432
    v_mul_f32 v120, 0xbb000000, v120
    v_mfma_f32_16x16x32_bf16 v[180:183], v[48:51], v[148:151], v[180:183]
    v_mul_f32 v121, 0x3b000000, v121
    v_fma_f32 v121, -v120, v120, v121
    v_mfma_f32_16x16x32_bf16 v[184:187], v[52:55], v[144:147], v[184:187]
    ds_read_b128 v[44:47], v2 offset:19456
    v_max_f32 v121, 0, v121
    v_mfma_f32_16x16x32_bf16 v[188:191], v[52:55], v[148:151], v[188:191]
    v_add_f32 v121, 0x3727c5ac, v121
    s_waitcnt lgkmcnt(4) vmcnt(8)
    v_mfma_f32_16x16x32_bf16 v[64:67], v[152:155], v[56:59], v[64:67]
    ds_read_b128 v[48:51], v1 offset:40960
    v_mfma_f32_16x16x32_bf16 v[68:71], v[156:159], v[56:59], v[68:71]
    buffer_load_dwordx4 v[144:147], v1, s[28:31], s44 offen offset:2048 sc1
    v_mfma_f32_16x16x32_bf16 v[72:75], v[152:155], v[60:63], v[72:75]
    ds_read_b128 v[52:55], v1 offset:41984
    v_mfma_f32_16x16x32_bf16 v[76:79], v[156:159], v[60:63], v[76:79]
    v_rsq_f32 v121, v121
    s_waitcnt lgkmcnt(4)
    v_mfma_f32_16x16x32_bf16 v[80:83], v[152:155], v[32:35], v[80:83]
    ds_read_b128 v[56:59], v1 offset:43008
    s_nop 0
    v_mfma_f32_16x16x32_bf16 v[84:87], v[156:159], v[32:35], v[84:87]
    ds_write2_b32 v13, v120, v121 offset0:0 offset1:32
    v_mfma_f32_16x16x32_bf16 v[88:91], v[152:155], v[36:39], v[88:91]
    ds_read_b128 v[60:63], v1 offset:44032
    buffer_load_dwordx4 v[148:151], v1, s[28:31], s45 offen offset:2048 sc1
    ds_read2_b32 v[124:125], v12 offset0:0 offset1:16
    v_mfma_f32_16x16x32_bf16 v[92:95], v[156:159], v[36:39], v[92:95]
    ds_read2_b32 v[126:127], v12 offset0:32 offset1:48
    s_waitcnt lgkmcnt(7)
    v_mfma_f32_16x16x32_bf16 v[176:179], v[40:43], v[152:155], v[176:179]
    ds_read_b128 v[32:35], v1 offset:45056
    v_accvgpr_read_b32 v13, a231
    v_mfma_f32_16x16x32_bf16 v[180:183], v[40:43], v[156:159], v[180:183]
    ds_read_b128 v[96:99], v13 offset:0
    ds_read_b128 v[104:107], v13 offset:128
    v_mfma_f32_16x16x32_bf16 v[184:187], v[44:47], v[152:155], v[184:187]
    ds_read_b128 v[36:39], v1 offset:46080
    ds_read_b128 v[100:103], v13 offset:64
    v_mfma_f32_16x16x32_bf16 v[188:191], v[44:47], v[156:159], v[188:191]
    s_waitcnt lgkmcnt(10) vmcnt(8)
    v_mfma_f32_16x16x32_bf16 v[64:67], v[160:163], v[48:51], v[64:67]
    ds_read_b128 v[40:43], v1 offset:47104
    v_mfma_f32_16x16x32_bf16 v[68:71], v[164:167], v[48:51], v[68:71]
    buffer_load_dwordx4 v[152:155], v1, s[28:31], s44 offen offset:3072 sc1
    v_mfma_f32_16x16x32_bf16 v[72:75], v[160:163], v[52:55], v[72:75]
    ds_read_b128 v[44:47], v1 offset:48128
    ds_read_b128 v[108:111], v13 offset:192
    v_mfma_f32_16x16x32_bf16 v[76:79], v[164:167], v[52:55], v[76:79]
    s_waitcnt lgkmcnt(10)
    v_mfma_f32_16x16x32_bf16 v[80:83], v[160:163], v[56:59], v[80:83]
    ds_read_b128 v[48:51], v1 offset:49152
    v_mfma_f32_16x16x32_bf16 v[84:87], v[164:167], v[56:59], v[84:87]
    buffer_load_dwordx4 v[156:159], v1, s[28:31], s45 offen offset:3072 sc1
    v_mfma_f32_16x16x32_bf16 v[88:91], v[160:163], v[60:63], v[88:91]
    ds_read_b128 v[52:55], v1 offset:50176
    v_mfma_f32_16x16x32_bf16 v[92:95], v[164:167], v[60:63], v[92:95]
    s_waitcnt lgkmcnt(6) vmcnt(8)
    v_mfma_f32_16x16x32_bf16 v[64:67], v[168:171], v[32:35], v[64:67]
    ds_read_b128 v[56:59], v1 offset:51200
    v_mfma_f32_16x16x32_bf16 v[68:71], v[172:175], v[32:35], v[68:71]
    s_mul_i32 s82, s32, 8192
    s_add_u32 s78, s82, s84
    s_mul_i32 s79, s74, 2228224
    s_sub_u32 s78, s78, s79
    s_add_u32 m0, s82, 98304
    s_add_u32 s79, s78, 245760
    buffer_load_dwordx4 v1, s[28:31], s79 offen offset:0 sc1 lds
    v_mfma_f32_16x16x32_bf16 v[72:75], v[168:171], v[36:39], v[72:75]
    ds_read_b128 v[60:63], v1 offset:52224
    s_waitcnt lgkmcnt(4)
    v_mfma_f32_16x16x32_bf16 v[76:79], v[172:175], v[36:39], v[76:79]
    v_mul_f32 v112, 0x3fb8aa3b, v104
    v_mfma_f32_16x16x32_bf16 v[80:83], v[168:171], v[40:43], v[80:83]
    ds_read_b128 v[32:35], v1 offset:53248
    v_mul_f32 v113, 0x3fb8aa3b, v105
    v_mfma_f32_16x16x32_bf16 v[84:87], v[172:175], v[40:43], v[84:87]
    v_mul_f32 v114, 0x3fb8aa3b, v106
    v_mfma_f32_16x16x32_bf16 v[88:91], v[168:171], v[44:47], v[88:91]
    ds_read_b128 v[36:39], v1 offset:54272
    buffer_load_dwordx4 v1, s[28:31], s79 offen offset:1024 sc1 lds
    v_mfma_f32_16x16x32_bf16 v[92:95], v[172:175], v[44:47], v[92:95]
    v_mul_f32 v115, 0x3fb8aa3b, v107
    s_waitcnt lgkmcnt(4) vmcnt(8)
    v_mfma_f32_16x16x32_bf16 v[64:67], v[128:131], v[48:51], v[64:67]
    ds_read_b128 v[40:43], v1 offset:55296
    v_mul_f32 v116, 0x3fb8aa3b, v108
    v_mfma_f32_16x16x32_bf16 v[68:71], v[132:135], v[48:51], v[68:71]
    v_mul_f32 v117, 0x3fb8aa3b, v109
L_pad11:
    s_cbranch_execz L_pad15
    v_mul_f32 v118, 0x3fb8aa3b, v110
    v_mfma_f32_16x16x32_bf16 v[72:75], v[128:131], v[52:55], v[72:75]
    ds_read_b128 v[44:47], v1 offset:56320
    v_mfma_f32_16x16x32_bf16 v[76:79], v[132:135], v[52:55], v[76:79]
    buffer_load_dwordx4 v1, s[28:31], s79 offen offset:2048 sc1 lds
    s_waitcnt lgkmcnt(4)
    v_mfma_f32_16x16x32_bf16 v[80:83], v[128:131], v[56:59], v[80:83]
    ds_read_b128 v[48:51], v1 offset:57344
    v_mul_f32 v119, 0x3fb8aa3b, v111
    v_mfma_f32_16x16x32_bf16 v[84:87], v[132:135], v[56:59], v[84:87]
    v_mul_f32 v120, 0x3fb8aa3b, v126
    v_mul_f32 v121, 0x3fb8aa3b, v127
    v_mfma_f32_16x16x32_bf16 v[88:91], v[128:131], v[60:63], v[88:91]
    ds_read_b128 v[52:55], v1 offset:58368
    v_accvgpr_read_b32 v24, a224
    v_mfma_f32_16x16x32_bf16 v[92:95], v[132:135], v[60:63], v[92:95]
    s_waitcnt lgkmcnt(4) vmcnt(7)
    v_mfma_f32_16x16x32_bf16 v[64:67], v[136:139], v[32:35], v[64:67]
    ds_read_b128 v[56:59], v1 offset:59392
    buffer_load_dwordx4 v1, s[28:31], s79 offen offset:3072 sc1 lds
    v_mfma_f32_16x16x32_bf16 v[68:71], v[140:143], v[32:35], v[68:71]
    ds_read2_b32 v[12:13], v24 offset0:0 offset1:16
    ds_read2_b32 v[14:15], v24 offset0:32 offset1:48
    v_mfma_f32_16x16x32_bf16 v[72:75], v[136:139], v[36:39], v[72:75]
    ds_read_b128 v[60:63], v1 offset:60416
    v_mfma_f32_16x16x32_bf16 v[76:79], v[140:143], v[36:39], v[76:79]
    s_waitcnt lgkmcnt(6)
    v_mfma_f32_16x16x32_bf16 v[80:83], v[136:139], v[40:43], v[80:83]
    ds_read_b128 v[32:35], v1 offset:61440
    v_mfma_f32_16x16x32_bf16 v[84:87], v[140:143], v[40:43], v[84:87]
    s_add_u32 m0, s82, 102400
    s_add_u32 s79, s78, 249856
    buffer_load_dwordx4 v1, s[28:31], s79 offen offset:0 sc1 lds
    v_mfma_f32_16x16x32_bf16 v[88:91], v[136:139], v[44:47], v[88:91]
    ds_read_b128 v[36:39], v1 offset:62464
    v_mfma_f32_16x16x32_bf16 v[92:95], v[140:143], v[44:47], v[92:95]
    s_waitcnt lgkmcnt(6) vmcnt(7)
    v_mfma_f32_16x16x32_bf16 v[64:67], v[144:147], v[48:51], v[64:67]
    ds_read_b128 v[40:43], v1 offset:63488
    v_mfma_f32_16x16x32_bf16 v[68:71], v[148:151], v[48:51], v[68:71]
    buffer_load_dwordx4 v1, s[28:31], s79 offen offset:1024 sc1 lds
    v_mfma_f32_16x16x32_bf16 v[72:75], v[144:147], v[52:55], v[72:75]
    ds_read_b128 v[44:47], v1 offset:64512
    v_mfma_f32_16x16x32_bf16 v[76:79], v[148:151], v[52:55], v[76:79]
    s_waitcnt lgkmcnt(4)
    v_mfma_f32_16x16x32_bf16 v[80:83], v[144:147], v[56:59], v[80:83]
    buffer_load_dwordx4 v1, s[28:31], s79 offen offset:2048 sc1 lds
    v_mfma_f32_16x16x32_bf16 v[84:87], v[148:151], v[56:59], v[84:87]
    v_mfma_f32_16x16x32_bf16 v[88:91], v[144:147], v[60:63], v[88:91]
    v_mfma_f32_16x16x32_bf16 v[92:95], v[148:151], v[60:63], v[92:95]
    s_waitcnt lgkmcnt(2) vmcnt(7)
    v_mfma_f32_16x16x32_bf16 v[64:67], v[152:155], v[32:35], v[64:67]
    v_mfma_f32_16x16x32_bf16 v[68:71], v[156:159], v[32:35], v[68:71]
    buffer_load_dwordx4 v1, s[28:31], s79 offen offset:3072 sc1 lds
    v_mfma_f32_16x16x32_bf16 v[72:75], v[152:155], v[36:39], v[72:75]
    v_mfma_f32_16x16x32_bf16 v[76:79], v[156:159], v[36:39], v[76:79]
    s_waitcnt lgkmcnt(0)
    v_mfma_f32_16x16x32_bf16 v[80:83], v[152:155], v[40:43], v[80:83]
    v_mfma_f32_16x16x32_bf16 v[84:87], v[156:159], v[40:43], v[84:87]
    v_mfma_f32_16x16x32_bf16 v[88:91], v[152:155], v[44:47], v[88:91]
    v_mfma_f32_16x16x32_bf16 v[92:95], v[156:159], v[44:47], v[92:95]
    s_barrier
    s_nop 2
    v_accvgpr_read_b32 v54, a232
    v_accvgpr_read_b32 v55, a233
    v_pk_fma_f32 v[64:65], v[96:97], v[12:13], v[64:65] op_sel:[0,0,0] op_sel_hi:[1,0,1]
    v_pk_fma_f32 v[66:67], v[98:99], v[12:13], v[66:67] op_sel:[0,0,0] op_sel_hi:[1,0,1]
    v_pk_mul_f32 v[56:57], v[64:65], v[112:113]
    v_pk_mul_f32 v[58:59], v[66:67], v[114:115]
    v_exp_f32 v56, v56 clamp
    v_exp_f32 v57, v57 clamp
    v_exp_f32 v58, v58 clamp
    v_exp_f32 v59, v59 clamp
    v_max_f32 v64, 0, v64
    v_max_f32 v65, 0, v65
    v_max_f32 v66, 0, v66
    v_max_f32 v67, 0, v67
    v_pk_fma_f32 v[64:65], v[64:65], v[104:105], v[56:57]
    v_pk_fma_f32 v[66:67], v[66:67], v[106:107], v[58:59]
    v_pk_add_f32 v[64:65], v[64:65], s[40:41]
    v_pk_add_f32 v[66:67], v[66:67], s[40:41]
    v_cvt_pk_bf16_f32 v24, v64, v65
    v_cvt_pk_bf16_f32 v25, v66, v67
    v_pk_fma_f32 v[68:69], v[100:101], v[12:13], v[68:69] op_sel:[0,0,0] op_sel_hi:[1,0,1]
    v_pk_fma_f32 v[70:71], v[102:103], v[12:13], v[70:71] op_sel:[0,0,0] op_sel_hi:[1,0,1]
    v_pk_mul_f32 v[56:57], v[68:69], v[116:117]
    v_pk_mul_f32 v[58:59], v[70:71], v[118:119]
    v_exp_f32 v56, v56 clamp
    v_exp_f32 v57, v57 clamp
    v_exp_f32 v58, v58 clamp
    v_exp_f32 v59, v59 clamp
    v_max_f32 v68, 0, v68
    v_max_f32 v69, 0, v69
    v_max_f32 v70, 0, v70
    v_max_f32 v71, 0, v71
    v_pk_fma_f32 v[68:69], v[68:69], v[108:109], v[56:57]
    v_pk_fma_f32 v[70:71], v[70:71], v[110:111], v[58:59]
    v_pk_add_f32 v[68:69], v[68:69], s[40:41]
    v_pk_add_f32 v[70:71], v[70:71], s[40:41]
    v_cvt_pk_bf16_f32 v26, v68, v69
    v_cvt_pk_bf16_f32 v27, v70, v71
    v_pk_fma_f32 v[72:73], v[96:97], v[12:13], v[72:73] op_sel:[0,1,0] op_sel_hi:[1,1,1]
    v_pk_fma_f32 v[74:75], v[98:99], v[12:13], v[74:75] op_sel:[0,1,0] op_sel_hi:[1,1,1]
    v_pk_mul_f32 v[56:57], v[72:73], v[112:113]
    v_pk_mul_f32 v[58:59], v[74:75], v[114:115]
    v_exp_f32 v56, v56 clamp
    v_exp_f32 v57, v57 clamp
    v_exp_f32 v58, v58 clamp
    v_exp_f32 v59, v59 clamp
    v_max_f32 v72, 0, v72
    v_max_f32 v73, 0, v73
    v_max_f32 v74, 0, v74
    v_max_f32 v75, 0, v75
    v_pk_fma_f32 v[72:73], v[72:73], v[104:105], v[56:57]
    v_pk_fma_f32 v[74:75], v[74:75], v[106:107], v[58:59]
    v_pk_add_f32 v[72:73], v[72:73], s[40:41]
    v_pk_add_f32 v[74:75], v[74:75], s[40:41]
    v_cvt_pk_bf16_f32 v28, v72, v73
    v_cvt_pk_bf16_f32 v29, v74, v75
    v_pk_fma_f32 v[76:77], v[100:101], v[12:13], v[76:77] op_sel:[0,1,0] op_sel_hi:[1,1,1]
    v_pk_fma_f32 v[78:79], v[102:103], v[12:13], v[78:79] op_sel:[0,1,0] op_sel_hi:[1,1,1]
    v_pk_mul_f32 v[56:57], v[76:77], v[116:117]
    v_pk_mul_f32 v[58:59], v[78:79], v[118:119]
    v_exp_f32 v56, v56 clamp
    v_exp_f32 v57, v57 clamp
    v_exp_f32 v58, v58 clamp
    v_exp_f32 v59, v59 clamp
    v_max_f32 v76, 0, v76
    v_max_f32 v77, 0, v77
    v_max_f32 v78, 0, v78
    v_max_f32 v79, 0, v79
    v_pk_fma_f32 v[76:77], v[76:77], v[108:109], v[56:57]
    v_pk_fma_f32 v[78:79], v[78:79], v[110:111], v[58:59]
    v_pk_add_f32 v[76:77], v[76:77], s[40:41]
    v_pk_add_f32 v[78:79], v[78:79], s[40:41]
    v_cvt_pk_bf16_f32 v30, v76, v77
    v_cvt_pk_bf16_f32 v31, v78, v79
    v_pk_fma_f32 v[80:81], v[96:97], v[14:15], v[80:81] op_sel:[0,0,0] op_sel_hi:[1,0,1]
    v_pk_fma_f32 v[82:83], v[98:99], v[14:15], v[82:83] op_sel:[0,0,0] op_sel_hi:[1,0,1]
    v_pk_mul_f32 v[80:81], v[80:81], v[104:105]
    v_pk_mul_f32 v[82:83], v[82:83], v[106:107]
    v_cvt_pk_bf16_f32 v64, v80, v81
    v_cvt_pk_bf16_f32 v65, v82, v83
    v_mfma_f32_16x16x32_bf16 v[72:75], v[24:27], a[248:251], 0
    v_pk_fma_f32 v[84:85], v[100:101], v[14:15], v[84:85] op_sel:[0,0,0] op_sel_hi:[1,0,1]
    v_pk_fma_f32 v[86:87], v[102:103], v[14:15], v[86:87] op_sel:[0,0,0] op_sel_hi:[1,0,1]
    v_pk_mul_f32 v[84:85], v[84:85], v[108:109]
    v_pk_mul_f32 v[86:87], v[86:87], v[110:111]
    v_cvt_pk_bf16_f32 v66, v84, v85
    v_cvt_pk_bf16_f32 v67, v86, v87
    v_pk_fma_f32 v[88:89], v[96:97], v[14:15], v[88:89] op_sel:[0,1,0] op_sel_hi:[1,1,1]
    v_pk_fma_f32 v[90:91], v[98:99], v[14:15], v[90:91] op_sel:[0,1,0] op_sel_hi:[1,1,1]
    v_pk_mul_f32 v[88:89], v[88:89], v[104:105]
    v_pk_mul_f32 v[90:91], v[90:91], v[106:107]
    v_cvt_pk_bf16_f32 v68, v88, v89
    v_cvt_pk_bf16_f32 v69, v90, v91
    v_mfma_f32_16x16x32_bf16 v[76:79], v[28:31], a[248:251], 0
    v_pk_fma_f32 v[92:93], v[100:101], v[14:15], v[92:93] op_sel:[0,1,0] op_sel_hi:[1,1,1]
    v_pk_fma_f32 v[94:95], v[102:103], v[14:15], v[94:95] op_sel:[0,1,0] op_sel_hi:[1,1,1]
    v_pk_mul_f32 v[92:93], v[92:93], v[108:109]
    v_pk_mul_f32 v[94:95], v[94:95], v[110:111]
    v_cvt_pk_bf16_f32 v70, v92, v93
    v_cvt_pk_bf16_f32 v71, v94, v95
    ds_write_b128 v54, v[72:75] offset:32768
    v_mfma_f32_16x16x32_bf16 v[80:83], v[24:27], v[64:67], 0
    v_mfma_f32_16x16x32_bf16 v[84:87], v[28:31], v[68:71], 0
    ds_write_b128 v54, v[76:79] offset:36864
    v_accvgpr_read_b32 v53, a236
    s_nop 4
    ds_write_b128 v54, v[80:83] offset:0
    ds_write_b128 v54, v[84:87] offset:16384
    s_waitcnt lgkmcnt(0)
    s_barrier
    ds_read_b128 v[32:35], v55 offset:0
    ds_read_b128 v[36:39], v55 offset:1024
    ds_read_b128 v[40:43], v55 offset:2048
    ds_read_b128 v[44:47], v55 offset:3072
    s_waitcnt lgkmcnt(2)
    v_pk_add_f32 v[32:33], v[32:33], v[36:37]
    v_pk_add_f32 v[34:35], v[34:35], v[38:39]
    s_waitcnt lgkmcnt(0)
    v_pk_add_f32 v[40:41], v[40:41], v[44:45]
    v_pk_add_f32 v[42:43], v[42:43], v[46:47]
    v_pk_add_f32 v[96:97], v[32:33], v[40:41]
    v_pk_add_f32 v[98:99], v[34:35], v[42:43]
    v_and_b32 v96, 0xffffff00, v96
    v_or_b32 v96, s77, v96
    s_mov_b64 exec, s[96:97]
    buffer_store_dwordx4 v[96:99], v53, s[28:31], s73 offen sc1
    s_mov_b64 exec, -1
    v_accvgpr_read_b32 v12, a225
    ds_read_b128 v[88:91], v12 offset:256
    ds_read_b128 v[92:95], v12 offset:320
    v_accvgpr_read_b32 v14, a246
    s_add_u32 s44, s72, 4096
    s_lshl_b32 s47, s32, 14
    v_add_u32 v15, s47, v1
    ds_read_b128 v[32:35], v2 offset:20480
    ds_read_b128 v[36:39], v2 offset:21504
    ds_read_b128 v[40:43], v2 offset:22528
    ds_read_b128 v[44:47], v2 offset:23552
    ds_read_b128 v[48:51], v2 offset:24576
    ds_read_b128 v[52:55], v2 offset:25600
    s_waitcnt lgkmcnt(4)
    v_mfma_f32_16x16x32_bf16 v[176:179], v[32:35], v[160:163], v[176:179]
    ds_read_b128 v[56:59], v2 offset:26624
    v_mfma_f32_16x16x32_bf16 v[180:183], v[32:35], v[164:167], v[180:183]
    ds_write_b128 v15, v[192:195] offset:0
    v_mfma_f32_16x16x32_bf16 v[184:187], v[36:39], v[160:163], v[184:187]
    ds_read_b128 v[60:63], v2 offset:27648
    v_mfma_f32_16x16x32_bf16 v[188:191], v[36:39], v[164:167], v[188:191]
    s_waitcnt lgkmcnt(5)
    v_mfma_f32_16x16x32_bf16 v[176:179], v[40:43], v[168:171], v[176:179]
    ds_read_b128 v[32:35], v2 offset:28672
    v_mfma_f32_16x16x32_bf16 v[180:183], v[40:43], v[172:175], v[180:183]
    ds_write_b128 v15, v[196:199] offset:1024
    v_mfma_f32_16x16x32_bf16 v[184:187], v[44:47], v[168:171], v[184:187]
    ds_read_b128 v[36:39], v2 offset:29696
    v_mfma_f32_16x16x32_bf16 v[188:191], v[44:47], v[172:175], v[188:191]
    s_waitcnt lgkmcnt(6)
    v_mfma_f32_16x16x32_bf16 v[176:179], v[48:51], v[128:131], v[176:179]
    ds_read_b128 v[40:43], v2 offset:30720
    v_mfma_f32_16x16x32_bf16 v[180:183], v[48:51], v[132:135], v[180:183]
    ds_write_b128 v15, v[200:203] offset:2048
    v_mfma_f32_16x16x32_bf16 v[184:187], v[52:55], v[128:131], v[184:187]
    ds_read_b128 v[44:47], v2 offset:31744
    v_mfma_f32_16x16x32_bf16 v[188:191], v[52:55], v[132:135], v[188:191]
    s_waitcnt lgkmcnt(6)
    v_mfma_f32_16x16x32_bf16 v[176:179], v[56:59], v[136:139], v[176:179]
    v_mfma_f32_16x16x32_bf16 v[180:183], v[56:59], v[140:143], v[180:183]
    ds_write_b128 v15, v[204:207] offset:3072
    v_mfma_f32_16x16x32_bf16 v[184:187], v[60:63], v[136:139], v[184:187]
    v_mfma_f32_16x16x32_bf16 v[188:191], v[60:63], v[140:143], v[188:191]
    s_waitcnt lgkmcnt(4)
    v_mfma_f32_16x16x32_bf16 v[176:179], v[32:35], v[144:147], v[176:179]
    v_mfma_f32_16x16x32_bf16 v[180:183], v[32:35], v[148:151], v[180:183]
    ds_write_b128 v15, v[208:211] offset:4096
    v_mfma_f32_16x16x32_bf16 v[184:187], v[36:39], v[144:147], v[184:187]
    v_mfma_f32_16x16x32_bf16 v[188:191], v[36:39], v[148:151], v[188:191]
    s_waitcnt lgkmcnt(2)
    v_mfma_f32_16x16x32_bf16 v[176:179], v[40:43], v[152:155], v[176:179]
    v_mfma_f32_16x16x32_bf16 v[180:183], v[40:43], v[156:159], v[180:183]
    ds_write_b128 v15, v[212:215] offset:5120
    v_mfma_f32_16x16x32_bf16 v[184:187], v[44:47], v[152:155], v[184:187]
    v_mfma_f32_16x16x32_bf16 v[188:191], v[44:47], v[156:159], v[188:191]
    s_barrier
    s_nop 3
    s_mul_i32 s82, s32, 8192
    s_add_u32 s78, s82, s84
    s_mul_i32 s79, s74, 2228224
    s_sub_u32 s78, s78, s79
    s_add_u32 m0, s82, 65536
    s_add_u32 s79, s78, 212992
    buffer_load_dwordx4 v1, s[28:31], s79 offen offset:0 sc1 lds
    buffer_load_dwordx4 v1, s[28:31], s79 offen offset:1024 sc1 lds
    buffer_load_dwordx4 v1, s[28:31], s79 offen offset:2048 sc1 lds
    buffer_load_dwordx4 v1, s[28:31], s79 offen offset:3072 sc1 lds
    s_waitcnt lgkmcnt(0)
    v_pk_fma_f32 v[176:177], v[88:89], v[124:125], v[176:177] op_sel:[0,0,0] op_sel_hi:[1,0,1]
    v_pk_fma_f32 v[178:179], v[90:91], v[124:125], v[178:179] op_sel:[0,0,0] op_sel_hi:[1,0,1]
    v_pk_mul_f32 v[32:33], v[176:177], v[120:121] op_sel:[0,0] op_sel_hi:[1,0]
    v_pk_mul_f32 v[34:35], v[178:179], v[120:121] op_sel:[0,0] op_sel_hi:[1,0]
    v_exp_f32 v32, v32 clamp
    ds_write_b128 v15, v[216:219] offset:6144
    v_exp_f32 v33, v33 clamp
    v_exp_f32 v34, v34 clamp
    v_exp_f32 v35, v35 clamp
    v_max_f32 v176, 0, v176
    s_add_u32 m0, s82, 69632
    s_add_u32 s79, s78, 217088
    buffer_load_dwordx4 v1, s[28:31], s79 offen offset:0 sc1 lds
    v_max_f32 v177, 0, v177
    ds_write_b128 v15, v[220:223] offset:7168
    v_max_f32 v178, 0, v178
    v_max_f32 v179, 0, v179
    v_pk_fma_f32 v[176:177], v[176:177], v[126:127], v[32:33] op_sel:[0,0,0] op_sel_hi:[1,0,1]
    v_pk_fma_f32 v[178:179], v[178:179], v[126:127], v[34:35] op_sel:[0,0,0] op_sel_hi:[1,0,1]
    v_pk_add_f32 v[176:177], v[176:177], s[40:41]
    ds_write_b128 v15, v[224:227] offset:8192
    v_pk_add_f32 v[178:179], v[178:179], s[40:41]
L_pad12:
    s_cbranch_execz L_pad16
    v_cvt_pk_bf16_f32 v24, v176, v177
    buffer_load_dwordx4 v1, s[28:31], s79 offen offset:1024 sc1 lds
    v_cvt_pk_bf16_f32 v25, v178, v179
    v_pk_fma_f32 v[180:181], v[88:89], v[124:125], v[180:181] op_sel:[0,1,0] op_sel_hi:[1,1,1]
    v_pk_fma_f32 v[182:183], v[90:91], v[124:125], v[182:183] op_sel:[0,1,0] op_sel_hi:[1,1,1]
    ds_write_b128 v15, v[228:231] offset:9216
    v_pk_mul_f32 v[32:33], v[180:181], v[120:121] op_sel:[0,1] op_sel_hi:[1,1]
    v_pk_mul_f32 v[34:35], v[182:183], v[120:121] op_sel:[0,1] op_sel_hi:[1,1]
    v_exp_f32 v32, v32 clamp
    v_exp_f32 v33, v33 clamp
    v_exp_f32 v34, v34 clamp
    ds_write_b128 v15, v[232:235] offset:10240
    buffer_load_dwordx4 v1, s[28:31], s79 offen offset:2048 sc1 lds
    v_exp_f32 v35, v35 clamp
    v_max_f32 v180, 0, v180
    v_max_f32 v181, 0, v181
    v_max_f32 v182, 0, v182
    v_max_f32 v183, 0, v183
    ds_write_b128 v15, v[236:239] offset:11264
    v_pk_fma_f32 v[180:181], v[180:181], v[126:127], v[32:33] op_sel:[0,1,0] op_sel_hi:[1,1,1]
    v_pk_fma_f32 v[182:183], v[182:183], v[126:127], v[34:35] op_sel:[0,1,0] op_sel_hi:[1,1,1]
    v_pk_add_f32 v[180:181], v[180:181], s[40:41]
    v_pk_add_f32 v[182:183], v[182:183], s[40:41]
    buffer_load_dwordx4 v1, s[28:31], s79 offen offset:3072 sc1 lds
    v_cvt_pk_bf16_f32 v26, v180, v181
    ds_write_b128 v15, v[240:243] offset:12288
    v_cvt_pk_bf16_f32 v27, v182, v183
    v_pk_fma_f32 v[184:185], v[92:93], v[124:125], v[184:185] op_sel:[0,0,0] op_sel_hi:[1,0,1]
    v_pk_fma_f32 v[186:187], v[94:95], v[124:125], v[186:187] op_sel:[0,0,0] op_sel_hi:[1,0,1]
    v_pk_mul_f32 v[32:33], v[184:185], v[120:121] op_sel:[0,0] op_sel_hi:[1,0]
    v_pk_mul_f32 v[34:35], v[186:187], v[120:121] op_sel:[0,0] op_sel_hi:[1,0]
    ds_write_b128 v15, v[244:247] offset:13312
    v_exp_f32 v32, v32 clamp
    v_exp_f32 v33, v33 clamp
    v_exp_f32 v34, v34 clamp
    v_exp_f32 v35, v35 clamp
    v_max_f32 v184, 0, v184
    ds_write_b128 v15, v[248:251] offset:14336
    v_max_f32 v185, 0, v185
    v_max_f32 v186, 0, v186
    v_max_f32 v187, 0, v187
    v_pk_fma_f32 v[184:185], v[184:185], v[126:127], v[32:33] op_sel:[0,0,0] op_sel_hi:[1,0,1]
    v_pk_fma_f32 v[186:187], v[186:187], v[126:127], v[34:35] op_sel:[0,0,0] op_sel_hi:[1,0,1]
    ds_write_b128 v15, v[252:255] offset:15360
    v_pk_add_f32 v[184:185], v[184:185], s[40:41]
    v_pk_add_f32 v[186:187], v[186:187], s[40:41]
    v_cvt_pk_bf16_f32 v28, v184, v185
    v_cvt_pk_bf16_f32 v29, v186, v187
    v_pk_fma_f32 v[188:189], v[92:93], v[124:125], v[188:189] op_sel:[0,1,0] op_sel_hi:[1,1,1]
    v_pk_fma_f32 v[190:191], v[94:95], v[124:125], v[190:191] op_sel:[0,1,0] op_sel_hi:[1,1,1]
    v_pk_mul_f32 v[32:33], v[188:189], v[120:121] op_sel:[0,1] op_sel_hi:[1,1]
    v_pk_mul_f32 v[34:35], v[190:191], v[120:121] op_sel:[0,1] op_sel_hi:[1,1]
    v_exp_f32 v32, v32 clamp
    v_exp_f32 v33, v33 clamp
    v_exp_f32 v34, v34 clamp
    v_exp_f32 v35, v35 clamp
    v_max_f32 v188, 0, v188
    v_max_f32 v189, 0, v189
    v_max_f32 v190, 0, v190
    v_max_f32 v191, 0, v191
    v_pk_fma_f32 v[188:189], v[188:189], v[126:127], v[32:33] op_sel:[0,1,0] op_sel_hi:[1,1,1]
    v_pk_fma_f32 v[190:191], v[190:191], v[126:127], v[34:35] op_sel:[0,1,0] op_sel_hi:[1,1,1]
    v_pk_add_f32 v[188:189], v[188:189], s[40:41]
    v_pk_add_f32 v[190:191], v[190:191], s[40:41]
    v_cvt_pk_bf16_f32 v30, v188, v189
    v_cvt_pk_bf16_f32 v31, v190, v191
    buffer_load_dwordx4 v[160:163], v14, s[28:31], s72 offen sc1
    buffer_load_dwordx4 v[128:131], v1, s[28:31], s72 offen offset:0 sc1
    buffer_load_dwordx4 v[132:135], v1, s[28:31], s72 offen offset:1024 sc1
    buffer_load_dwordx4 v[136:139], v1, s[28:31], s72 offen offset:2048 sc1
    buffer_load_dwordx4 v[140:143], v1, s[28:31], s72 offen offset:3072 sc1
    buffer_load_dwordx4 v[144:147], v1, s[28:31], s44 offen offset:0 sc1
    buffer_load_dwordx4 v[148:151], v1, s[28:31], s44 offen offset:1024 sc1
    buffer_load_dwordx4 v[152:155], v1, s[28:31], s44 offen offset:2048 sc1
    buffer_load_dwordx4 v[156:159], v1, s[28:31], s44 offen offset:3072 sc1
    v_accvgpr_read_b32 v13, a237
    v_accvgpr_read_b32 v50, a247
    v_accvgpr_read_b32 v48, a238
    v_accvgpr_read_b32 v49, a239
    s_branch L_kp_49_s
L_kp_49:
    buffer_load_dwordx4 v[160:163], v14, s[28:31], s72 offen sc1
    buffer_load_dwordx4 v[128:131], v1, s[28:31], s72 offen offset:0 sc1
    buffer_load_dwordx4 v[132:135], v1, s[28:31], s72 offen offset:1024 sc1
    buffer_load_dwordx4 v[136:139], v1, s[28:31], s72 offen offset:2048 sc1
    buffer_load_dwordx4 v[140:143], v1, s[28:31], s72 offen offset:3072 sc1
    buffer_load_dwordx4 v[144:147], v1, s[28:31], s44 offen offset:0 sc1
    buffer_load_dwordx4 v[148:151], v1, s[28:31], s44 offen offset:1024 sc1
    buffer_load_dwordx4 v[152:155], v1, s[28:31], s44 offen offset:2048 sc1
    buffer_load_dwordx4 v[156:159], v1, s[28:31], s44 offen offset:3072 sc1
    s_waitcnt vmcnt(0)
L_kp_49_s:
    s_waitcnt vmcnt(8)
    v_xor_b32 v160, s77, v160
    v_mov_b32 v44, v160
    v_permlane32_swap_b32 v162, v163
    v_permlane32_swap_b32 v160, v161
    v_add_f32 v160, v160, v161
    v_add_f32 v162, v162, v163
    s_nop 1
    v_permlane16_swap_b32 v160, v162
    v_add_f32 v160, v160, v162
    s_nop 1
    v_add_f32_dpp v160, v160, v160 row_ror:4 row_mask:0xf bank_mask:0xf
    s_nop 1
    v_add_f32_dpp v160, v160, v160 row_ror:8 row_mask:0xf bank_mask:0xf
    v_cvt_pk_bf16_f32 v160, v160, v160
    ds_write_b16 v50, v160
    s_waitcnt vmcnt(6)
    v_xor_b32 v128, s77, v128
    v_xor_b32 v132, s77, v132
    v_or3_b32 v44, v44, v128, v132
    v_pk_add_f32 v[40:41], v[128:129], v[132:133]
    v_pk_add_f32 v[42:43], v[130:131], v[134:135]
    s_waitcnt vmcnt(4)
    v_xor_b32 v136, s77, v136
    v_xor_b32 v140, s77, v140
    v_or3_b32 v44, v44, v136, v140
    v_pk_add_f32 v[136:137], v[136:137], v[140:141]
    v_pk_add_f32 v[138:139], v[138:139], v[142:143]
    v_pk_add_f32 v[40:41], v[40:41], v[136:137]
    v_pk_add_f32 v[42:43], v[42:43], v[138:139]
    s_waitcnt vmcnt(2)
    v_xor_b32 v144, s77, v144
    v_xor_b32 v148, s77, v148
    v_or3_b32 v44, v44, v144, v148
    v_pk_add_f32 v[144:145], v[144:145], v[148:149]
    v_pk_add_f32 v[146:147], v[146:147], v[150:151]
    v_pk_add_f32 v[40:41], v[40:41], v[144:145]
    v_pk_add_f32 v[42:43], v[42:43], v[146:147]
    s_waitcnt vmcnt(0)
    v_xor_b32 v152, s77, v152
    v_xor_b32 v156, s77, v156
    v_or3_b32 v44, v44, v152, v156
    v_pk_add_f32 v[152:153], v[152:153], v[156:157]
    v_pk_add_f32 v[154:155], v[154:155], v[158:159]
    v_pk_add_f32 v[40:41], v[40:41], v[152:153]
    v_pk_add_f32 v[42:43], v[42:43], v[154:155]
    ds_write_b128 v13, v[40:43]
    v_and_b32 v44, 0xff, v44
    v_cmp_ne_u32 vcc, 0, v44
    s_cbranch_vccz L_kd_50
    s_waitcnt lgkmcnt(0)
    s_sub_u32 s38, s38, 4
    s_cbranch_scc0 L_kp_49
    s_mov_b32 s38, 0
L_kd_50:
    s_waitcnt lgkmcnt(0)
    s_barrier
    ds_read_b64 v[34:35], v49 offset:0
    ds_read_b64 v[38:39], v49 offset:32
    ds_read_b128 v[128:131], v48 offset:0
    ds_read_b128 v[132:135], v48 offset:1024
    ds_read_b128 v[136:139], v48 offset:2048
    ds_read_b128 v[140:143], v48 offset:3072
    s_waitcnt lgkmcnt(4)
    v_mfma_f32_16x16x16_bf16 v[84:87], v[34:35], v[24:25], 0
    v_mfma_f32_16x16x16_bf16 v[92:95], v[38:39], v[28:29], 0
    v_mfma_f32_16x16x16_bf16 v[100:103], v[34:35], v[26:27], 0
    v_mfma_f32_16x16x16_bf16 v[108:111], v[38:39], v[30:31], 0
    s_waitcnt lgkmcnt(0)
    v_pk_add_f32 v[128:129], v[128:129], v[132:133]
    v_pk_add_f32 v[130:131], v[130:131], v[134:135]
    v_pk_add_f32 v[136:137], v[136:137], v[140:141]
    v_pk_add_f32 v[138:139], v[138:139], v[142:143]
    v_cvt_pk_bf16_f32 v32, v128, v129
    v_cvt_pk_bf16_f32 v33, v130, v131
    v_cvt_pk_bf16_f32 v36, v136, v137
    v_cvt_pk_bf16_f32 v37, v138, v139
    v_add_f32 v84, s40, v84
    v_add_f32 v92, s40, v92
    v_add_f32 v100, s40, v100
    v_add_f32 v108, s40, v108
    v_mfma_f32_16x16x16_bf16 v[80:83], v[32:33], v[24:25], 0
    v_mfma_f32_16x16x16_bf16 v[88:91], v[36:37], v[28:29], 0
    v_mfma_f32_16x16x16_bf16 v[96:99], v[32:33], v[26:27], 0
    v_mfma_f32_16x16x16_bf16 v[104:107], v[36:37], v[30:31], 0
    v_rcp_f32 v84, v84
    v_rcp_f32 v92, v92
    v_rcp_f32 v100, v100
    v_rcp_f32 v108, v108
    s_nop 1
    v_pk_mul_f32 v[80:81], v[80:81], v[84:85] op_sel_hi:[1,0]
    v_pk_mul_f32 v[82:83], v[82:83], v[84:85] op_sel_hi:[1,0]
    v_cvt_pk_bf16_f32 v24, v80, v81
    v_cvt_pk_bf16_f32 v25, v82, v83
    v_pk_mul_f32 v[88:89], v[88:89], v[92:93] op_sel_hi:[1,0]
    v_pk_mul_f32 v[90:91], v[90:91], v[92:93] op_sel_hi:[1,0]
    v_cvt_pk_bf16_f32 v26, v88, v89
    v_cvt_pk_bf16_f32 v27, v90, v91
    v_pk_mul_f32 v[96:97], v[96:97], v[100:101] op_sel_hi:[1,0]
    v_pk_mul_f32 v[98:99], v[98:99], v[100:101] op_sel_hi:[1,0]
    v_cvt_pk_bf16_f32 v28, v96, v97
    v_cvt_pk_bf16_f32 v29, v98, v99
    v_pk_mul_f32 v[104:105], v[104:105], v[108:109] op_sel_hi:[1,0]
    v_pk_mul_f32 v[106:107], v[106:107], v[108:109] op_sel_hi:[1,0]
    v_cvt_pk_bf16_f32 v30, v104, v105
    v_cvt_pk_bf16_f32 v31, v106, v107
    s_cmp_lg_u32 s36, 0
    s_cbranch_scc1 L_ss_51
    buffer_store_dwordx4 v[24:27], v1, s[28:31], s52 offen nt
    buffer_store_dwordx4 v[28:31], v1, s[28:31], s53 offen nt
L_se_52:
    v_accvgpr_read_b32 v15, a226
    v_mov_b32 v13, s35
    s_waitcnt vmcnt(0)
    s_mov_b64 exec, 1
    s_cmp_lg_u32 s36, 0
    s_cbranch_scc1 L_ss_53
    buffer_store_dword v13, v1, s[28:31], s54 offen offset:0
L_se_54:
    s_mov_b64 exec, -1
    buffer_load_dword v12, v15, s[28:31], s55 offen offset:0 sc1
    ds_read_b128 v[32:35], v2 offset:0
    ds_read_b128 v[36:39], v2 offset:1024
    ds_read_b128 v[40:43], v2 offset:2048
    ds_read_b128 v[44:47], v2 offset:3072
    ds_read_b128 v[48:51], v2 offset:4096
    ds_read_b128 v[52:55], v2 offset:5120
    ds_read_b128 v[56:59], v2 offset:6144
    v_lshlrev_b32 v64, 16, v16
    v_and_b32 v65, 0xffff0000, v16
    v_lshlrev_b32 v66, 16, v17
    v_and_b32 v67, 0xffff0000, v17
    v_lshlrev_b32 v68, 16, v18
    v_and_b32 v69, 0xffff0000, v18
    v_lshlrev_b32 v70, 16, v19
    v_and_b32 v71, 0xffff0000, v19
    v_lshlrev_b32 v72, 16, v20
    v_and_b32 v73, 0xffff0000, v20
    v_lshlrev_b32 v74, 16, v21
    v_and_b32 v75, 0xffff0000, v21
    v_lshlrev_b32 v76, 16, v22
    v_and_b32 v77, 0xffff0000, v22
    v_lshlrev_b32 v78, 16, v23
    v_and_b32 v79, 0xffff0000, v23
L_poll_55:
    buffer_load_dword v14, v15, s[28:31], s55 offen offset:0 sc1
    s_waitcnt vmcnt(1)
    v_cmp_ne_u32 vcc, s35, v12
    s_cbranch_vccz L_pd_56
    buffer_load_dword v12, v15, s[28:31], s55 offen offset:0 sc1
    s_waitcnt vmcnt(1)
    v_cmp_ne_u32 vcc, s35, v14
    s_cbranch_vccz L_pd_56
    s_sub_u32 s38, s38, 1
    s_cbranch_scc0 L_poll_55
    s_mov_b32 s38, 0
L_pd_56:
    s_add_u32 s44, s50, 163840
    buffer_load_dwordx4 v[128:131], v1, s[28:31], s44 offen offset:0 sc1
    buffer_load_dwordx4 v[132:135], v1, s[28:31], s44 offen offset:1024 sc1
    buffer_load_dwordx4 v[136:139], v1, s[28:31], s44 offen offset:2048 sc1
    buffer_load_dwordx4 v[140:143], v1, s[28:31], s44 offen offset:3072 sc1
    s_add_u32 s44, s50, 167936
    buffer_load_dwordx4 v[144:147], v1, s[28:31], s44 offen offset:0 sc1
    buffer_load_dwordx4 v[148:151], v1, s[28:31], s44 offen offset:1024 sc1
    buffer_load_dwordx4 v[152:155], v1, s[28:31], s44 offen offset:2048 sc1
    buffer_load_dwordx4 v[156:159], v1, s[28:31], s44 offen offset:3072 sc1
    s_waitcnt lgkmcnt(5) vmcnt(7)
    v_mfma_f32_16x16x32_bf16 v[64:67], v[32:35], v[128:131], v[64:67]
    ds_read_b128 v[60:63], v2 offset:7168
    v_mfma_f32_16x16x32_bf16 v[68:71], v[36:39], v[128:131], v[68:71]
    ds_read_b128 v[32:35], v2 offset:8192
    s_waitcnt lgkmcnt(5)
    v_mfma_f32_16x16x32_bf16 v[72:75], v[40:43], v[128:131], v[72:75]
    ds_read_b128 v[36:39], v2 offset:9216
    v_mfma_f32_16x16x32_bf16 v[76:79], v[44:47], v[128:131], v[76:79]
    ds_read_b128 v[40:43], v2 offset:10240
    s_add_u32 s44, s50, 172032
    buffer_load_dwordx4 v[160:163], v1, s[28:31], s44 offen offset:0 sc1
    s_waitcnt lgkmcnt(5) vmcnt(7)
    v_mfma_f32_16x16x32_bf16 v[64:67], v[48:51], v[132:135], v[64:67]
    ds_read_b128 v[44:47], v2 offset:11264
    v_mfma_f32_16x16x32_bf16 v[68:71], v[52:55], v[132:135], v[68:71]
    ds_read_b128 v[48:51], v2 offset:12288
    s_waitcnt lgkmcnt(5)
    v_mfma_f32_16x16x32_bf16 v[72:75], v[56:59], v[132:135], v[72:75]
    ds_read_b128 v[52:55], v2 offset:13312
    buffer_load_dwordx4 v[164:167], v1, s[28:31], s44 offen offset:1024 sc1
    v_mfma_f32_16x16x32_bf16 v[76:79], v[60:63], v[132:135], v[76:79]
    ds_read_b128 v[56:59], v2 offset:14336
    s_waitcnt lgkmcnt(5) vmcnt(7)
    v_mfma_f32_16x16x32_bf16 v[64:67], v[32:35], v[136:139], v[64:67]
    ds_read_b128 v[60:63], v2 offset:15360
    v_mfma_f32_16x16x32_bf16 v[68:71], v[36:39], v[136:139], v[68:71]
    ds_read_b128 v[32:35], v2 offset:16384
    buffer_load_dwordx4 v[168:171], v1, s[28:31], s44 offen offset:2048 sc1
    s_waitcnt lgkmcnt(5)
    v_mfma_f32_16x16x32_bf16 v[72:75], v[40:43], v[136:139], v[72:75]
    ds_read_b128 v[36:39], v2 offset:17408
    v_mfma_f32_16x16x32_bf16 v[76:79], v[44:47], v[136:139], v[76:79]
    ds_read_b128 v[40:43], v2 offset:18432
    s_waitcnt lgkmcnt(5) vmcnt(7)
    v_mfma_f32_16x16x32_bf16 v[64:67], v[48:51], v[140:143], v[64:67]
    ds_read_b128 v[44:47], v2 offset:19456
    buffer_load_dwordx4 v[172:175], v1, s[28:31], s44 offen offset:3072 sc1
    v_mfma_f32_16x16x32_bf16 v[68:71], v[52:55], v[140:143], v[68:71]
    ds_read_b128 v[48:51], v2 offset:20480
    s_waitcnt lgkmcnt(5)
    v_mfma_f32_16x16x32_bf16 v[72:75], v[56:59], v[140:143], v[72:75]
    ds_read_b128 v[52:55], v2 offset:21504
    v_mfma_f32_16x16x32_bf16 v[76:79], v[60:63], v[140:143], v[76:79]
    ds_read_b128 v[56:59], v2 offset:22528
    s_add_u32 s44, s50, 176128
    buffer_load_dwordx4 v[176:179], v1, s[28:31], s44 offen offset:0 sc1
    s_waitcnt lgkmcnt(5) vmcnt(8)
    v_mfma_f32_16x16x32_bf16 v[64:67], v[32:35], v[144:147], v[64:67]
L_pad13:
    s_cbranch_execz L_pad17
    ds_read_b128 v[60:63], v2 offset:23552
    v_mfma_f32_16x16x32_bf16 v[68:71], v[36:39], v[144:147], v[68:71]
    ds_read_b128 v[32:35], v2 offset:24576
    s_waitcnt lgkmcnt(5)
    v_mfma_f32_16x16x32_bf16 v[72:75], v[40:43], v[144:147], v[72:75]
    ds_read_b128 v[36:39], v2 offset:25600
    buffer_load_dwordx4 v[180:183], v1, s[28:31], s44 offen offset:1024 sc1
    v_mfma_f32_16x16x32_bf16 v[76:79], v[44:47], v[144:147], v[76:79]
    ds_read_b128 v[40:43], v2 offset:26624
    s_waitcnt lgkmcnt(5) vmcnt(8)
    v_mfma_f32_16x16x32_bf16 v[64:67], v[48:51], v[148:151], v[64:67]
    ds_read_b128 v[44:47], v2 offset:27648
    v_mfma_f32_16x16x32_bf16 v[68:71], v[52:55], v[148:151], v[68:71]
    ds_read_b128 v[48:51], v2 offset:28672
    buffer_load_dwordx4 v[184:187], v1, s[28:31], s44 offen offset:2048 sc1
    s_waitcnt lgkmcnt(5)
    v_mfma_f32_16x16x32_bf16 v[72:75], v[56:59], v[148:151], v[72:75]
    ds_read_b128 v[52:55], v2 offset:29696
    v_mfma_f32_16x16x32_bf16 v[76:79], v[60:63], v[148:151], v[76:79]
    ds_read_b128 v[56:59], v2 offset:30720
    s_waitcnt lgkmcnt(5) vmcnt(8)
    v_mfma_f32_16x16x32_bf16 v[64:67], v[32:35], v[152:155], v[64:67]
    ds_read_b128 v[60:63], v2 offset:31744
    buffer_load_dwordx4 v[188:191], v1, s[28:31], s44 offen offset:3072 sc1
    v_mfma_f32_16x16x32_bf16 v[68:71], v[36:39], v[152:155], v[68:71]
    ds_read_b128 v[32:35], v2 offset:32768
    s_waitcnt lgkmcnt(5)
    v_mfma_f32_16x16x32_bf16 v[72:75], v[40:43], v[152:155], v[72:75]
    ds_read_b128 v[36:39], v2 offset:33792
    v_mfma_f32_16x16x32_bf16 v[76:79], v[44:47], v[152:155], v[76:79]
    ds_read_b128 v[40:43], v2 offset:34816
    s_waitcnt lgkmcnt(5) vmcnt(8)
    v_mfma_f32_16x16x32_bf16 v[64:67], v[48:51], v[156:159], v[64:67]
    ds_read_b128 v[44:47], v2 offset:35840
    v_mfma_f32_16x16x32_bf16 v[68:71], v[52:55], v[156:159], v[68:71]
    ds_read_b128 v[48:51], v2 offset:36864
    s_waitcnt lgkmcnt(5)
    v_mfma_f32_16x16x32_bf16 v[72:75], v[56:59], v[156:159], v[72:75]
    ds_read_b128 v[52:55], v2 offset:37888
    v_mfma_f32_16x16x32_bf16 v[76:79], v[60:63], v[156:159], v[76:79]
    ds_read_b128 v[56:59], v2 offset:38912
    s_waitcnt lgkmcnt(5) vmcnt(7)
    v_mfma_f32_16x16x32_bf16 v[64:67], v[32:35], v[160:163], v[64:67]
    ds_read_b128 v[60:63], v2 offset:39936
    v_mfma_f32_16x16x32_bf16 v[68:71], v[36:39], v[160:163], v[68:71]
    ds_read_b128 v[32:35], v2 offset:40960
    s_waitcnt lgkmcnt(5)
    v_mfma_f32_16x16x32_bf16 v[72:75], v[40:43], v[160:163], v[72:75]
    ds_read_b128 v[36:39], v2 offset:41984
    v_mfma_f32_16x16x32_bf16 v[76:79], v[44:47], v[160:163], v[76:79]
    ds_read_b128 v[40:43], v2 offset:43008
    s_waitcnt lgkmcnt(5) vmcnt(6)
    v_mfma_f32_16x16x32_bf16 v[64:67], v[48:51], v[164:167], v[64:67]
    ds_read_b128 v[44:47], v2 offset:44032
    v_mfma_f32_16x16x32_bf16 v[68:71], v[52:55], v[164:167], v[68:71]
    ds_read_b128 v[48:51], v2 offset:45056
    s_waitcnt lgkmcnt(5)
    v_mfma_f32_16x16x32_bf16 v[72:75], v[56:59], v[164:167], v[72:75]
    ds_read_b128 v[52:55], v2 offset:46080
    v_mfma_f32_16x16x32_bf16 v[76:79], v[60:63], v[164:167], v[76:79]
    ds_read_b128 v[56:59], v2 offset:47104
    s_waitcnt lgkmcnt(5) vmcnt(5)
    v_mfma_f32_16x16x32_bf16 v[64:67], v[32:35], v[168:171], v[64:67]
    ds_read_b128 v[60:63], v2 offset:48128
    v_mfma_f32_16x16x32_bf16 v[68:71], v[36:39], v[168:171], v[68:71]
    ds_read_b128 v[32:35], v2 offset:49152
    s_waitcnt lgkmcnt(5)
    v_mfma_f32_16x16x32_bf16 v[72:75], v[40:43], v[168:171], v[72:75]
    ds_read_b128 v[36:39], v2 offset:50176
    v_mfma_f32_16x16x32_bf16 v[76:79], v[44:47], v[168:171], v[76:79]
    ds_read_b128 v[40:43], v2 offset:51200
    s_waitcnt lgkmcnt(5) vmcnt(4)
    v_mfma_f32_16x16x32_bf16 v[64:67], v[48:51], v[172:175], v[64:67]
    ds_read_b128 v[44:47], v2 offset:52224
    v_mfma_f32_16x16x32_bf16 v[68:71], v[52:55], v[172:175], v[68:71]
    ds_read_b128 v[48:51], v2 offset:53248
    s_waitcnt lgkmcnt(5)
    v_mfma_f32_16x16x32_bf16 v[72:75], v[56:59], v[172:175], v[72:75]
    ds_read_b128 v[52:55], v2 offset:54272
    v_mfma_f32_16x16x32_bf16 v[76:79], v[60:63], v[172:175], v[76:79]
    ds_read_b128 v[56:59], v2 offset:55296
    s_waitcnt lgkmcnt(5) vmcnt(3)
    v_mfma_f32_16x16x32_bf16 v[64:67], v[32:35], v[176:179], v[64:67]
    ds_read_b128 v[60:63], v2 offset:56320
    v_mfma_f32_16x16x32_bf16 v[68:71], v[36:39], v[176:179], v[68:71]
    ds_read_b128 v[32:35], v2 offset:57344
    s_waitcnt lgkmcnt(5)
    v_mfma_f32_16x16x32_bf16 v[72:75], v[40:43], v[176:179], v[72:75]
    ds_read_b128 v[36:39], v2 offset:58368
    v_mfma_f32_16x16x32_bf16 v[76:79], v[44:47], v[176:179], v[76:79]
    ds_read_b128 v[40:43], v2 offset:59392
    s_waitcnt lgkmcnt(5) vmcnt(2)
    v_mfma_f32_16x16x32_bf16 v[64:67], v[48:51], v[180:183], v[64:67]
    ds_read_b128 v[44:47], v2 offset:60416
    v_mfma_f32_16x16x32_bf16 v[68:71], v[52:55], v[180:183], v[68:71]
    ds_read_b128 v[48:51], v2 offset:61440
    s_waitcnt lgkmcnt(5)
    v_mfma_f32_16x16x32_bf16 v[72:75], v[56:59], v[180:183], v[72:75]
    ds_read_b128 v[52:55], v2 offset:62464
    v_mfma_f32_16x16x32_bf16 v[76:79], v[60:63], v[180:183], v[76:79]
    ds_read_b128 v[56:59], v2 offset:63488
    s_waitcnt lgkmcnt(5) vmcnt(1)
    v_mfma_f32_16x16x32_bf16 v[64:67], v[32:35], v[184:187], v[64:67]
    ds_read_b128 v[60:63], v2 offset:64512
    v_mfma_f32_16x16x32_bf16 v[68:71], v[36:39], v[184:187], v[68:71]
    s_waitcnt lgkmcnt(4)
    v_mfma_f32_16x16x32_bf16 v[72:75], v[40:43], v[184:187], v[72:75]
    v_mfma_f32_16x16x32_bf16 v[76:79], v[44:47], v[184:187], v[76:79]
    s_waitcnt lgkmcnt(2) vmcnt(0)
    v_mfma_f32_16x16x32_bf16 v[64:67], v[48:51], v[188:191], v[64:67]
    v_mfma_f32_16x16x32_bf16 v[68:71], v[52:55], v[188:191], v[68:71]
    s_waitcnt lgkmcnt(0)
    v_mfma_f32_16x16x32_bf16 v[72:75], v[56:59], v[188:191], v[72:75]
    v_mfma_f32_16x16x32_bf16 v[76:79], v[60:63], v[188:191], v[76:79]
    v_add_u32 v3, 65536, v1
    s_nop 6
    v_cvt_pk_bf16_f32 v16, v64, v65
    v_cvt_pk_bf16_f32 v17, v66, v67
    v_cvt_pk_bf16_f32 v18, v68, v69
    v_cvt_pk_bf16_f32 v19, v70, v71
    v_cvt_pk_bf16_f32 v20, v72, v73
    v_cvt_pk_bf16_f32 v21, v74, v75
    v_cvt_pk_bf16_f32 v22, v76, v77
    v_cvt_pk_bf16_f32 v23, v78, v79
    s_add_u32 s43, s51, 32768
    s_cmp_lg_u32 s36, 0
    s_cbranch_scc1 L_ss_57
    buffer_store_dwordx4 v[16:19], v1, s[28:31], s43 offen offset:0 nt
    buffer_store_dwordx4 v[20:23], v1, s[28:31], s43 offen offset:1024 nt
L_se_58:
    v_mov_b32 v41, 0x3f803f80
    v_dot2_f32_bf16 v13, v16, v16, 0
    v_dot2_f32_bf16 v15, v20, v20, 0
    v_dot2_f32_bf16 v12, v41, v16, 0
    v_dot2_f32_bf16 v14, v41, v20, 0
    v_dot2_f32_bf16 v13, v17, v17, v13
    v_dot2_f32_bf16 v15, v21, v21, v15
    v_dot2_f32_bf16 v12, v41, v17, v12
    v_dot2_f32_bf16 v14, v41, v21, v14
    v_dot2_f32_bf16 v13, v18, v18, v13
    v_dot2_f32_bf16 v15, v22, v22, v15
    v_dot2_f32_bf16 v12, v41, v18, v12
    v_dot2_f32_bf16 v14, v41, v22, v14
    v_dot2_f32_bf16 v13, v19, v19, v13
    v_dot2_f32_bf16 v15, v23, v23, v15
    v_dot2_f32_bf16 v12, v41, v19, v12
    v_dot2_f32_bf16 v14, v41, v23, v14
    v_accvgpr_read_b32 v40, a228
    s_add_u32 s45, s58, 4096
    v_add_f32 v13, v13, v15
    v_add_f32 v12, v12, v14
    s_nop 1
    v_permlane16_swap_b32 v12, v13
    v_add_f32 v12, v12, v13
    v_mov_b32 v13, v12
    s_nop 1
    v_permlane32_swap_b32 v12, v13
    v_add_f32 v14, v12, v13
    s_add_u32 s93, s93, 1
    s_and_b32 s93, s93, 0xff
    v_and_b32 v14, 0xffffff00, v14
    v_or_b32 v14, s93, v14
    s_mov_b32 exec_hi, 0
    s_cmp_lg_u32 s36, 0
    s_cbranch_scc1 L_ss_59
    buffer_store_dword v14, v40, s[28:31], s45 offen
L_se_60:
    s_mov_b64 exec, -1
    v_accvgpr_read_b32 v15, a226
    v_mov_b32 v13, s35
    s_waitcnt vmcnt(1)
    s_mov_b64 exec, 1
    s_cmp_lg_u32 s36, 0
    s_cbranch_scc1 L_ss_61
    buffer_store_dword v13, v1, s[28:31], s56 offen offset:512
L_se_62:
    s_mov_b64 exec, -1
    buffer_load_dword v12, v15, s[28:31], s57 offen offset:512 sc1
    s_barrier
    v_add_u32 v10, 131072, v1
    ds_read_b128 v[32:35], v1 offset:0
    ds_read_b128 v[36:39], v1 offset:1024
    ds_read_b128 v[40:43], v1 offset:2048
    ds_read_b128 v[44:47], v1 offset:3072
    ds_read_b128 v[48:51], v1 offset:4096
    ds_read_b128 v[52:55], v1 offset:5120
L_poll_63:
    buffer_load_dword v14, v15, s[28:31], s57 offen offset:512 sc1
    s_waitcnt vmcnt(1)
    v_cmp_ne_u32 vcc, s35, v12
    s_cbranch_vccz L_pd_64
    buffer_load_dword v12, v15, s[28:31], s57 offen offset:512 sc1
    s_waitcnt vmcnt(1)
    v_cmp_ne_u32 vcc, s35, v14
    s_cbranch_vccz L_pd_64
    s_sub_u32 s38, s38, 1
    s_cbranch_scc0 L_poll_63
    s_mov_b32 s38, 0
L_pd_64:
    s_add_u32 s44, s48, 32768
    buffer_load_dwordx4 v[128:131], v1, s[28:31], s44 offen offset:0 sc1
    s_add_u32 s45, s49, 32768
    buffer_load_dwordx4 v[132:135], v1, s[28:31], s45 offen offset:0 sc1
    buffer_load_dwordx4 v[136:139], v1, s[28:31], s44 offen offset:1024 sc1
    buffer_load_dwordx4 v[140:143], v1, s[28:31], s45 offen offset:1024 sc1
    buffer_load_dwordx4 v[144:147], v1, s[28:31], s44 offen offset:2048 sc1
    buffer_load_dwordx4 v[148:151], v1, s[28:31], s45 offen offset:2048 sc1
    buffer_load_dwordx4 v[152:155], v1, s[28:31], s44 offen offset:3072 sc1
    buffer_load_dwordx4 v[156:159], v1, s[28:31], s45 offen offset:3072 sc1
    s_waitcnt lgkmcnt(4) vmcnt(7)
    v_mfma_f32_16x16x32_bf16 v[64:67], v[32:35], v[128:131], 0
    ds_read_b128 v[56:59], v1 offset:6144
    s_add_u32 s46, s59, 4096
    buffer_load_dwordx4 v[24:27], v1, s[28:31], s46 offen offset:0 sc1
    s_waitcnt vmcnt(7)
    v_mfma_f32_16x16x32_bf16 v[68:71], v[32:35], v[132:135], 0
    v_mfma_f32_16x16x32_bf16 v[72:75], v[36:39], v[128:131], 0
    ds_read_b128 v[60:63], v1 offset:7168
    v_mfma_f32_16x16x32_bf16 v[76:79], v[36:39], v[132:135], 0
    s_waitcnt lgkmcnt(4)
    v_mfma_f32_16x16x32_bf16 v[80:83], v[40:43], v[128:131], 0
    ds_read_b128 v[32:35], v1 offset:8192
    v_mfma_f32_16x16x32_bf16 v[84:87], v[40:43], v[132:135], 0
    buffer_load_dwordx4 v[28:31], v1, s[28:31], s46 offen offset:1024 sc1
    v_mfma_f32_16x16x32_bf16 v[88:91], v[44:47], v[128:131], 0
    ds_read_b128 v[36:39], v1 offset:9216
    v_mfma_f32_16x16x32_bf16 v[92:95], v[44:47], v[132:135], 0
    s_waitcnt lgkmcnt(4) vmcnt(6)
    v_mfma_f32_16x16x32_bf16 v[64:67], v[48:51], v[136:139], v[64:67]
    ds_read_b128 v[40:43], v1 offset:10240
    v_mfma_f32_16x16x32_bf16 v[68:71], v[48:51], v[140:143], v[68:71]
    s_add_u32 s44, s48, 36864
    buffer_load_dwordx4 v[160:163], v1, s[28:31], s44 offen offset:0 sc1
    v_mfma_f32_16x16x32_bf16 v[72:75], v[52:55], v[136:139], v[72:75]
    ds_read_b128 v[44:47], v1 offset:11264
    v_mfma_f32_16x16x32_bf16 v[76:79], v[52:55], v[140:143], v[76:79]
    s_waitcnt lgkmcnt(4)
    v_mfma_f32_16x16x32_bf16 v[80:83], v[56:59], v[136:139], v[80:83]
    ds_read_b128 v[48:51], v1 offset:12288
    v_mfma_f32_16x16x32_bf16 v[84:87], v[56:59], v[140:143], v[84:87]
    s_add_u32 s45, s49, 36864
    buffer_load_dwordx4 v[164:167], v1, s[28:31], s45 offen offset:0 sc1
    v_mfma_f32_16x16x32_bf16 v[88:91], v[60:63], v[136:139], v[88:91]
    ds_read_b128 v[52:55], v1 offset:13312
    v_mfma_f32_16x16x32_bf16 v[92:95], v[60:63], v[140:143], v[92:95]
    s_waitcnt lgkmcnt(4) vmcnt(6)
    v_mfma_f32_16x16x32_bf16 v[64:67], v[32:35], v[144:147], v[64:67]
    ds_read_b128 v[56:59], v1 offset:14336
    v_mfma_f32_16x16x32_bf16 v[68:71], v[32:35], v[148:151], v[68:71]
    buffer_load_dwordx4 v[168:171], v1, s[28:31], s44 offen offset:1024 sc1
    v_mfma_f32_16x16x32_bf16 v[72:75], v[36:39], v[144:147], v[72:75]
    ds_read_b128 v[60:63], v1 offset:15360
    v_mfma_f32_16x16x32_bf16 v[76:79], v[36:39], v[148:151], v[76:79]
    s_waitcnt lgkmcnt(4)
    v_mfma_f32_16x16x32_bf16 v[80:83], v[40:43], v[144:147], v[80:83]
    ds_read_b128 v[32:35], v1 offset:16384
    v_mfma_f32_16x16x32_bf16 v[84:87], v[40:43], v[148:151], v[84:87]
    buffer_load_dwordx4 v[172:175], v1, s[28:31], s45 offen offset:1024 sc1
    v_mfma_f32_16x16x32_bf16 v[88:91], v[44:47], v[144:147], v[88:91]
    ds_read_b128 v[36:39], v1 offset:17408
    v_mfma_f32_16x16x32_bf16 v[92:95], v[44:47], v[148:151], v[92:95]
    s_waitcnt lgkmcnt(4) vmcnt(6)
    v_mfma_f32_16x16x32_bf16 v[64:67], v[48:51], v[152:155], v[64:67]
    ds_read_b128 v[40:43], v1 offset:18432
    buffer_load_dwordx4 v[176:179], v1, s[28:31], s44 offen offset:2048 sc1
    v_mfma_f32_16x16x32_bf16 v[68:71], v[48:51], v[156:159], v[68:71]
    buffer_load_dwordx4 v[180:183], v1, s[28:31], s45 offen offset:2048 sc1
    v_mfma_f32_16x16x32_bf16 v[72:75], v[52:55], v[152:155], v[72:75]
    ds_read_b128 v[44:47], v1 offset:19456
    v_mfma_f32_16x16x32_bf16 v[76:79], v[52:55], v[156:159], v[76:79]
    s_waitcnt lgkmcnt(4)
    v_mfma_f32_16x16x32_bf16 v[80:83], v[56:59], v[152:155], v[80:83]
    ds_read_b128 v[48:51], v1 offset:20480
    v_mfma_f32_16x16x32_bf16 v[84:87], v[56:59], v[156:159], v[84:87]
    buffer_load_dwordx4 v[184:187], v1, s[28:31], s44 offen offset:3072 sc1
    v_mfma_f32_16x16x32_bf16 v[88:91], v[60:63], v[152:155], v[88:91]
    ds_read_b128 v[52:55], v1 offset:21504
    v_mfma_f32_16x16x32_bf16 v[92:95], v[60:63], v[156:159], v[92:95]
    s_waitcnt lgkmcnt(4) vmcnt(5)
    v_mfma_f32_16x16x32_bf16 v[64:67], v[32:35], v[160:163], v[64:67]
    ds_read_b128 v[56:59], v1 offset:22528
    v_mfma_f32_16x16x32_bf16 v[68:71], v[32:35], v[164:167], v[68:71]
    buffer_load_dwordx4 v[188:191], v1, s[28:31], s45 offen offset:3072 sc1
    v_mfma_f32_16x16x32_bf16 v[72:75], v[36:39], v[160:163], v[72:75]
    ds_read_b128 v[60:63], v1 offset:23552
    v_mfma_f32_16x16x32_bf16 v[76:79], v[36:39], v[164:167], v[76:79]
    s_waitcnt lgkmcnt(4)
    v_mfma_f32_16x16x32_bf16 v[80:83], v[40:43], v[160:163], v[80:83]
    ds_read_b128 v[32:35], v1 offset:24576
    v_mfma_f32_16x16x32_bf16 v[84:87], v[40:43], v[164:167], v[84:87]
    s_add_u32 s44, s48, 40960
    buffer_load_dwordx4 v[192:195], v1, s[28:31], s44 offen offset:0 sc1
    v_mfma_f32_16x16x32_bf16 v[88:91], v[44:47], v[160:163], v[88:91]
    ds_read_b128 v[36:39], v1 offset:25600
    v_mfma_f32_16x16x32_bf16 v[92:95], v[44:47], v[164:167], v[92:95]
L_pad14:
    s_cbranch_execz L_padret0
    s_waitcnt lgkmcnt(4) vmcnt(5)
    v_mfma_f32_16x16x32_bf16 v[64:67], v[48:51], v[168:171], v[64:67]
    ds_read_b128 v[40:43], v1 offset:26624
    v_mfma_f32_16x16x32_bf16 v[68:71], v[48:51], v[172:175], v[68:71]
    s_add_u32 s45, s49, 40960
    buffer_load_dwordx4 v[196:199], v1, s[28:31], s45 offen offset:0 sc1
    v_mfma_f32_16x16x32_bf16 v[72:75], v[52:55], v[168:171], v[72:75]
    ds_read_b128 v[44:47], v1 offset:27648
    v_mfma_f32_16x16x32_bf16 v[76:79], v[52:55], v[172:175], v[76:79]
    s_waitcnt lgkmcnt(4)
    v_mfma_f32_16x16x32_bf16 v[80:83], v[56:59], v[168:171], v[80:83]
    ds_read_b128 v[48:51], v1 offset:28672
    v_mfma_f32_16x16x32_bf16 v[84:87], v[56:59], v[172:175], v[84:87]
    buffer_load_dwordx4 v[200:203], v1, s[28:31], s44 offen offset:1024 sc1
    v_mfma_f32_16x16x32_bf16 v[88:91], v[60:63], v[168:171], v[88:91]
    ds_read_b128 v[52:55], v1 offset:29696
    v_mfma_f32_16x16x32_bf16 v[92:95], v[60:63], v[172:175], v[92:95]
    v_xor_b32 v24, s93, v24
    s_waitcnt lgkmcnt(4) vmcnt(5)
    v_mfma_f32_16x16x32_bf16 v[64:67], v[32:35], v[176:179], v[64:67]
    ds_read_b128 v[56:59], v1 offset:30720
    v_xor_b32 v25, s93, v25
    v_mfma_f32_16x16x32_bf16 v[68:71], v[32:35], v[180:183], v[68:71]
    buffer_load_dwordx4 v[204:207], v1, s[28:31], s45 offen offset:1024 sc1
    v_xor_b32 v26, s93, v26
    v_mfma_f32_16x16x32_bf16 v[72:75], v[36:39], v[176:179], v[72:75]
    ds_read_b128 v[60:63], v1 offset:31744
    v_xor_b32 v27, s93, v27
    v_mfma_f32_16x16x32_bf16 v[76:79], v[36:39], v[180:183], v[76:79]
    v_xor_b32 v28, s93, v28
    s_waitcnt lgkmcnt(4)
    v_mfma_f32_16x16x32_bf16 v[80:83], v[40:43], v[176:179], v[80:83]
    ds_read_b128 v[32:35], v1 offset:32768
    v_xor_b32 v29, s93, v29
    v_mfma_f32_16x16x32_bf16 v[84:87], v[40:43], v[180:183], v[84:87]
    buffer_load_dwordx4 v[208:211], v1, s[28:31], s44 offen offset:2048 sc1
    v_xor_b32 v30, s93, v30
    v_mfma_f32_16x16x32_bf16 v[88:91], v[44:47], v[176:179], v[88:91]
    ds_read_b128 v[36:39], v1 offset:33792
    v_xor_b32 v31, s93, v31
    v_mfma_f32_16x16x32_bf16 v[92:95], v[44:47], v[180:183], v[92:95]
    v_or3_b32 v120, v24, v25, v26
    v_or3_b32 v121, v27, v28, v29
    s_waitcnt lgkmcnt(4) vmcnt(5)
    v_mfma_f32_16x16x32_bf16 v[64:67], v[48:51], v[184:187], v[64:67]
    ds_read_b128 v[40:43], v1 offset:34816
    v_or3_b32 v120, v120, v30, v31
    v_mfma_f32_16x16x32_bf16 v[68:71], v[48:51], v[188:191], v[68:71]
    buffer_load_dwordx4 v[212:215], v1, s[28:31], s45 offen offset:2048 sc1
    v_or_b32 v120, v120, v121
    v_mfma_f32_16x16x32_bf16 v[72:75], v[52:55], v[184:187], v[72:75]
    ds_read_b128 v[44:47], v1 offset:35840
    v_and_b32 v120, 0xff, v120
    v_mfma_f32_16x16x32_bf16 v[76:79], v[52:55], v[188:191], v[76:79]
    v_cmp_ne_u32 vcc, 0, v120
    s_cbranch_vccnz L_sg_65
L_sgok_66:
    s_waitcnt lgkmcnt(4)
    v_mfma_f32_16x16x32_bf16 v[80:83], v[56:59], v[184:187], v[80:83]
    ds_read_b128 v[48:51], v1 offset:36864
    buffer_load_dwordx4 v[216:219], v1, s[28:31], s44 offen offset:3072 sc1
    v_add_f32 v120, v24, v28
    v_mfma_f32_16x16x32_bf16 v[84:87], v[56:59], v[188:191], v[84:87]
    v_add_f32 v121, v25, v29
    v_add_f32 v122, v26, v30
    v_mfma_f32_16x16x32_bf16 v[88:91], v[60:63], v[184:187], v[88:91]
    ds_read_b128 v[52:55], v1 offset:37888
    v_add_f32 v123, v27, v31
    v_mfma_f32_16x16x32_bf16 v[92:95], v[60:63], v[188:191], v[92:95]
    s_waitcnt lgkmcnt(4) vmcnt(5)
    v_mfma_f32_16x16x32_bf16 v[64:67], v[32:35], v[192:195], v[64:67]
    ds_read_b128 v[56:59], v1 offset:38912
    buffer_load_dwordx4 v[220:223], v1, s[28:31], s45 offen offset:3072 sc1
    v_accvgpr_read_b32 v13, a229
    v_accvgpr_read_b32 v12, a230
    v_mfma_f32_16x16x32_bf16 v[68:71], v[32:35], v[196:199], v[68:71]
    v_permlane32_swap_b32 v120, v122
    v_permlane32_swap_b32 v121, v123
    v_mfma_f32_16x16x32_bf16 v[72:75], v[36:39], v[192:195], v[72:75]
    ds_read_b128 v[60:63], v1 offset:39936
    v_mfma_f32_16x16x32_bf16 v[76:79], v[36:39], v[196:199], v[76:79]
    s_add_u32 s44, s48, 45056
    buffer_load_dwordx4 v[224:227], v1, s[28:31], s44 offen offset:0 sc1
    v_add_f32 v120, v120, v122
    s_waitcnt lgkmcnt(4)
    v_mfma_f32_16x16x32_bf16 v[80:83], v[40:43], v[192:195], v[80:83]
    ds_read_b128 v[32:35], v1 offset:40960
    v_add_f32 v121, v121, v123
    v_mfma_f32_16x16x32_bf16 v[84:87], v[40:43], v[196:199], v[84:87]
    v_mov_b32 v122, v120
    v_mov_b32 v123, v121
    v_mfma_f32_16x16x32_bf16 v[88:91], v[44:47], v[192:195], v[88:91]
    ds_read_b128 v[36:39], v1 offset:41984
    v_mfma_f32_16x16x32_bf16 v[92:95], v[44:47], v[196:199], v[92:95]
    s_add_u32 s45, s49, 45056
    buffer_load_dwordx4 v[228:231], v1, s[28:31], s45 offen offset:0 sc1
    s_nop 0
    s_waitcnt lgkmcnt(4) vmcnt(6)
    v_mfma_f32_16x16x32_bf16 v[64:67], v[48:51], v[200:203], v[64:67]
    ds_read_b128 v[40:43], v1 offset:43008
    v_permlane16_swap_b32 v120, v122
    v_mfma_f32_16x16x32_bf16 v[68:71], v[48:51], v[204:207], v[68:71]
    v_permlane16_swap_b32 v121, v123
    v_add_f32 v120, v120, v122
    v_mfma_f32_16x16x32_bf16 v[72:75], v[52:55], v[200:203], v[72:75]
    ds_read_b128 v[44:47], v1 offset:44032
    v_add_f32 v121, v121, v123
    v_mfma_f32_16x16x32_bf16 v[76:79], v[52:55], v[204:207], v[76:79]
    buffer_load_dwordx4 v[232:235], v1, s[28:31], s44 offen offset:1024 sc1
    v_mul_f32 v120, 0xbb000000, v120
    s_waitcnt lgkmcnt(4)
    v_mfma_f32_16x16x32_bf16 v[80:83], v[56:59], v[200:203], v[80:83]
    ds_read_b128 v[48:51], v1 offset:45056
    v_mul_f32 v121, 0x3b000000, v121
    v_mfma_f32_16x16x32_bf16 v[84:87], v[56:59], v[204:207], v[84:87]
    v_fma_f32 v121, -v120, v120, v121
    v_mfma_f32_16x16x32_bf16 v[88:91], v[60:63], v[200:203], v[88:91]
    ds_read_b128 v[52:55], v1 offset:46080
    buffer_load_dwordx4 v[236:239], v1, s[28:31], s45 offen offset:1024 sc1
    v_max_f32 v121, 0, v121
    v_mfma_f32_16x16x32_bf16 v[92:95], v[60:63], v[204:207], v[92:95]
    v_add_f32 v121, 0x3727c5ac, v121
    s_waitcnt lgkmcnt(4) vmcnt(6)
    v_mfma_f32_16x16x32_bf16 v[64:67], v[32:35], v[208:211], v[64:67]
    ds_read_b128 v[56:59], v1 offset:47104
    v_rsq_f32 v121, v121
    v_mfma_f32_16x16x32_bf16 v[68:71], v[32:35], v[212:215], v[68:71]
    s_nop 0
    v_mfma_f32_16x16x32_bf16 v[72:75], v[36:39], v[208:211], v[72:75]
    ds_read_b128 v[60:63], v1 offset:48128
    buffer_load_dwordx4 v[240:243], v1, s[28:31], s44 offen offset:2048 sc1
    ds_write2_b32 v13, v120, v121 offset0:0 offset1:32
    v_mfma_f32_16x16x32_bf16 v[76:79], v[36:39], v[212:215], v[76:79]
    ds_read2_b32 v[124:125], v12 offset0:0 offset1:16
    s_waitcnt lgkmcnt(6)
    v_mfma_f32_16x16x32_bf16 v[80:83], v[40:43], v[208:211], v[80:83]
    ds_read_b128 v[32:35], v1 offset:49152
    v_accvgpr_read_b32 v12, a225
    v_mfma_f32_16x16x32_bf16 v[84:87], v[40:43], v[212:215], v[84:87]
    buffer_load_dwordx4 v[244:247], v1, s[28:31], s45 offen offset:2048 sc1
    ds_read_b128 v[100:103], v12 offset:640
    v_mfma_f32_16x16x32_bf16 v[88:91], v[44:47], v[208:211], v[88:91]
    ds_read_b128 v[36:39], v1 offset:50176
    ds_read_b128 v[108:111], v12 offset:704
    v_mfma_f32_16x16x32_bf16 v[92:95], v[44:47], v[212:215], v[92:95]
    ds_read_b128 v[116:119], v12 offset:768
    s_waitcnt lgkmcnt(9) vmcnt(6)
    v_mfma_f32_16x16x32_bf16 v[64:67], v[48:51], v[216:219], v[64:67]
    ds_read_b128 v[40:43], v1 offset:51200
    v_mfma_f32_16x16x32_bf16 v[68:71], v[48:51], v[220:223], v[68:71]
    buffer_load_dwordx4 v[248:251], v1, s[28:31], s44 offen offset:3072 sc1
    v_mfma_f32_16x16x32_bf16 v[72:75], v[52:55], v[216:219], v[72:75]
    ds_read_b128 v[44:47], v1 offset:52224
    v_mfma_f32_16x16x32_bf16 v[76:79], v[52:55], v[220:223], v[76:79]
    s_waitcnt lgkmcnt(9)
    v_mfma_f32_16x16x32_bf16 v[80:83], v[56:59], v[216:219], v[80:83]
    ds_read_b128 v[48:51], v1 offset:53248
    buffer_load_dwordx4 v[252:255], v1, s[28:31], s45 offen offset:3072 sc1
    s_waitcnt lgkmcnt(3)
    v_mfma_f32_16x16x32_bf16 v[84:87], v[56:59], v[220:223], v[84:87]
    v_mul_f32 v96, v100, v124
    v_mul_f32 v97, v101, v124
    v_mfma_f32_16x16x32_bf16 v[88:91], v[60:63], v[216:219], v[88:91]
    ds_read_b128 v[52:55], v1 offset:54272
    v_mul_f32 v98, v102, v124
    v_mfma_f32_16x16x32_bf16 v[92:95], v[60:63], v[220:223], v[92:95]
    v_mul_f32 v99, v103, v124
    s_waitcnt vmcnt(6)
    v_mfma_f32_16x16x32_bf16 v[64:67], v[32:35], v[224:227], v[64:67]
    ds_read_b128 v[56:59], v1 offset:55296
    s_mul_i32 s82, s32, 6144
    s_add_u32 s78, s82, s84
    s_add_u32 m0, s82, 65536
    s_add_u32 s79, s78, 188416
    buffer_load_dwordx4 v1, s[28:31], s79 offen offset:0 sc1 lds
    v_mfma_f32_16x16x32_bf16 v[68:71], v[32:35], v[228:231], v[68:71]
    v_mul_f32 v100, v100, v125
    v_mul_f32 v101, v101, v125
    v_mfma_f32_16x16x32_bf16 v[72:75], v[36:39], v[224:227], v[72:75]
    ds_read_b128 v[60:63], v1 offset:56320
    v_mul_f32 v102, v102, v125
    v_mfma_f32_16x16x32_bf16 v[76:79], v[36:39], v[228:231], v[76:79]
    buffer_load_dwordx4 v1, s[28:31], s79 offen offset:1024 sc1 lds
    s_waitcnt lgkmcnt(4)
    v_mfma_f32_16x16x32_bf16 v[80:83], v[40:43], v[224:227], v[80:83]
    ds_read_b128 v[32:35], v1 offset:57344
    v_mul_f32 v103, v103, v125
    v_mfma_f32_16x16x32_bf16 v[84:87], v[40:43], v[228:231], v[84:87]
    v_mul_f32 v104, v108, v124
    v_mul_f32 v105, v109, v124
    v_mfma_f32_16x16x32_bf16 v[88:91], v[44:47], v[224:227], v[88:91]
    ds_read_b128 v[36:39], v1 offset:58368
    v_mul_f32 v106, v110, v124
    buffer_load_dwordx4 v1, s[28:31], s79 offen offset:2048 sc1 lds
    v_mfma_f32_16x16x32_bf16 v[92:95], v[44:47], v[228:231], v[92:95]
    v_mul_f32 v107, v111, v124
    s_waitcnt lgkmcnt(4) vmcnt(7)
    v_mfma_f32_16x16x32_bf16 v[64:67], v[48:51], v[232:235], v[64:67]
    ds_read_b128 v[40:43], v1 offset:59392
    v_mul_f32 v108, v108, v125
    v_mfma_f32_16x16x32_bf16 v[68:71], v[48:51], v[236:239], v[68:71]
    v_mul_f32 v109, v109, v125
    buffer_load_dwordx4 v1, s[28:31], s79 offen offset:3072 sc1 lds
    v_mfma_f32_16x16x32_bf16 v[72:75], v[52:55], v[232:235], v[72:75]
    ds_read_b128 v[44:47], v1 offset:60416
    v_mul_f32 v110, v110, v125
    v_mfma_f32_16x16x32_bf16 v[76:79], v[52:55], v[236:239], v[76:79]
    v_mul_f32 v111, v111, v125
    s_waitcnt lgkmcnt(4)
    v_mfma_f32_16x16x32_bf16 v[80:83], v[56:59], v[232:235], v[80:83]
    ds_read_b128 v[48:51], v1 offset:61440
    v_mul_f32 v112, v116, v124
    s_add_u32 m0, s82, 69632
    s_add_u32 s79, s78, 192512
    buffer_load_dwordx4 v1, s[28:31], s79 offen offset:0 sc1 lds
    v_mfma_f32_16x16x32_bf16 v[84:87], v[56:59], v[236:239], v[84:87]
    v_mul_f32 v113, v117, v124
    v_mul_f32 v114, v118, v124
    v_mfma_f32_16x16x32_bf16 v[88:91], v[60:63], v[232:235], v[88:91]
    ds_read_b128 v[52:55], v1 offset:62464
    v_mul_f32 v115, v119, v124
    v_mfma_f32_16x16x32_bf16 v[92:95], v[60:63], v[236:239], v[92:95]
    buffer_load_dwordx4 v1, s[28:31], s79 offen offset:1024 sc1 lds
    s_waitcnt lgkmcnt(4) vmcnt(8)
    v_mfma_f32_16x16x32_bf16 v[64:67], v[32:35], v[240:243], v[64:67]
    ds_read_b128 v[56:59], v1 offset:63488
    v_mul_f32 v116, v116, v125
    v_mfma_f32_16x16x32_bf16 v[68:71], v[32:35], v[244:247], v[68:71]
    v_mul_f32 v117, v117, v125
    v_mul_f32 v118, v118, v125
    v_mfma_f32_16x16x32_bf16 v[72:75], v[36:39], v[240:243], v[72:75]
    ds_read_b128 v[60:63], v1 offset:64512
    v_mul_f32 v119, v119, v125
    v_mfma_f32_16x16x32_bf16 v[76:79], v[36:39], v[244:247], v[76:79]
    s_waitcnt lgkmcnt(4)
    v_mfma_f32_16x16x32_bf16 v[80:83], v[40:43], v[240:243], v[80:83]
    ds_read_b128 v[32:35], v10 offset:0
    v_mfma_f32_16x16x32_bf16 v[84:87], v[40:43], v[244:247], v[84:87]
    v_mfma_f32_16x16x32_bf16 v[88:91], v[44:47], v[240:243], v[88:91]
    ds_read_b128 v[36:39], v10 offset:1024
    v_mfma_f32_16x16x32_bf16 v[92:95], v[44:47], v[244:247], v[92:95]
    v_accvgpr_read_b32 v14, a225
    s_waitcnt lgkmcnt(4) vmcnt(6)
    v_mfma_f32_16x16x32_bf16 v[64:67], v[48:51], v[248:251], v[64:67]
    ds_read_b128 v[40:43], v10 offset:2048
    ds_read_b128 v[24:27], v14 offset:384
    v_mfma_f32_16x16x32_bf16 v[68:71], v[48:51], v[252:255], v[68:71]
    ds_read_b128 v[28:31], v14 offset:448
    v_mfma_f32_16x16x32_bf16 v[72:75], v[52:55], v[248:251], v[72:75]
    ds_read_b128 v[44:47], v10 offset:3072
    ds_read_b128 v[120:123], v14 offset:512
    v_mfma_f32_16x16x32_bf16 v[76:79], v[52:55], v[252:255], v[76:79]
    ds_read_b128 v[4:7], v14 offset:576
    s_waitcnt lgkmcnt(8)
    v_mfma_f32_16x16x32_bf16 v[80:83], v[56:59], v[248:251], v[80:83]
    ds_read_b128 v[48:51], v10 offset:4096
    v_mfma_f32_16x16x32_bf16 v[84:87], v[56:59], v[252:255], v[84:87]
    v_mfma_f32_16x16x32_bf16 v[88:91], v[60:63], v[248:251], v[88:91]
    ds_read_b128 v[52:55], v10 offset:5120
    v_mfma_f32_16x16x32_bf16 v[92:95], v[60:63], v[252:255], v[92:95]
    s_waitcnt lgkmcnt(8)
    v_mfma_f32_16x16x32_bf16 v[96:99], v[32:35], v[128:131], v[96:99]
    ds_read_b128 v[56:59], v10 offset:6144
    v_mfma_f32_16x16x32_bf16 v[100:103], v[32:35], v[132:135], v[100:103]
    s_waitcnt lgkmcnt(3)
    v_fmac_f32 v64, v24, v124
    v_mfma_f32_16x16x32_bf16 v[104:107], v[36:39], v[128:131], v[104:107]
    ds_read_b128 v[60:63], v10 offset:7168
    v_fmac_f32 v65, v25, v124
    v_mfma_f32_16x16x32_bf16 v[108:111], v[36:39], v[132:135], v[108:111]
    v_fmac_f32 v66, v26, v124
    v_mfma_f32_16x16x32_bf16 v[112:115], v[40:43], v[128:131], v[112:115]
    ds_read_b128 v[32:35], v10 offset:8192
    v_fmac_f32 v67, v27, v124
    v_mfma_f32_16x16x32_bf16 v[116:119], v[40:43], v[132:135], v[116:119]
    v_cvt_pk_bf16_f32 v64, v64, v65
    v_cvt_pk_bf16_f32 v65, v66, v67
    v_pk_max_i16 v64, v64, 0
    v_mfma_f32_16x16x32_bf16 v[96:99], v[44:47], v[136:139], v[96:99]
    ds_read_b128 v[36:39], v10 offset:9216
    v_pk_max_i16 v65, v65, 0
    v_fmac_f32 v72, v28, v124
    v_fmac_f32 v73, v29, v124
    v_fmac_f32 v74, v30, v124
    v_mfma_f32_16x16x32_bf16 v[100:103], v[44:47], v[140:143], v[100:103]
    v_fmac_f32 v75, v31, v124
    v_cvt_pk_bf16_f32 v66, v72, v73
    v_cvt_pk_bf16_f32 v67, v74, v75
    v_pk_max_i16 v66, v66, 0
    s_waitcnt lgkmcnt(4)
    v_mfma_f32_16x16x32_bf16 v[104:107], v[48:51], v[136:139], v[104:107]
    ds_read_b128 v[40:43], v10 offset:10240
    v_pk_max_i16 v67, v67, 0
    v_fmac_f32 v68, v24, v125
    v_fmac_f32 v69, v25, v125
    v_fmac_f32 v70, v26, v125
    v_mfma_f32_16x16x32_bf16 v[108:111], v[48:51], v[140:143], v[108:111]
    v_fmac_f32 v71, v27, v125
    v_cvt_pk_bf16_f32 v68, v68, v69
    v_cvt_pk_bf16_f32 v69, v70, v71
    v_pk_max_i16 v68, v68, 0
    v_mfma_f32_16x16x32_bf16 v[112:115], v[52:55], v[136:139], v[112:115]
L_pad15:
    s_cbranch_execz L_padret0
    ds_read_b128 v[44:47], v10 offset:11264
    v_pk_max_i16 v69, v69, 0
    v_fmac_f32 v76, v28, v125
    v_fmac_f32 v77, v29, v125
    v_fmac_f32 v78, v30, v125
    v_mfma_f32_16x16x32_bf16 v[116:119], v[52:55], v[140:143], v[116:119]
    v_fmac_f32 v79, v31, v125
    v_cvt_pk_bf16_f32 v70, v76, v77
    v_cvt_pk_bf16_f32 v71, v78, v79
    v_pk_max_i16 v70, v70, 0
    s_waitcnt lgkmcnt(4)
    v_mfma_f32_16x16x32_bf16 v[96:99], v[56:59], v[144:147], v[96:99]
    ds_read_b128 v[48:51], v10 offset:12288
    v_pk_max_i16 v71, v71, 0
    s_sub_u32 s44, s60, 1024
    s_sub_u32 s45, s61, 1024
    s_cmp_lg_u32 s36, 0
    s_cbranch_scc1 L_ss_67
    buffer_store_dwordx4 v[64:67], v1, s[28:31], s44 offen nt
    buffer_store_dwordx4 v[68:71], v1, s[28:31], s45 offen nt
L_se_68:
    v_fmac_f32 v80, v120, v124
    v_mfma_f32_16x16x32_bf16 v[100:103], v[56:59], v[148:151], v[100:103]
    v_fmac_f32 v81, v121, v124
    v_fmac_f32 v82, v122, v124
    v_mfma_f32_16x16x32_bf16 v[104:107], v[60:63], v[144:147], v[104:107]
    ds_read_b128 v[52:55], v10 offset:13312
    v_fmac_f32 v83, v123, v124
    v_cvt_pk_bf16_f32 v80, v80, v81
    v_mfma_f32_16x16x32_bf16 v[108:111], v[60:63], v[148:151], v[108:111]
    v_cvt_pk_bf16_f32 v81, v82, v83
    v_pk_max_i16 v80, v80, 0
    s_waitcnt lgkmcnt(4)
    v_mfma_f32_16x16x32_bf16 v[112:115], v[32:35], v[144:147], v[112:115]
    ds_read_b128 v[56:59], v10 offset:14336
    v_pk_max_i16 v81, v81, 0
    v_fmac_f32 v88, v4, v124
    v_mfma_f32_16x16x32_bf16 v[116:119], v[32:35], v[148:151], v[116:119]
    v_fmac_f32 v89, v5, v124
    v_fmac_f32 v90, v6, v124
    v_mfma_f32_16x16x32_bf16 v[96:99], v[36:39], v[152:155], v[96:99]
    ds_read_b128 v[60:63], v10 offset:15360
    v_fmac_f32 v91, v7, v124
    v_cvt_pk_bf16_f32 v82, v88, v89
    v_mfma_f32_16x16x32_bf16 v[100:103], v[36:39], v[156:159], v[100:103]
    v_cvt_pk_bf16_f32 v83, v90, v91
    v_pk_max_i16 v82, v82, 0
    s_waitcnt lgkmcnt(4)
    v_mfma_f32_16x16x32_bf16 v[104:107], v[40:43], v[152:155], v[104:107]
    ds_read_b128 v[32:35], v10 offset:16384
    v_pk_max_i16 v83, v83, 0
    v_fmac_f32 v84, v120, v125
    v_mfma_f32_16x16x32_bf16 v[108:111], v[40:43], v[156:159], v[108:111]
    v_fmac_f32 v85, v121, v125
    v_fmac_f32 v86, v122, v125
    v_mfma_f32_16x16x32_bf16 v[112:115], v[44:47], v[152:155], v[112:115]
    ds_read_b128 v[36:39], v10 offset:17408
    v_fmac_f32 v87, v123, v125
    v_cvt_pk_bf16_f32 v84, v84, v85
    v_mfma_f32_16x16x32_bf16 v[116:119], v[44:47], v[156:159], v[116:119]
    v_cvt_pk_bf16_f32 v85, v86, v87
    v_pk_max_i16 v84, v84, 0
    s_waitcnt lgkmcnt(4)
    v_mfma_f32_16x16x32_bf16 v[96:99], v[48:51], v[160:163], v[96:99]
    ds_read_b128 v[40:43], v10 offset:18432
    v_pk_max_i16 v85, v85, 0
    v_fmac_f32 v92, v4, v125
    v_mfma_f32_16x16x32_bf16 v[100:103], v[48:51], v[164:167], v[100:103]
    v_fmac_f32 v93, v5, v125
    v_fmac_f32 v94, v6, v125
    v_mfma_f32_16x16x32_bf16 v[104:107], v[52:55], v[160:163], v[104:107]
    ds_read_b128 v[44:47], v10 offset:19456
    v_fmac_f32 v95, v7, v125
    v_cvt_pk_bf16_f32 v86, v92, v93
    v_mfma_f32_16x16x32_bf16 v[108:111], v[52:55], v[164:167], v[108:111]
    v_cvt_pk_bf16_f32 v87, v94, v95
    v_pk_max_i16 v86, v86, 0
    s_waitcnt lgkmcnt(4)
    v_mfma_f32_16x16x32_bf16 v[112:115], v[56:59], v[160:163], v[112:115]
    ds_read_b128 v[48:51], v10 offset:20480
    v_pk_max_i16 v87, v87, 0
    s_cmp_lg_u32 s36, 0
    s_cbranch_scc1 L_ss_69
    buffer_store_dwordx4 v[80:83], v1, s[28:31], s60 offen offset:3072 nt
    buffer_store_dwordx4 v[84:87], v1, s[28:31], s61 offen offset:3072 nt
L_se_70:
    v_mov_b32 v13, s35
    s_waitcnt vmcnt(2)
    s_mov_b64 exec, 1
    s_cmp_lg_u32 s36, 0
    s_cbranch_scc1 L_ss_73
    buffer_store_dword v13, v1, s[28:31], s66 offen offset:1600
L_se_74:
    s_mov_b64 exec, -1
    v_mfma_f32_16x16x32_bf16 v[116:119], v[56:59], v[164:167], v[116:119]
    v_accvgpr_read_b32 v15, a226
    v_and_b32 v15, 28, v15
    v_mfma_f32_16x16x32_bf16 v[96:99], v[60:63], v[168:171], v[96:99]
    ds_read_b128 v[52:55], v10 offset:21504
    v_mfma_f32_16x16x32_bf16 v[100:103], v[60:63], v[172:175], v[100:103]
    s_waitcnt lgkmcnt(4)
    v_mfma_f32_16x16x32_bf16 v[104:107], v[32:35], v[168:171], v[104:107]
    ds_read_b128 v[56:59], v10 offset:22528
    v_mfma_f32_16x16x32_bf16 v[108:111], v[32:35], v[172:175], v[108:111]
    s_barrier
    v_mfma_f32_16x16x32_bf16 v[112:115], v[36:39], v[168:171], v[112:115]
    ds_read_b128 v[60:63], v10 offset:23552
    v_mfma_f32_16x16x32_bf16 v[116:119], v[36:39], v[172:175], v[116:119]
    s_waitcnt lgkmcnt(4)
    v_mfma_f32_16x16x32_bf16 v[96:99], v[40:43], v[176:179], v[96:99]
    ds_read_b128 v[32:35], v3 offset:0
    v_mfma_f32_16x16x32_bf16 v[100:103], v[40:43], v[180:183], v[100:103]
    v_mfma_f32_16x16x32_bf16 v[104:107], v[44:47], v[176:179], v[104:107]
    ds_read_b128 v[36:39], v3 offset:1024
    v_mfma_f32_16x16x32_bf16 v[108:111], v[44:47], v[180:183], v[108:111]
    s_waitcnt lgkmcnt(4)
    v_mfma_f32_16x16x32_bf16 v[112:115], v[48:51], v[176:179], v[112:115]
    ds_read_b128 v[40:43], v3 offset:2048
    v_mfma_f32_16x16x32_bf16 v[116:119], v[48:51], v[180:183], v[116:119]
    v_mfma_f32_16x16x32_bf16 v[96:99], v[52:55], v[184:187], v[96:99]
    ds_read_b128 v[44:47], v3 offset:3072
    v_mfma_f32_16x16x32_bf16 v[100:103], v[52:55], v[188:191], v[100:103]
    s_waitcnt lgkmcnt(4)
    v_mfma_f32_16x16x32_bf16 v[104:107], v[56:59], v[184:187], v[104:107]
    ds_read_b128 v[48:51], v3 offset:4096
    v_mfma_f32_16x16x32_bf16 v[108:111], v[56:59], v[188:191], v[108:111]
    buffer_load_dword v12, v15, s[28:31], s67 offen offset:1600 sc1
    v_mfma_f32_16x16x32_bf16 v[112:115], v[60:63], v[184:187], v[112:115]
    ds_read_b128 v[52:55], v3 offset:5120
    v_mfma_f32_16x16x32_bf16 v[116:119], v[60:63], v[188:191], v[116:119]
    s_waitcnt lgkmcnt(4)
    v_mfma_f32_16x16x32_bf16 v[96:99], v[32:35], v[192:195], v[96:99]
    ds_read_b128 v[56:59], v3 offset:6144
    v_mfma_f32_16x16x32_bf16 v[100:103], v[32:35], v[196:199], v[100:103]
    v_mfma_f32_16x16x32_bf16 v[104:107], v[36:39], v[192:195], v[104:107]
    ds_read_b128 v[60:63], v3 offset:7168
    v_mfma_f32_16x16x32_bf16 v[108:111], v[36:39], v[196:199], v[108:111]
    s_waitcnt lgkmcnt(4)
    v_mfma_f32_16x16x32_bf16 v[112:115], v[40:43], v[192:195], v[112:115]
    ds_read_b128 v[32:35], v3 offset:8192
    v_mfma_f32_16x16x32_bf16 v[116:119], v[40:43], v[196:199], v[116:119]
    v_mov_b32 v13, s35
    s_waitcnt vmcnt(2)
    s_mov_b64 exec, 1
    s_cmp_lg_u32 s36, 0
    s_cbranch_scc1 L_ss_71
    buffer_store_dword v13, v1, s[28:31], s66 offen offset:1536
L_se_72:
    s_mov_b64 exec, -1
    v_mfma_f32_16x16x32_bf16 v[96:99], v[44:47], v[200:203], v[96:99]
    ds_read_b128 v[36:39], v3 offset:9216
    v_mfma_f32_16x16x32_bf16 v[100:103], v[44:47], v[204:207], v[100:103]
    s_waitcnt lgkmcnt(4)
    v_mfma_f32_16x16x32_bf16 v[104:107], v[48:51], v[200:203], v[104:107]
    ds_read_b128 v[40:43], v3 offset:10240
    v_mfma_f32_16x16x32_bf16 v[108:111], v[48:51], v[204:207], v[108:111]
    v_mfma_f32_16x16x32_bf16 v[112:115], v[52:55], v[200:203], v[112:115]
    ds_read_b128 v[44:47], v3 offset:11264
    v_mfma_f32_16x16x32_bf16 v[116:119], v[52:55], v[204:207], v[116:119]
    s_waitcnt lgkmcnt(4)
    v_mfma_f32_16x16x32_bf16 v[96:99], v[56:59], v[208:211], v[96:99]
    ds_read_b128 v[48:51], v3 offset:12288
    v_mfma_f32_16x16x32_bf16 v[100:103], v[56:59], v[212:215], v[100:103]
    s_waitcnt vmcnt(1)
    v_cmp_ne_u32 vcc, s35, v12
    s_cbranch_vccnz L_ap_76
L_aok_75:
    v_mfma_f32_16x16x32_bf16 v[104:107], v[60:63], v[208:211], v[104:107]
    ds_read_b128 v[52:55], v3 offset:13312
    v_mfma_f32_16x16x32_bf16 v[108:111], v[60:63], v[212:215], v[108:111]
    buffer_load_dwordx4 v[128:131], v1, s[28:31], s68 offen offset:0 sc1
    s_waitcnt lgkmcnt(4)
    v_mfma_f32_16x16x32_bf16 v[112:115], v[32:35], v[208:211], v[112:115]
    ds_read_b128 v[56:59], v3 offset:14336
    v_mfma_f32_16x16x32_bf16 v[116:119], v[32:35], v[212:215], v[116:119]
    buffer_load_dwordx4 v[132:135], v1, s[28:31], s69 offen offset:0 sc1
    v_mfma_f32_16x16x32_bf16 v[96:99], v[36:39], v[216:219], v[96:99]
    ds_read_b128 v[60:63], v3 offset:15360
    v_mfma_f32_16x16x32_bf16 v[100:103], v[36:39], v[220:223], v[100:103]
    s_waitcnt lgkmcnt(4)
    v_mfma_f32_16x16x32_bf16 v[104:107], v[40:43], v[216:219], v[104:107]
    ds_read_b128 v[32:35], v3 offset:16384
    v_mfma_f32_16x16x32_bf16 v[108:111], v[40:43], v[220:223], v[108:111]
    buffer_load_dwordx4 v[136:139], v1, s[28:31], s70 offen offset:0 sc1
    v_mfma_f32_16x16x32_bf16 v[112:115], v[44:47], v[216:219], v[112:115]
    ds_read_b128 v[36:39], v3 offset:17408
    v_mfma_f32_16x16x32_bf16 v[116:119], v[44:47], v[220:223], v[116:119]
    s_waitcnt lgkmcnt(4)
    v_mfma_f32_16x16x32_bf16 v[96:99], v[48:51], v[224:227], v[96:99]
    ds_read_b128 v[40:43], v3 offset:18432
    v_mfma_f32_16x16x32_bf16 v[100:103], v[48:51], v[228:231], v[100:103]
    buffer_load_dwordx4 v[140:143], v1, s[28:31], s71 offen offset:0 sc1
    v_mfma_f32_16x16x32_bf16 v[104:107], v[52:55], v[224:227], v[104:107]
    ds_read_b128 v[44:47], v3 offset:19456
    v_mfma_f32_16x16x32_bf16 v[108:111], v[52:55], v[228:231], v[108:111]
    s_waitcnt lgkmcnt(4)
    v_mfma_f32_16x16x32_bf16 v[112:115], v[56:59], v[224:227], v[112:115]
    ds_read_b128 v[48:51], v3 offset:20480
    v_mfma_f32_16x16x32_bf16 v[116:119], v[56:59], v[228:231], v[116:119]
    buffer_load_dwordx4 v[144:147], v1, s[28:31], s68 offen offset:1024 sc1
    v_mfma_f32_16x16x32_bf16 v[96:99], v[60:63], v[232:235], v[96:99]
    ds_read_b128 v[52:55], v3 offset:21504
    v_mfma_f32_16x16x32_bf16 v[100:103], v[60:63], v[236:239], v[100:103]
    s_waitcnt lgkmcnt(4)
    v_mfma_f32_16x16x32_bf16 v[104:107], v[32:35], v[232:235], v[104:107]
    ds_read_b128 v[56:59], v3 offset:22528
    buffer_load_dword v12, v15, s[28:31], s67 offen offset:1536 sc1
    v_mfma_f32_16x16x32_bf16 v[108:111], v[32:35], v[236:239], v[108:111]
    buffer_load_dwordx4 v[148:151], v1, s[28:31], s69 offen offset:1024 sc1
    v_mfma_f32_16x16x32_bf16 v[112:115], v[36:39], v[232:235], v[112:115]
    ds_read_b128 v[60:63], v3 offset:23552
    v_mfma_f32_16x16x32_bf16 v[116:119], v[36:39], v[236:239], v[116:119]
    s_waitcnt lgkmcnt(4)
    v_mfma_f32_16x16x32_bf16 v[96:99], v[40:43], v[240:243], v[96:99]
    v_mfma_f32_16x16x32_bf16 v[100:103], v[40:43], v[244:247], v[100:103]
    buffer_load_dwordx4 v[152:155], v1, s[28:31], s70 offen offset:1024 sc1
    v_mfma_f32_16x16x32_bf16 v[104:107], v[44:47], v[240:243], v[104:107]
    v_mfma_f32_16x16x32_bf16 v[108:111], v[44:47], v[244:247], v[108:111]
    s_waitcnt lgkmcnt(2)
    v_mfma_f32_16x16x32_bf16 v[112:115], v[48:51], v[240:243], v[112:115]
    buffer_load_dwordx4 v[156:159], v1, s[28:31], s71 offen offset:1024 sc1
    v_mfma_f32_16x16x32_bf16 v[116:119], v[48:51], v[244:247], v[116:119]
    v_mfma_f32_16x16x32_bf16 v[96:99], v[52:55], v[248:251], v[96:99]
    v_mfma_f32_16x16x32_bf16 v[100:103], v[52:55], v[252:255], v[100:103]
    s_waitcnt lgkmcnt(0)
    v_mfma_f32_16x16x32_bf16 v[104:107], v[56:59], v[248:251], v[104:107]
    buffer_load_dwordx4 v[160:163], v1, s[28:31], s68 offen offset:2048 sc1
    v_mfma_f32_16x16x32_bf16 v[108:111], v[56:59], v[252:255], v[108:111]
    v_mfma_f32_16x16x32_bf16 v[112:115], v[60:63], v[248:251], v[112:115]
    v_mfma_f32_16x16x32_bf16 v[116:119], v[60:63], v[252:255], v[116:119]
    s_nop 3
    v_cvt_pk_bf16_f32 v48, v96, v97
    v_cvt_pk_bf16_f32 v49, v98, v99
    v_pk_max_i16 v48, v48, 0
    v_pk_max_i16 v49, v49, 0
    v_cvt_pk_bf16_f32 v56, v100, v101
    v_cvt_pk_bf16_f32 v57, v102, v103
    v_pk_max_i16 v56, v56, 0
    v_pk_max_i16 v57, v57, 0
    v_cvt_pk_bf16_f32 v50, v104, v105
    v_cvt_pk_bf16_f32 v51, v106, v107
    buffer_load_dwordx4 v[164:167], v1, s[28:31], s69 offen offset:2048 sc1
    v_pk_max_i16 v50, v50, 0
    v_pk_max_i16 v51, v51, 0
    v_cvt_pk_bf16_f32 v58, v108, v109
    v_cvt_pk_bf16_f32 v59, v110, v111
    v_pk_max_i16 v58, v58, 0
    v_pk_max_i16 v59, v59, 0
    v_cvt_pk_bf16_f32 v52, v112, v113
    v_cvt_pk_bf16_f32 v53, v114, v115
    v_pk_max_i16 v52, v52, 0
    v_pk_max_i16 v53, v53, 0
    buffer_load_dwordx4 v[168:171], v1, s[28:31], s70 offen offset:2048 sc1
    v_cvt_pk_bf16_f32 v60, v116, v117
    v_cvt_pk_bf16_f32 v61, v118, v119
    v_pk_max_i16 v60, v60, 0
    v_pk_max_i16 v61, v61, 0
    s_cmp_lg_u32 s36, 0
    s_cbranch_scc1 L_ss_77
    buffer_store_dwordx4 v[48:51], v1, s[28:31], s62 offen nt
    buffer_store_dwordx2 v[52:53], v1, s[28:31], s64 offen nt
    buffer_store_dwordx4 v[56:59], v1, s[28:31], s63 offen nt
    buffer_store_dwordx2 v[60:61], v1, s[28:31], s65 offen nt
L_se_78:
    v_accvgpr_read_b32 v25, a244
    ds_read_b32 v24, v25
    s_waitcnt vmcnt(15)
    v_mfma_f32_16x16x32_bf16 v[64:67], a[0:3], v[128:131], 0
    v_mfma_f32_16x16x32_bf16 v[68:71], a[4:7], v[128:131], 0
    v_mfma_f32_16x16x32_bf16 v[72:75], a[8:11], v[128:131], 0
    v_mfma_f32_16x16x32_bf16 v[76:79], a[12:15], v[128:131], 0
    s_waitcnt vmcnt(14)
    v_mfma_f32_16x16x32_bf16 v[80:83], a[0:3], v[132:135], 0
    v_mfma_f32_16x16x32_bf16 v[84:87], a[4:7], v[132:135], 0
    v_mfma_f32_16x16x32_bf16 v[88:91], a[8:11], v[132:135], 0
    v_mfma_f32_16x16x32_bf16 v[92:95], a[12:15], v[132:135], 0
    s_waitcnt vmcnt(13)
    v_mfma_f32_16x16x32_bf16 v[96:99], a[0:3], v[136:139], 0
    buffer_load_dwordx4 v[172:175], v1, s[28:31], s71 offen offset:2048 sc1
    v_mfma_f32_16x16x32_bf16 v[100:103], a[4:7], v[136:139], 0
    v_mfma_f32_16x16x32_bf16 v[104:107], a[8:11], v[136:139], 0
    v_mfma_f32_16x16x32_bf16 v[108:111], a[12:15], v[136:139], 0
    s_waitcnt vmcnt(13)
    v_mfma_f32_16x16x32_bf16 v[112:115], a[0:3], v[140:143], 0
    buffer_load_dwordx4 v[176:179], v1, s[28:31], s68 offen offset:3072 sc1
    v_mfma_f32_16x16x32_bf16 v[116:119], a[4:7], v[140:143], 0
    v_mfma_f32_16x16x32_bf16 v[120:123], a[8:11], v[140:143], 0
    v_mfma_f32_16x16x32_bf16 v[124:127], a[12:15], v[140:143], 0
    s_waitcnt vmcnt(13)
    v_mfma_f32_16x16x32_bf16 v[64:67], a[32:35], v[144:147], v[64:67]
    buffer_load_dwordx4 v[180:183], v1, s[28:31], s69 offen offset:3072 sc1
    v_mfma_f32_16x16x32_bf16 v[68:71], a[36:39], v[144:147], v[68:71]
    v_mfma_f32_16x16x32_bf16 v[72:75], a[40:43], v[144:147], v[72:75]
    v_mfma_f32_16x16x32_bf16 v[76:79], a[44:47], v[144:147], v[76:79]
    s_waitcnt vmcnt(12)
    v_mfma_f32_16x16x32_bf16 v[80:83], a[32:35], v[148:151], v[80:83]
    buffer_load_dwordx4 v[184:187], v1, s[28:31], s70 offen offset:3072 sc1
L_pad16:
    s_cbranch_execz L_padret0
    v_mfma_f32_16x16x32_bf16 v[84:87], a[36:39], v[148:151], v[84:87]
    v_mfma_f32_16x16x32_bf16 v[88:91], a[40:43], v[148:151], v[88:91]
    v_mfma_f32_16x16x32_bf16 v[92:95], a[44:47], v[148:151], v[92:95]
    v_mov_b32 v13, s35
    s_waitcnt vmcnt(4)
    s_mov_b64 exec, 1
    s_cmp_lg_u32 s36, 0
    s_cbranch_scc1 L_ss_79
    buffer_store_dword v13, v1, s[28:31], s66 offen offset:2560
L_se_80:
    s_mov_b64 exec, -1
    v_mfma_f32_16x16x32_bf16 v[96:99], a[32:35], v[152:155], v[96:99]
    buffer_load_dwordx4 v[188:191], v1, s[28:31], s71 offen offset:3072 sc1
    v_mfma_f32_16x16x32_bf16 v[100:103], a[36:39], v[152:155], v[100:103]
    v_mfma_f32_16x16x32_bf16 v[104:107], a[40:43], v[152:155], v[104:107]
    v_mfma_f32_16x16x32_bf16 v[108:111], a[44:47], v[152:155], v[108:111]
    v_mfma_f32_16x16x32_bf16 v[112:115], a[32:35], v[156:159], v[112:115]
    v_cmp_ne_u32 vcc, s35, v12
    s_cbranch_vccnz L_ap_82
L_aok_81:
    s_add_u32 s68, s68, 4096
    buffer_load_dwordx4 v[128:131], v1, s[28:31], s68 offen offset:0 sc1
    v_mfma_f32_16x16x32_bf16 v[116:119], a[36:39], v[156:159], v[116:119]
    v_mfma_f32_16x16x32_bf16 v[120:123], a[40:43], v[156:159], v[120:123]
    v_mfma_f32_16x16x32_bf16 v[124:127], a[44:47], v[156:159], v[124:127]
    v_mfma_f32_16x16x32_bf16 v[64:67], a[64:67], v[160:163], v[64:67]
    s_add_u32 s69, s69, 4096
    buffer_load_dwordx4 v[132:135], v1, s[28:31], s69 offen offset:0 sc1
    v_mfma_f32_16x16x32_bf16 v[68:71], a[68:71], v[160:163], v[68:71]
    v_lshlrev_b32 v32, 16, v16
    v_mfma_f32_16x16x32_bf16 v[72:75], a[72:75], v[160:163], v[72:75]
    v_mfma_f32_16x16x32_bf16 v[76:79], a[76:79], v[160:163], v[76:79]
    v_mfma_f32_16x16x32_bf16 v[80:83], a[64:67], v[164:167], v[80:83]
    s_add_u32 s70, s70, 4096
    buffer_load_dwordx4 v[136:139], v1, s[28:31], s70 offen offset:0 sc1
    v_mfma_f32_16x16x32_bf16 v[84:87], a[68:71], v[164:167], v[84:87]
    v_and_b32 v33, 0xffff0000, v16
    v_mfma_f32_16x16x32_bf16 v[88:91], a[72:75], v[164:167], v[88:91]
    v_mfma_f32_16x16x32_bf16 v[92:95], a[76:79], v[164:167], v[92:95]
    v_mfma_f32_16x16x32_bf16 v[96:99], a[64:67], v[168:171], v[96:99]
    s_add_u32 s71, s71, 4096
    buffer_load_dwordx4 v[140:143], v1, s[28:31], s71 offen offset:0 sc1
    v_mfma_f32_16x16x32_bf16 v[100:103], a[68:71], v[168:171], v[100:103]
    v_lshlrev_b32 v34, 16, v17
    v_mfma_f32_16x16x32_bf16 v[104:107], a[72:75], v[168:171], v[104:107]
    v_mfma_f32_16x16x32_bf16 v[108:111], a[76:79], v[168:171], v[108:111]
    s_waitcnt vmcnt(9)
    v_mfma_f32_16x16x32_bf16 v[112:115], a[64:67], v[172:175], v[112:115]
    buffer_load_dwordx4 v[144:147], v1, s[28:31], s68 offen offset:1024 sc1
    v_mfma_f32_16x16x32_bf16 v[116:119], a[68:71], v[172:175], v[116:119]
    v_and_b32 v35, 0xffff0000, v17
    v_mfma_f32_16x16x32_bf16 v[120:123], a[72:75], v[172:175], v[120:123]
    v_mfma_f32_16x16x32_bf16 v[124:127], a[76:79], v[172:175], v[124:127]
    s_waitcnt vmcnt(9)
    v_mfma_f32_16x16x32_bf16 v[64:67], a[96:99], v[176:179], v[64:67]
    buffer_load_dwordx4 v[148:151], v1, s[28:31], s69 offen offset:1024 sc1
    v_mfma_f32_16x16x32_bf16 v[68:71], a[100:103], v[176:179], v[68:71]
    v_lshlrev_b32 v36, 16, v18
    v_mfma_f32_16x16x32_bf16 v[72:75], a[104:107], v[176:179], v[72:75]
    v_mfma_f32_16x16x32_bf16 v[76:79], a[108:111], v[176:179], v[76:79]
    s_waitcnt vmcnt(9)
    v_mfma_f32_16x16x32_bf16 v[80:83], a[96:99], v[180:183], v[80:83]
    buffer_load_dwordx4 v[152:155], v1, s[28:31], s70 offen offset:1024 sc1
    v_mfma_f32_16x16x32_bf16 v[84:87], a[100:103], v[180:183], v[84:87]
    v_and_b32 v37, 0xffff0000, v18
    v_mfma_f32_16x16x32_bf16 v[88:91], a[104:107], v[180:183], v[88:91]
    v_mfma_f32_16x16x32_bf16 v[92:95], a[108:111], v[180:183], v[92:95]
    s_waitcnt vmcnt(9)
    v_mfma_f32_16x16x32_bf16 v[96:99], a[96:99], v[184:187], v[96:99]
    buffer_load_dwordx4 v[156:159], v1, s[28:31], s71 offen offset:1024 sc1
    v_mfma_f32_16x16x32_bf16 v[100:103], a[100:103], v[184:187], v[100:103]
    v_lshlrev_b32 v38, 16, v19
    v_mfma_f32_16x16x32_bf16 v[104:107], a[104:107], v[184:187], v[104:107]
    v_mfma_f32_16x16x32_bf16 v[108:111], a[108:111], v[184:187], v[108:111]
    s_waitcnt vmcnt(8)
    v_mfma_f32_16x16x32_bf16 v[112:115], a[96:99], v[188:191], v[112:115]
    buffer_load_dwordx4 v[160:163], v1, s[28:31], s68 offen offset:2048 sc1
    v_mfma_f32_16x16x32_bf16 v[116:119], a[100:103], v[188:191], v[116:119]
    v_and_b32 v39, 0xffff0000, v19
    v_mfma_f32_16x16x32_bf16 v[120:123], a[104:107], v[188:191], v[120:123]
    v_mfma_f32_16x16x32_bf16 v[124:127], a[108:111], v[188:191], v[124:127]
    s_waitcnt vmcnt(8)
    v_mfma_f32_16x16x32_bf16 v[64:67], a[16:19], v[128:131], v[64:67]
    buffer_load_dword v12, v15, s[28:31], s67 offen offset:2560 sc1
    buffer_load_dwordx4 v[164:167], v1, s[28:31], s69 offen offset:2048 sc1
    v_mfma_f32_16x16x32_bf16 v[68:71], a[20:23], v[128:131], v[68:71]
    v_lshlrev_b32 v40, 16, v20
    v_mfma_f32_16x16x32_bf16 v[72:75], a[24:27], v[128:131], v[72:75]
    v_mfma_f32_16x16x32_bf16 v[76:79], a[28:31], v[128:131], v[76:79]
    s_waitcnt vmcnt(9)
    v_mfma_f32_16x16x32_bf16 v[80:83], a[16:19], v[132:135], v[80:83]
    buffer_load_dwordx4 v[168:171], v1, s[28:31], s70 offen offset:2048 sc1
    v_mfma_f32_16x16x32_bf16 v[84:87], a[20:23], v[132:135], v[84:87]
    v_and_b32 v41, 0xffff0000, v20
    v_mfma_f32_16x16x32_bf16 v[88:91], a[24:27], v[132:135], v[88:91]
    v_mfma_f32_16x16x32_bf16 v[92:95], a[28:31], v[132:135], v[92:95]
    s_waitcnt vmcnt(9)
    v_mfma_f32_16x16x32_bf16 v[96:99], a[16:19], v[136:139], v[96:99]
    buffer_load_dwordx4 v[172:175], v1, s[28:31], s71 offen offset:2048 sc1
    v_mfma_f32_16x16x32_bf16 v[100:103], a[20:23], v[136:139], v[100:103]
    v_lshlrev_b32 v42, 16, v21
    v_mfma_f32_16x16x32_bf16 v[104:107], a[24:27], v[136:139], v[104:107]
    v_mfma_f32_16x16x32_bf16 v[108:111], a[28:31], v[136:139], v[108:111]
    s_waitcnt vmcnt(9)
    v_mfma_f32_16x16x32_bf16 v[112:115], a[16:19], v[140:143], v[112:115]
    buffer_load_dwordx4 v[176:179], v1, s[28:31], s68 offen offset:3072 sc1
    v_mfma_f32_16x16x32_bf16 v[116:119], a[20:23], v[140:143], v[116:119]
    v_and_b32 v43, 0xffff0000, v21
    v_mfma_f32_16x16x32_bf16 v[120:123], a[24:27], v[140:143], v[120:123]
    v_mfma_f32_16x16x32_bf16 v[124:127], a[28:31], v[140:143], v[124:127]
    s_waitcnt vmcnt(9)
    v_mfma_f32_16x16x32_bf16 v[64:67], a[48:51], v[144:147], v[64:67]
    buffer_load_dwordx4 v[180:183], v1, s[28:31], s69 offen offset:3072 sc1
    v_mfma_f32_16x16x32_bf16 v[68:71], a[52:55], v[144:147], v[68:71]
    v_lshlrev_b32 v44, 16, v22
    v_mfma_f32_16x16x32_bf16 v[72:75], a[56:59], v[144:147], v[72:75]
    v_mfma_f32_16x16x32_bf16 v[76:79], a[60:63], v[144:147], v[76:79]
    s_waitcnt vmcnt(9)
    v_mfma_f32_16x16x32_bf16 v[80:83], a[48:51], v[148:151], v[80:83]
    buffer_load_dwordx4 v[184:187], v1, s[28:31], s70 offen offset:3072 sc1
    v_mfma_f32_16x16x32_bf16 v[84:87], a[52:55], v[148:151], v[84:87]
    v_and_b32 v45, 0xffff0000, v22
    v_mfma_f32_16x16x32_bf16 v[88:91], a[56:59], v[148:151], v[88:91]
    v_mfma_f32_16x16x32_bf16 v[92:95], a[60:63], v[148:151], v[92:95]
    s_waitcnt vmcnt(9)
    v_mfma_f32_16x16x32_bf16 v[96:99], a[48:51], v[152:155], v[96:99]
    buffer_load_dwordx4 v[188:191], v1, s[28:31], s71 offen offset:3072 sc1
    v_mfma_f32_16x16x32_bf16 v[100:103], a[52:55], v[152:155], v[100:103]
    v_lshlrev_b32 v46, 16, v23
    v_mfma_f32_16x16x32_bf16 v[104:107], a[56:59], v[152:155], v[104:107]
    v_mfma_f32_16x16x32_bf16 v[108:111], a[60:63], v[152:155], v[108:111]
    s_waitcnt vmcnt(9)
    v_mfma_f32_16x16x32_bf16 v[112:115], a[48:51], v[156:159], v[112:115]
    s_waitcnt vmcnt(7)
    v_cmp_ne_u32 vcc, s35, v12
    s_cbranch_vccnz L_ap_84
L_aok_83:
    s_sub_u32 s68, s68, s92
    buffer_load_dwordx4 v[128:131], v1, s[28:31], s68 offen offset:0 sc1
    v_mfma_f32_16x16x32_bf16 v[116:119], a[52:55], v[156:159], v[116:119]
    v_and_b32 v47, 0xffff0000, v23
    v_mfma_f32_16x16x32_bf16 v[120:123], a[56:59], v[156:159], v[120:123]
    v_mfma_f32_16x16x32_bf16 v[124:127], a[60:63], v[156:159], v[124:127]
    v_mfma_f32_16x16x32_bf16 v[64:67], a[80:83], v[160:163], v[64:67]
    s_sub_u32 s69, s69, s92
    buffer_load_dwordx4 v[132:135], v1, s[28:31], s69 offen offset:0 sc1
    v_mfma_f32_16x16x32_bf16 v[68:71], a[84:87], v[160:163], v[68:71]
    s_add_u32 s42, s32, 0
    s_and_b32 s42, s42, 3
    v_mfma_f32_16x16x32_bf16 v[72:75], a[88:91], v[160:163], v[72:75]
    v_mfma_f32_16x16x32_bf16 v[76:79], a[92:95], v[160:163], v[76:79]
    s_waitcnt vmcnt(8)
    v_mfma_f32_16x16x32_bf16 v[80:83], a[80:83], v[164:167], v[80:83]
    s_sub_u32 s70, s70, s92
    buffer_load_dwordx4 v[136:139], v1, s[28:31], s70 offen offset:0 sc1
    v_mfma_f32_16x16x32_bf16 v[84:87], a[84:87], v[164:167], v[84:87]
    s_lshl_b32 s42, s42, 14
    s_add_u32 s42, s42, 0
    v_mfma_f32_16x16x32_bf16 v[88:91], a[88:91], v[164:167], v[88:91]
    v_mfma_f32_16x16x32_bf16 v[92:95], a[92:95], v[164:167], v[92:95]
    s_waitcnt vmcnt(8)
    v_mfma_f32_16x16x32_bf16 v[96:99], a[80:83], v[168:171], v[96:99]
    s_sub_u32 s71, s71, s92
    buffer_load_dwordx4 v[140:143], v1, s[28:31], s71 offen offset:0 sc1
    v_mfma_f32_16x16x32_bf16 v[100:103], a[84:87], v[168:171], v[100:103]
    v_add_u32 v28, s42, v1
    v_mfma_f32_16x16x32_bf16 v[104:107], a[88:91], v[168:171], v[104:107]
    v_mfma_f32_16x16x32_bf16 v[108:111], a[92:95], v[168:171], v[108:111]
    s_waitcnt vmcnt(8)
    v_mfma_f32_16x16x32_bf16 v[112:115], a[80:83], v[172:175], v[112:115]
    buffer_load_dwordx4 v[144:147], v1, s[28:31], s68 offen offset:1024 sc1
    v_mfma_f32_16x16x32_bf16 v[116:119], a[84:87], v[172:175], v[116:119]
    s_add_u32 s42, s32, 1
    s_and_b32 s42, s42, 3
    v_mfma_f32_16x16x32_bf16 v[120:123], a[88:91], v[172:175], v[120:123]
    v_mfma_f32_16x16x32_bf16 v[124:127], a[92:95], v[172:175], v[124:127]
    s_waitcnt vmcnt(8)
    v_mfma_f32_16x16x32_bf16 v[64:67], a[112:115], v[176:179], v[64:67]
    buffer_load_dwordx4 v[148:151], v1, s[28:31], s69 offen offset:1024 sc1
    v_mfma_f32_16x16x32_bf16 v[68:71], a[116:119], v[176:179], v[68:71]
    s_lshl_b32 s42, s42, 14
    s_add_u32 s42, s42, 0
    v_mfma_f32_16x16x32_bf16 v[72:75], a[120:123], v[176:179], v[72:75]
    v_mfma_f32_16x16x32_bf16 v[76:79], a[124:127], v[176:179], v[76:79]
    s_waitcnt vmcnt(8)
    v_mfma_f32_16x16x32_bf16 v[80:83], a[112:115], v[180:183], v[80:83]
    buffer_load_dwordx4 v[152:155], v1, s[28:31], s70 offen offset:1024 sc1
    v_mfma_f32_16x16x32_bf16 v[84:87], a[116:119], v[180:183], v[84:87]
    v_add_u32 v29, s42, v1
    v_mfma_f32_16x16x32_bf16 v[88:91], a[120:123], v[180:183], v[88:91]
    v_mfma_f32_16x16x32_bf16 v[92:95], a[124:127], v[180:183], v[92:95]
    s_waitcnt vmcnt(8)
    v_mfma_f32_16x16x32_bf16 v[96:99], a[112:115], v[184:187], v[96:99]
    buffer_load_dwordx4 v[156:159], v1, s[28:31], s71 offen offset:1024 sc1
    v_mfma_f32_16x16x32_bf16 v[100:103], a[116:119], v[184:187], v[100:103]
    s_add_u32 s42, s32, 2
    s_and_b32 s42, s42, 3
    v_mfma_f32_16x16x32_bf16 v[104:107], a[120:123], v[184:187], v[104:107]
    v_mfma_f32_16x16x32_bf16 v[108:111], a[124:127], v[184:187], v[108:111]
    s_waitcnt vmcnt(8)
    v_mfma_f32_16x16x32_bf16 v[112:115], a[112:115], v[188:191], v[112:115]
    buffer_load_dwordx4 v[160:163], v1, s[28:31], s69 offen offset:2048 sc1
    v_mfma_f32_16x16x32_bf16 v[116:119], a[116:119], v[188:191], v[116:119]
    s_lshl_b32 s42, s42, 14
    s_add_u32 s42, s42, 4096
    v_mfma_f32_16x16x32_bf16 v[120:123], a[120:123], v[188:191], v[120:123]
    v_mfma_f32_16x16x32_bf16 v[124:127], a[124:127], v[188:191], v[124:127]
    s_waitcnt vmcnt(8)
    v_mfma_f32_16x16x32_bf16 v[64:67], a[128:131], v[128:131], v[64:67]
    buffer_load_dwordx4 v[164:167], v1, s[28:31], s69 offen offset:3072 sc1
    v_mfma_f32_16x16x32_bf16 v[68:71], a[132:135], v[128:131], v[68:71]
    v_add_u32 v30, s42, v1
    v_mfma_f32_16x16x32_bf16 v[72:75], a[136:139], v[128:131], v[72:75]
    v_mfma_f32_16x16x32_bf16 v[76:79], a[140:143], v[128:131], v[76:79]
    s_waitcnt vmcnt(8)
    v_mfma_f32_16x16x32_bf16 v[80:83], a[128:131], v[132:135], v[80:83]
    s_add_u32 s69, s69, 4096
    buffer_load_dwordx4 v[168:171], v1, s[28:31], s69 offen offset:0 sc1
    v_mfma_f32_16x16x32_bf16 v[84:87], a[132:135], v[132:135], v[84:87]
    s_add_u32 s42, s32, 3
    s_and_b32 s42, s42, 3
    v_mfma_f32_16x16x32_bf16 v[88:91], a[136:139], v[132:135], v[88:91]
    v_mfma_f32_16x16x32_bf16 v[92:95], a[140:143], v[132:135], v[92:95]
    s_waitcnt vmcnt(8)
    v_mfma_f32_16x16x32_bf16 v[96:99], a[128:131], v[136:139], v[96:99]
    buffer_load_dwordx4 v[172:175], v1, s[28:31], s69 offen offset:1024 sc1
    v_mfma_f32_16x16x32_bf16 v[100:103], a[132:135], v[136:139], v[100:103]
    s_lshl_b32 s42, s42, 14
    s_add_u32 s42, s42, 8192
    v_mfma_f32_16x16x32_bf16 v[104:107], a[136:139], v[136:139], v[104:107]
    v_mfma_f32_16x16x32_bf16 v[108:111], a[140:143], v[136:139], v[108:111]
    s_waitcnt vmcnt(8)
    v_mfma_f32_16x16x32_bf16 v[112:115], a[128:131], v[140:143], v[112:115]
    buffer_load_dwordx4 v[176:179], v1, s[28:31], s70 offen offset:2048 sc1
    v_mfma_f32_16x16x32_bf16 v[116:119], a[132:135], v[140:143], v[116:119]
    v_add_u32 v31, s42, v1
    v_mfma_f32_16x16x32_bf16 v[120:123], a[136:139], v[140:143], v[120:123]
    v_mfma_f32_16x16x32_bf16 v[124:127], a[140:143], v[140:143], v[124:127]
    s_waitcnt vmcnt(8)
    v_mfma_f32_16x16x32_bf16 v[64:67], a[144:147], v[144:147], v[64:67]
    buffer_load_dwordx4 v[180:183], v1, s[28:31], s70 offen offset:3072 sc1
    v_mfma_f32_16x16x32_bf16 v[68:71], a[148:151], v[144:147], v[68:71]
    v_mfma_f32_16x16x32_bf16 v[72:75], a[152:155], v[144:147], v[72:75]
    v_mfma_f32_16x16x32_bf16 v[76:79], a[156:159], v[144:147], v[76:79]
    s_waitcnt vmcnt(8)
    v_mfma_f32_16x16x32_bf16 v[80:83], a[144:147], v[148:151], v[80:83]
    s_add_u32 s70, s70, 4096
    buffer_load_dwordx4 v[184:187], v1, s[28:31], s70 offen offset:0 sc1
    v_mfma_f32_16x16x32_bf16 v[84:87], a[148:151], v[148:151], v[84:87]
    v_mfma_f32_16x16x32_bf16 v[88:91], a[152:155], v[148:151], v[88:91]
    v_mfma_f32_16x16x32_bf16 v[92:95], a[156:159], v[148:151], v[92:95]
    s_waitcnt vmcnt(8)
    v_mfma_f32_16x16x32_bf16 v[96:99], a[144:147], v[152:155], v[96:99]
    buffer_load_dwordx4 v[188:191], v1, s[28:31], s70 offen offset:1024 sc1
    v_mfma_f32_16x16x32_bf16 v[100:103], a[148:151], v[152:155], v[100:103]
    v_mfma_f32_16x16x32_bf16 v[104:107], a[152:155], v[152:155], v[104:107]
    v_mfma_f32_16x16x32_bf16 v[108:111], a[156:159], v[152:155], v[108:111]
    s_waitcnt vmcnt(8)
    v_mfma_f32_16x16x32_bf16 v[112:115], a[144:147], v[156:159], v[112:115]
    buffer_load_dwordx4 v[128:131], v1, s[28:31], s71 offen offset:2048 sc1
    v_mfma_f32_16x16x32_bf16 v[116:119], a[148:151], v[156:159], v[116:119]
    v_mfma_f32_16x16x32_bf16 v[120:123], a[152:155], v[156:159], v[120:123]
    v_mfma_f32_16x16x32_bf16 v[124:127], a[156:159], v[156:159], v[124:127]
    s_waitcnt vmcnt(8)
    v_mfma_f32_16x16x32_bf16 v[80:83], a[160:163], v[160:163], v[80:83]
    buffer_load_dwordx4 v[132:135], v1, s[28:31], s71 offen offset:3072 sc1
    v_mfma_f32_16x16x32_bf16 v[84:87], a[164:167], v[160:163], v[84:87]
    v_mfma_f32_16x16x32_bf16 v[88:91], a[168:171], v[160:163], v[88:91]
    v_mfma_f32_16x16x32_bf16 v[92:95], a[172:175], v[160:163], v[92:95]
    s_waitcnt vmcnt(8)
    v_mfma_f32_16x16x32_bf16 v[80:83], a[176:179], v[164:167], v[80:83]
    s_add_u32 s71, s71, 4096
    buffer_load_dwordx4 v[136:139], v1, s[28:31], s71 offen offset:0 sc1
    v_mfma_f32_16x16x32_bf16 v[84:87], a[180:183], v[164:167], v[84:87]
    v_mfma_f32_16x16x32_bf16 v[88:91], a[184:187], v[164:167], v[88:91]
    v_mfma_f32_16x16x32_bf16 v[92:95], a[188:191], v[164:167], v[92:95]
    s_waitcnt vmcnt(8)
    v_mfma_f32_16x16x32_bf16 v[80:83], a[192:195], v[168:171], v[80:83]
    buffer_load_dwordx4 v[140:143], v1, s[28:31], s71 offen offset:1024 sc1
    v_mfma_f32_16x16x32_bf16 v[84:87], a[196:199], v[168:171], v[84:87]
    v_mfma_f32_16x16x32_bf16 v[88:91], a[200:203], v[168:171], v[88:91]
    v_mfma_f32_16x16x32_bf16 v[92:95], a[204:207], v[168:171], v[92:95]
    s_waitcnt vmcnt(8)
    v_mfma_f32_16x16x32_bf16 v[80:83], a[208:211], v[172:175], v[80:83]
    buffer_load_dwordx4 v[144:147], v1, s[28:31], s68 offen offset:2048 sc1
    v_mfma_f32_16x16x32_bf16 v[84:87], a[212:215], v[172:175], v[84:87]
    v_mfma_f32_16x16x32_bf16 v[88:91], a[216:219], v[172:175], v[88:91]
    v_mfma_f32_16x16x32_bf16 v[92:95], a[220:223], v[172:175], v[92:95]
    s_waitcnt vmcnt(8)
    v_mfma_f32_16x16x32_bf16 v[96:99], a[160:163], v[176:179], v[96:99]
    buffer_load_dwordx4 v[148:151], v1, s[28:31], s68 offen offset:3072 sc1
    v_mfma_f32_16x16x32_bf16 v[100:103], a[164:167], v[176:179], v[100:103]
    v_mfma_f32_16x16x32_bf16 v[104:107], a[168:171], v[176:179], v[104:107]
    v_mfma_f32_16x16x32_bf16 v[108:111], a[172:175], v[176:179], v[108:111]
    s_waitcnt vmcnt(8)
    v_mfma_f32_16x16x32_bf16 v[96:99], a[176:179], v[180:183], v[96:99]
L_pad17:
    s_cbranch_execz L_padret0
    s_add_u32 s68, s68, 4096
    buffer_load_dwordx4 v[152:155], v1, s[28:31], s68 offen offset:0 sc1
    v_mfma_f32_16x16x32_bf16 v[100:103], a[180:183], v[180:183], v[100:103]
    ds_write_b128 v29, v[80:83] offset:0
    v_mfma_f32_16x16x32_bf16 v[104:107], a[184:187], v[180:183], v[104:107]
    v_mfma_f32_16x16x32_bf16 v[108:111], a[188:191], v[180:183], v[108:111]
    ds_write_b128 v29, v[84:87] offset:1024
    s_waitcnt vmcnt(8)
    v_mfma_f32_16x16x32_bf16 v[96:99], a[192:195], v[184:187], v[96:99]
    buffer_load_dwordx4 v[156:159], v1, s[28:31], s68 offen offset:1024 sc1
    v_mfma_f32_16x16x32_bf16 v[100:103], a[196:199], v[184:187], v[100:103]
    ds_write_b128 v29, v[88:91] offset:2048
    v_mfma_f32_16x16x32_bf16 v[104:107], a[200:203], v[184:187], v[104:107]
    v_mfma_f32_16x16x32_bf16 v[108:111], a[204:207], v[184:187], v[108:111]
    ds_write_b128 v29, v[92:95] offset:3072
    s_waitcnt vmcnt(8)
    v_mfma_f32_16x16x32_bf16 v[96:99], a[208:211], v[188:191], v[96:99]
    v_mfma_f32_16x16x32_bf16 v[100:103], a[212:215], v[188:191], v[100:103]
    v_mfma_f32_16x16x32_bf16 v[104:107], a[216:219], v[188:191], v[104:107]
    v_mfma_f32_16x16x32_bf16 v[108:111], a[220:223], v[188:191], v[108:111]
    s_waitcnt vmcnt(7)
    v_mfma_f32_16x16x32_bf16 v[112:115], a[160:163], v[128:131], v[112:115]
    v_mfma_f32_16x16x32_bf16 v[116:119], a[164:167], v[128:131], v[116:119]
    v_mfma_f32_16x16x32_bf16 v[120:123], a[168:171], v[128:131], v[120:123]
    v_mfma_f32_16x16x32_bf16 v[124:127], a[172:175], v[128:131], v[124:127]
    s_waitcnt vmcnt(6)
    v_mfma_f32_16x16x32_bf16 v[112:115], a[176:179], v[132:135], v[112:115]
    v_mfma_f32_16x16x32_bf16 v[116:119], a[180:183], v[132:135], v[116:119]
    ds_write_b128 v30, v[96:99] offset:0
    v_mfma_f32_16x16x32_bf16 v[120:123], a[184:187], v[132:135], v[120:123]
    v_mfma_f32_16x16x32_bf16 v[124:127], a[188:191], v[132:135], v[124:127]
    ds_write_b128 v30, v[100:103] offset:1024
    s_waitcnt vmcnt(5)
    v_mfma_f32_16x16x32_bf16 v[112:115], a[192:195], v[136:139], v[112:115]
    v_mfma_f32_16x16x32_bf16 v[116:119], a[196:199], v[136:139], v[116:119]
    ds_write_b128 v30, v[104:107] offset:2048
    v_mfma_f32_16x16x32_bf16 v[120:123], a[200:203], v[136:139], v[120:123]
    v_mfma_f32_16x16x32_bf16 v[124:127], a[204:207], v[136:139], v[124:127]
    ds_write_b128 v30, v[108:111] offset:3072
    s_waitcnt vmcnt(4)
    v_mfma_f32_16x16x32_bf16 v[112:115], a[208:211], v[140:143], v[112:115]
    v_mfma_f32_16x16x32_bf16 v[116:119], a[212:215], v[140:143], v[116:119]
    v_mfma_f32_16x16x32_bf16 v[120:123], a[216:219], v[140:143], v[120:123]
    v_mfma_f32_16x16x32_bf16 v[124:127], a[220:223], v[140:143], v[124:127]
    s_waitcnt vmcnt(3)
    v_mfma_f32_16x16x32_bf16 v[64:67], a[160:163], v[144:147], v[64:67]
    v_mfma_f32_16x16x32_bf16 v[68:71], a[164:167], v[144:147], v[68:71]
    v_mfma_f32_16x16x32_bf16 v[72:75], a[168:171], v[144:147], v[72:75]
    v_mfma_f32_16x16x32_bf16 v[76:79], a[172:175], v[144:147], v[76:79]
    s_waitcnt vmcnt(2)
    v_mfma_f32_16x16x32_bf16 v[64:67], a[176:179], v[148:151], v[64:67]
    v_mfma_f32_16x16x32_bf16 v[68:71], a[180:183], v[148:151], v[68:71]
    ds_write_b128 v31, v[112:115] offset:0
    v_mfma_f32_16x16x32_bf16 v[72:75], a[184:187], v[148:151], v[72:75]
    v_mfma_f32_16x16x32_bf16 v[76:79], a[188:191], v[148:151], v[76:79]
    ds_write_b128 v31, v[116:119] offset:1024
    s_waitcnt vmcnt(1)
    v_mfma_f32_16x16x32_bf16 v[64:67], a[192:195], v[152:155], v[64:67]
    v_mfma_f32_16x16x32_bf16 v[68:71], a[196:199], v[152:155], v[68:71]
    ds_write_b128 v31, v[120:123] offset:2048
    v_mfma_f32_16x16x32_bf16 v[72:75], a[200:203], v[152:155], v[72:75]
    v_mfma_f32_16x16x32_bf16 v[76:79], a[204:207], v[152:155], v[76:79]
    ds_write_b128 v31, v[124:127] offset:3072
    s_waitcnt vmcnt(0)
    v_mfma_f32_16x16x32_bf16 v[64:67], a[208:211], v[156:159], v[64:67]
    v_mfma_f32_16x16x32_bf16 v[68:71], a[212:215], v[156:159], v[68:71]
    v_mfma_f32_16x16x32_bf16 v[72:75], a[216:219], v[156:159], v[72:75]
    v_mfma_f32_16x16x32_bf16 v[76:79], a[220:223], v[156:159], v[76:79]
    v_accvgpr_read_b32 v14, a245
    s_waitcnt lgkmcnt(0)
    s_barrier
    ds_read_b128 v[80:83], v28 offset:0
    ds_read_b128 v[96:99], v28 offset:4096
    ds_read_b128 v[112:115], v28 offset:8192
    ds_read_b128 v[84:87], v28 offset:1024
    ds_read_b128 v[100:103], v28 offset:5120
    ds_read_b128 v[116:119], v28 offset:9216
    ds_read_b128 v[88:91], v28 offset:2048
    ds_read_b128 v[104:107], v28 offset:6144
    ds_read_b128 v[120:123], v28 offset:10240
    ds_read_b128 v[92:95], v28 offset:3072
    ds_read_b128 v[108:111], v28 offset:7168
    ds_read_b128 v[124:127], v28 offset:11264
    s_waitcnt lgkmcnt(9)
    v_pk_add_f32 v[64:65], v[64:65], v[80:81]
    v_pk_add_f32 v[66:67], v[66:67], v[82:83]
    v_pk_add_f32 v[64:65], v[64:65], v[96:97]
    v_pk_add_f32 v[66:67], v[66:67], v[98:99]
    v_pk_add_f32 v[64:65], v[64:65], v[112:113]
    v_pk_add_f32 v[66:67], v[66:67], v[114:115]
    v_pk_fma_f32 v[64:65], v[64:65], v[24:25], v[32:33] op_sel_hi:[1,0,1]
    v_pk_fma_f32 v[66:67], v[66:67], v[24:25], v[34:35] op_sel_hi:[1,0,1]
    v_cvt_pk_bf16_f32 v16, v64, v65
    v_cvt_pk_bf16_f32 v17, v66, v67
    s_waitcnt lgkmcnt(6)
    v_pk_add_f32 v[68:69], v[68:69], v[84:85]
    v_pk_add_f32 v[70:71], v[70:71], v[86:87]
    v_pk_add_f32 v[68:69], v[68:69], v[100:101]
    v_pk_add_f32 v[70:71], v[70:71], v[102:103]
    v_pk_add_f32 v[68:69], v[68:69], v[116:117]
    v_pk_add_f32 v[70:71], v[70:71], v[118:119]
    v_pk_fma_f32 v[68:69], v[68:69], v[24:25], v[36:37] op_sel_hi:[1,0,1]
    v_pk_fma_f32 v[70:71], v[70:71], v[24:25], v[38:39] op_sel_hi:[1,0,1]
    v_cvt_pk_bf16_f32 v18, v68, v69
    v_cvt_pk_bf16_f32 v19, v70, v71
    s_waitcnt lgkmcnt(3)
    v_pk_add_f32 v[72:73], v[72:73], v[88:89]
    v_pk_add_f32 v[74:75], v[74:75], v[90:91]
    v_pk_add_f32 v[72:73], v[72:73], v[104:105]
    v_pk_add_f32 v[74:75], v[74:75], v[106:107]
    v_pk_add_f32 v[72:73], v[72:73], v[120:121]
    v_pk_add_f32 v[74:75], v[74:75], v[122:123]
    v_pk_fma_f32 v[72:73], v[72:73], v[24:25], v[40:41] op_sel_hi:[1,0,1]
    v_pk_fma_f32 v[74:75], v[74:75], v[24:25], v[42:43] op_sel_hi:[1,0,1]
    v_cvt_pk_bf16_f32 v20, v72, v73
    v_cvt_pk_bf16_f32 v21, v74, v75
    s_waitcnt lgkmcnt(0)
    v_pk_add_f32 v[76:77], v[76:77], v[92:93]
    v_pk_add_f32 v[78:79], v[78:79], v[94:95]
    v_pk_add_f32 v[76:77], v[76:77], v[108:109]
    v_pk_add_f32 v[78:79], v[78:79], v[110:111]
    v_pk_add_f32 v[76:77], v[76:77], v[124:125]
    v_pk_add_f32 v[78:79], v[78:79], v[126:127]
    v_pk_fma_f32 v[76:77], v[76:77], v[24:25], v[44:45] op_sel_hi:[1,0,1]
    v_pk_fma_f32 v[78:79], v[78:79], v[24:25], v[46:47] op_sel_hi:[1,0,1]
    v_cvt_pk_bf16_f32 v22, v76, v77
    v_cvt_pk_bf16_f32 v23, v78, v79
    s_nop 1
    v_permlane16_swap_b32 v16, v18
    v_permlane16_swap_b32 v17, v19
    buffer_store_dwordx4 v[16:19], v14, s[24:27], 0 offen offset:0 sc1
    v_permlane16_swap_b32 v20, v22
    v_permlane16_swap_b32 v21, v23
    buffer_store_dwordx4 v[20:23], v14, s[24:27], 0 offen offset:64 sc1
    s_or_b32 s44, s2, s32
    s_cbranch_scc1 L_ep_85
    s_add_u32 s39, s39, 1
    v_mov_b32 v13, s39
    s_mov_b64 exec, 1
    buffer_store_dword v13, v1, s[28:31], 0 offen offset:0
    s_mov_b64 exec, -1
L_ep_85:
L_end:
    s_endpgm
L_code_end:
L_ss_13:
    buffer_store_dwordx4 v[24:27], v1, s[28:31], s52 offen sc1
    buffer_store_dwordx4 v[28:31], v1, s[28:31], s53 offen sc1
    s_branch L_se_14
L_ss_15:
    buffer_store_dword v13, v1, s[28:31], s54 offen offset:0 sc1
    s_branch L_se_16
L_ss_19:
    buffer_store_dwordx4 v[16:19], v1, s[28:31], s43 offen offset:0 sc1
    buffer_store_dwordx4 v[20:23], v1, s[28:31], s43 offen offset:1024 sc1
    s_branch L_se_20
L_ss_21:
    buffer_store_dword v14, v40, s[28:31], s45 offen sc1
    s_branch L_se_22
L_ss_23:
    buffer_store_dword v13, v1, s[28:31], s56 offen offset:512 sc1
    s_branch L_se_24
L_sg_27:
    buffer_load_dwordx4 v[24:27], v1, s[28:31], s46 offen offset:0 sc1
    buffer_load_dwordx4 v[28:31], v1, s[28:31], s46 offen offset:1024 sc1
    s_waitcnt vmcnt(0)
    v_xor_b32 v24, s93, v24
    v_xor_b32 v25, s93, v25
    v_xor_b32 v26, s93, v26
    v_xor_b32 v27, s93, v27
    v_xor_b32 v28, s93, v28
    v_xor_b32 v29, s93, v29
    v_xor_b32 v30, s93, v30
    v_xor_b32 v31, s93, v31
    v_or3_b32 v120, v24, v25, v26
    v_or3_b32 v121, v27, v28, v29
    v_or3_b32 v120, v120, v30, v31
    v_or_b32 v120, v120, v121
    v_and_b32 v120, 0xff, v120
    v_cmp_ne_u32 vcc, 0, v120
    s_cbranch_vccz L_sgok_28
    s_sub_u32 s38, s38, 1
    s_cbranch_scc0 L_sg_27
    s_mov_b32 s38, 0
    s_branch L_sgok_28
L_ss_29:
    buffer_store_dword v13, v1, s[28:31], s66 offen offset:1536 sc1
    s_branch L_se_30
L_ss_31:
    buffer_store_dwordx4 v[48:51], v1, s[28:31], s62 offen sc1
    buffer_store_dwordx2 v[52:53], v1, s[28:31], s64 offen sc1
    buffer_store_dwordx4 v[56:59], v1, s[28:31], s63 offen sc1
    buffer_store_dwordx2 v[60:61], v1, s[28:31], s65 offen sc1
    s_branch L_se_32
L_ap_34:
    buffer_load_dword v12, v15, s[28:31], s67 offen offset:1536 sc1
    s_waitcnt vmcnt(0)
    v_cmp_ne_u32 vcc, s35, v12
    s_cbranch_vccz L_aok_33
    s_sub_u32 s38, s38, 1
    s_cbranch_scc0 L_ap_34
    s_mov_b32 s38, 0
    s_branch L_aok_33
L_ss_35:
    buffer_store_dword v13, v1, s[28:31], s66 offen offset:2560 sc1
    s_branch L_se_36
L_ap_38:
    buffer_load_dword v12, v15, s[28:31], s67 offen offset:2560 sc1
    s_waitcnt vmcnt(0)
    v_cmp_ne_u32 vcc, s35, v12
    s_cbranch_vccz L_aok_37
    s_sub_u32 s38, s38, 1
    s_cbranch_scc0 L_ap_38
    s_mov_b32 s38, 0
    s_branch L_aok_37
L_ss_39:
    buffer_store_dwordx4 v[16:19], v1, s[28:31], s43 offen offset:0 sc1
    buffer_store_dwordx4 v[20:23], v1, s[28:31], s43 offen offset:1024 sc1
    s_branch L_se_40
L_ss_41:
    buffer_store_dword v14, v40, s[28:31], s45 offen sc1
    s_branch L_se_42
L_ss_43:
    buffer_store_dword v13, v1, s[28:31], s56 offen offset:1024 sc1
    s_branch L_se_44
L_sg_47:
    buffer_load_dwordx4 v[112:115], v1, s[28:31], s46 offen offset:0 sc1
    buffer_load_dwordx4 v[116:119], v1, s[28:31], s46 offen offset:1024 sc1
    s_waitcnt vmcnt(0)
    v_xor_b32 v112, s93, v112
    v_xor_b32 v113, s93, v113
    v_xor_b32 v114, s93, v114
    v_xor_b32 v115, s93, v115
    v_xor_b32 v116, s93, v116
    v_xor_b32 v117, s93, v117
    v_xor_b32 v118, s93, v118
    v_xor_b32 v119, s93, v119
    v_or3_b32 v120, v112, v113, v114
    v_or3_b32 v121, v115, v116, v117
    v_or3_b32 v120, v120, v118, v119
    v_or_b32 v120, v120, v121
    v_and_b32 v120, 0xff, v120
    v_cmp_ne_u32 vcc, 0, v120
    s_cbranch_vccz L_sgok_48
    s_sub_u32 s38, s38, 1
    s_cbranch_scc0 L_sg_47
    s_mov_b32 s38, 0
    s_branch L_sgok_48
L_ss_51:
    buffer_store_dwordx4 v[24:27], v1, s[28:31], s52 offen sc1
    buffer_store_dwordx4 v[28:31], v1, s[28:31], s53 offen sc1
    s_branch L_se_52
L_ss_53:
    buffer_store_dword v13, v1, s[28:31], s54 offen offset:0 sc1
    s_branch L_se_54
L_ss_57:
    buffer_store_dwordx4 v[16:19], v1, s[28:31], s43 offen offset:0 sc1
    buffer_store_dwordx4 v[20:23], v1, s[28:31], s43 offen offset:1024 sc1
    s_branch L_se_58
L_ss_59:
    buffer_store_dword v14, v40, s[28:31], s45 offen sc1
    s_branch L_se_60
L_ss_61:
    buffer_store_dword v13, v1, s[28:31], s56 offen offset:512 sc1
    s_branch L_se_62
L_sg_65:
    buffer_load_dwordx4 v[24:27], v1, s[28:31], s46 offen offset:0 sc1
    buffer_load_dwordx4 v[28:31], v1, s[28:31], s46 offen offset:1024 sc1
    s_waitcnt vmcnt(0)
    v_xor_b32 v24, s93, v24
    v_xor_b32 v25, s93, v25
    v_xor_b32 v26, s93, v26
    v_xor_b32 v27, s93, v27
    v_xor_b32 v28, s93, v28
    v_xor_b32 v29, s93, v29
    v_xor_b32 v30, s93, v30
    v_xor_b32 v31, s93, v31
    v_or3_b32 v120, v24, v25, v26
    v_or3_b32 v121, v27, v28, v29
    v_or3_b32 v120, v120, v30, v31
    v_or_b32 v120, v120, v121
    v_and_b32 v120, 0xff, v120
    v_cmp_ne_u32 vcc, 0, v120
    s_cbranch_vccz L_sgok_66
    s_sub_u32 s38, s38, 1
    s_cbranch_scc0 L_sg_65
    s_mov_b32 s38, 0
    s_branch L_sgok_66
L_ss_67:
    buffer_store_dwordx4 v[64:67], v1, s[28:31], s44 offen sc1
    buffer_store_dwordx4 v[68:71], v1, s[28:31], s45 offen sc1
    s_branch L_se_68
L_ss_69:
    buffer_store_dwordx4 v[80:83], v1, s[28:31], s60 offen offset:3072 sc1
    buffer_store_dwordx4 v[84:87], v1, s[28:31], s61 offen offset:3072 sc1
    s_branch L_se_70
L_ss_71:
    buffer_store_dword v13, v1, s[28:31], s66 offen offset:1536 sc1
    s_branch L_se_72
L_ss_73:
    buffer_store_dword v13, v1, s[28:31], s66 offen offset:1600 sc1
    s_branch L_se_74
L_ap_76:
    buffer_load_dword v12, v15, s[28:31], s67 offen offset:1600 sc1
    s_waitcnt vmcnt(0)
    v_cmp_ne_u32 vcc, s35, v12
    s_cbranch_vccz L_aok_75
    s_sub_u32 s38, s38, 1
    s_cbranch_scc0 L_ap_76
    s_mov_b32 s38, 0
    s_branch L_aok_75
L_ss_77:
    buffer_store_dwordx4 v[48:51], v1, s[28:31], s62 offen sc1
    buffer_store_dwordx2 v[52:53], v1, s[28:31], s64 offen sc1
    buffer_store_dwordx4 v[56:59], v1, s[28:31], s63 offen sc1
    buffer_store_dwordx2 v[60:61], v1, s[28:31], s65 offen sc1
    s_branch L_se_78
L_ss_79:
    buffer_store_dword v13, v1, s[28:31], s66 offen offset:2560 sc1
    s_branch L_se_80
L_ap_82:
    buffer_load_dword v12, v15, s[28:31], s67 offen offset:1536 sc1
    s_waitcnt vmcnt(0)
    v_cmp_ne_u32 vcc, s35, v12
    s_cbranch_vccz L_aok_81
    s_sub_u32 s38, s38, 1
    s_cbranch_scc0 L_ap_82
    s_mov_b32 s38, 0
    s_branch L_aok_81
L_ap_84:
    buffer_load_dword v12, v15, s[28:31], s67 offen offset:2560 sc1
    s_waitcnt vmcnt(0)
    v_cmp_ne_u32 vcc, s35, v12
    s_cbranch_vccz L_aok_83
    s_sub_u32 s38, s38, 1
    s_cbranch_scc0 L_ap_84
    s_mov_b32 s38, 0
    s_branch L_aok_83
.section .rodata,"a"
.p2align 6
.amdhsa_kernel interleave_layers__linear_attn_block__dense_activation_relu__prompt_kernel
  .amdhsa_next_free_vgpr 512
  .amdhsa_next_free_sgpr 102
  .amdhsa_accum_offset 256
  .amdhsa_group_segment_fixed_size 0
  .amdhsa_kernarg_size 72
  .amdhsa_user_sgpr_count 2
  .amdhsa_user_sgpr_kernarg_segment_ptr 1
  .amdhsa_system_sgpr_workgroup_id_x 1
.end_amdhsa_kernel
```
